```python
import torch

def _softmax(x, axis=-1):
    return torch.softmax(x, dim=axis)

def _gelu(x):
    return torch.nn.functional.gelu(x, approximate='tanh')

def _silu(x):
    return torch.nn.functional.silu(x)

def _sigmoid(x):
    return torch.sigmoid(x)

def _layernorm(x, axis=-1, eps=1e-05):
    m = x.mean(dim=axis, keepdim=True)
    v = x.var(dim=axis, keepdim=True, unbiased=False)
    return (x - m) / torch.sqrt(v + eps)

def _scatter_add(tgt, idx, src, axis=0):
    return tgt.clone().index_add_(axis, idx, src)

def _segment_sum(src, seg, n):
    out = torch.zeros((n,) + src.shape[1:], dtype=src.dtype)
    return out.index_add_(0, seg, src)

def _pad(x, pw):
    flat = tuple((v for pair in reversed(pw) for v in pair))
    return torch.nn.functional.pad(x, flat)
kernel_name = 'recurrent_scan__memory_aug_recurrent_mem_tr__geglu_ffn__prompt'

def setup_inputs():

    _w = lambda a: (lambda t: t.to(torch.bfloat16) if t.is_floating_point() else t)(torch.as_tensor(a))

    def _A_setup():
        B, S, Dm = (1, 2048, 640)
        H, Dh = (32, 128)
        M, seg = (8, 32)
        seg = min(seg, S)
        S = S // seg * seg
        return {'x': _w((lambda *s: torch.randn(*s, dtype=torch.bfloat16) * 0.05)(B, S, Dm)), 'mem0': _w((lambda *s: torch.randn(*s, dtype=torch.bfloat16) * 0.2)(B, M, Dm)), 'Wq': _w((lambda *s: torch.randn(*s, dtype=torch.bfloat16) * 0.8)(Dm, H, Dh) * Dm ** (-0.5)), 'Wk': _w((lambda *s: torch.randn(*s, dtype=torch.bfloat16) * 0.8)(Dm, H, Dh) * Dm ** (-0.5)), 'Wv': _w((lambda *s: torch.randn(*s, dtype=torch.bfloat16) * 0.2)(Dm, H, Dh) * Dm ** (-0.5)), 'Wo': _w((lambda *s: torch.randn(*s, dtype=torch.bfloat16) * 0.2)(H, Dh, Dm) * (H * Dh) ** (-0.5)), 'seg_len': seg}
    _A_in = _A_setup()

    def _B_setup():
        B, S, D, F = (1, 2048, 640, 1728)
        return {'x': _w((lambda *s: torch.randn(*s, dtype=torch.bfloat16) * 0.05)(B, S, D)), 'w_gate': _w((lambda *s: torch.randn(*s, dtype=torch.bfloat16) * 0.1)(D, F)), 'w_up': _w((lambda *s: torch.randn(*s, dtype=torch.bfloat16) * 0.1)(D, F)), 'w_down': _w((lambda *s: torch.randn(*s, dtype=torch.bfloat16) * 0.1)(F, D))}
    _B_in = _B_setup()
    return {'A_x': _A_in['x'], 'A_mem0': _A_in['mem0'], 'A_Wq': _A_in['Wq'], 'A_Wk': _A_in['Wk'], 'A_Wv': _A_in['Wv'], 'A_Wo': _A_in['Wo'], 'A_seg_len': _A_in['seg_len'], 'B_x': _B_in['x'], 'B_w_gate': _B_in['w_gate'], 'B_w_up': _B_in['w_up'], 'B_w_down': _B_in['w_down']}

def reference(A_x, A_mem0, A_Wq, A_Wk, A_Wv, A_Wo, A_seg_len, B_x, B_w_gate, B_w_up, B_w_down):

    def _A_ref(x, mem0, Wq, Wk, Wv, Wo, seg_len):
        B, S, Dm = x.shape
        H, Dh = (Wq.shape[1], Wq.shape[2])
        M = mem0.shape[1]
        scale = Dh ** (-0.5)
        n_seg = S // seg_len
        L = M + seg_len
        idx = torch.arange(L)
        mask = (idx[:, None] < M) | (idx[:, None] >= idx[None, :])
        mem = mem0
        outs = []
        for s in range(n_seg):
            xs = x[:, s * seg_len:(s + 1) * seg_len, :].clone()
            h = torch.concatenate([mem, xs], axis=1)
            q = torch.einsum('btd,dhe->bhte', h, Wq)
            k = torch.einsum('btd,dhe->bhte', h, Wk)
            v = torch.einsum('btd,dhe->bhte', h, Wv)
            scores = torch.einsum('bhqe,bhke->bhqk', q, k) * scale
            scores = torch.where(mask[None, None], scores, -1000000000.0)
            p = _softmax(scores, axis=-1)
            o = torch.einsum('bhqk,bhke->bhqe', p, v)
            o = torch.einsum('bhte,hed->btd', o, Wo)
            mem = o[:, :M, :].clone()
            outs.append(o[:, M:, :])
        return torch.concatenate(outs, axis=1)

    def _B_ref(x, w_gate, w_up, w_down):
        return _gelu(x @ w_gate) * (x @ w_up) @ w_down
    x = A_x
    xn = _layernorm(x, axis=-1)
    s = _A_ref(xn, A_mem0, A_Wq, A_Wk, A_Wv, A_Wo, A_seg_len)
    g = _silu(_B_ref(xn, B_w_gate, B_w_up, B_w_down))
    return x + s * g
```

```asm
; @launch grid=(256,1,1) block=(256,1,1) lds=163840
.amdgcn_target "amdgcn-amd-amdhsa--gfx950"
.text
.globl recurrent_scan__memory_aug_recurrent_mem_tr__geglu_ffn__prompt_kernel
.p2align 8
.type recurrent_scan__memory_aug_recurrent_mem_tr__geglu_ffn__prompt_kernel,@function
recurrent_scan__memory_aug_recurrent_mem_tr__geglu_ffn__prompt_kernel:
    s_cmp_ge_u32 s2, 256
    s_cbranch_scc1 M_done
    s_add_u32 s6, s2, 7
    s_and_b32 s6, s6, 7
    s_cmp_lt_u32 s6, 2
    s_cbranch_scc1 M_rec
    s_sub_u32 s3, s6, 2
    s_lshr_b32 s5, s2, 3
    s_load_dwordx2 s[8:9], s[0:1], 104
    s_load_dwordx8 s[72:79], s[0:1], 16
    s_load_dwordx4 s[80:83], s[0:1], 64
    s_load_dwordx2 s[84:85], s[0:1], 80
    s_load_dwordx2 s[86:87], s[0:1], 0
    s_load_dwordx2 s[88:89], s[0:1], 88
    s_load_dwordx2 s[92:93], s[0:1], 96
    s_mov_b32 s94, 256
    s_mov_b32 s95, 0x20000
    v_lshrrev_b32 v6, 6, v0
    v_and_b32 v7, 63, v0
    v_readfirstlane_b32 s4, v6
    s_mov_b32 s10, 0x10000000
    s_mov_b32 s11, 0x20000
    s_mov_b32 s15, 0x20000
    s_mov_b32 s19, 0x20000
    v_lshlrev_b32 v0, 4, v7
    s_mov_b32 s40, 2000000
    s_waitcnt lgkmcnt(0)
    s_lshl_b32 s64, s3, 5
    s_add_u32 s64, s64, s5
    s_mul_i32 s26, s64, 10923
    s_lshr_b32 s26, s26, 16
    s_mul_i32 s65, s26, 6
    s_sub_u32 s20, s64, s65
    s_mov_b32 s36, s64
    s_cmp_ge_u32 s36, 128
    s_cbranch_scc1 KV_noln0
    s_mov_b32 s16, s86
    s_mov_b32 s17, s87
    s_mov_b32 s18, 2621440
    s_lshl_b32 s64, s36, 2
    s_add_u32 s64, s64, s4
    s_lshl_b32 s64, s64, 2
    v_lshrrev_b32 v116, 4, v7
    v_add_u32 v116, s64, v116
    v_and_b32 v117, 15, v7
    v_mul_u32_u24 v118, 1280, v116
    v_lshl_add_u32 v118, v117, 4, v118
    buffer_load_dwordx4 v[96:99], v118, s[16:19], 0 offen offset:0
    buffer_load_dwordx4 v[100:103], v118, s[16:19], 0 offen offset:256
    buffer_load_dwordx4 v[104:107], v118, s[16:19], 0 offen offset:512
    buffer_load_dwordx4 v[108:111], v118, s[16:19], 0 offen offset:768
    buffer_load_dwordx4 v[112:115], v118, s[16:19], 0 offen offset:1024
KV_noln0:
    s_sub_u32 s38, s26, 21
    s_cmp_eq_u32 s20, 5
    s_cselect_b32 s38, s38, 6
    s_mov_b32 s37, s38
    s_cmp_ge_u32 s38, 6
    s_cbranch_scc1 P_ns
    s_lshl_b32 s37, s37, 14
    s_lshl_b32 s64, s4, 11
    s_add_u32 s37, s37, s64
    s_add_u32 s37, s37, 106561536
    v_and_b32 v8, 1, v7
    v_lshlrev_b32 v8, 13, v8
    v_bfe_u32 v9, v7, 1, 4
    v_lshl_add_u32 v8, v9, 7, v8
    v_mov_b32 v9, 1
    buffer_store_dword v9, v8, s[8:11], s37 offen sc1
P_ns:
    s_lshl_b32 s64, s20, 1
    s_lshr_b32 s65, s4, 1
    s_add_u32 s64, s64, s65
    s_mul_i32 s23, s64, 40960
    s_and_b32 s65, s4, 1
    s_lshl_b32 s65, s65, 12
    s_add_u32 s23, s23, s65
    s_lshl_b32 s27, s4, 12
    s_mov_b32 s22, 0
    s_mov_b32 s29, 0
    s_cmp_ge_u32 s26, 16
    s_cselect_b32 s12, s76, s74
    s_cselect_b32 s13, s77, s75
    s_mov_b32 s14, 5242880
    s_and_b32 s64, s26, 15
    s_lshl_b32 s64, s64, 9
    s_lshl_b32 s65, s4, 7
    s_add_u32 s32, s64, s65
    s_mul_i32 s33, s4, 24576
    s_add_u32 s33, s33, 65536
    v_lshrrev_b32 v8, 3, v7
    v_and_b32 v9, 7, v7
    v_lshlrev_b32 v3, 13, v8
    v_lshl_add_u32 v3, v9, 4, v3
    v_lshrrev_b32 v8, 5, v7
    v_lshlrev_b32 v8, 10, v8
    v_bfe_u32 v10, v7, 2, 2
    v_lshl_add_u32 v8, v10, 7, v8
    v_bfe_u32 v10, v7, 4, 1
    v_lshl_add_u32 v8, v10, 5, v8
    v_and_b32 v9, 3, v7
    v_lshl_add_u32 v8, v9, 3, v8
    v_add_u32 v4, s33, v8
    s_add_u32 m0, s33, 0
    s_add_u32 s64, s32, 0
    buffer_load_dwordx4 v3, s[12:15], s64 offen lds
    s_add_u32 m0, s33, 1024
    s_add_u32 s64, s32, 65536
    buffer_load_dwordx4 v3, s[12:15], s64 offen lds
    s_add_u32 m0, s33, 2048
    s_add_u32 s64, s32, 131072
    buffer_load_dwordx4 v3, s[12:15], s64 offen lds
    s_add_u32 m0, s33, 3072
    s_add_u32 s64, s32, 196608
    buffer_load_dwordx4 v3, s[12:15], s64 offen lds
    s_add_u32 m0, s33, 4096
    s_add_u32 s64, s32, 262144
    buffer_load_dwordx4 v3, s[12:15], s64 offen lds
    s_add_u32 m0, s33, 5120
    s_add_u32 s64, s32, 327680
    buffer_load_dwordx4 v3, s[12:15], s64 offen lds
    s_add_u32 m0, s33, 6144
    s_add_u32 s64, s32, 393216
    buffer_load_dwordx4 v3, s[12:15], s64 offen lds
    s_add_u32 m0, s33, 7168
    s_add_u32 s64, s32, 458752
    buffer_load_dwordx4 v3, s[12:15], s64 offen lds
    s_add_u32 m0, s33, 8192
    s_add_u32 s64, s32, 524288
    buffer_load_dwordx4 v3, s[12:15], s64 offen lds
    s_add_u32 m0, s33, 9216
    s_add_u32 s64, s32, 589824
    buffer_load_dwordx4 v3, s[12:15], s64 offen lds
    s_add_u32 m0, s33, 10240
    s_add_u32 s64, s32, 655360
    buffer_load_dwordx4 v3, s[12:15], s64 offen lds
    s_add_u32 m0, s33, 11264
    s_add_u32 s64, s32, 720896
    buffer_load_dwordx4 v3, s[12:15], s64 offen lds
    s_add_u32 m0, s33, 12288
    s_add_u32 s64, s32, 786432
    buffer_load_dwordx4 v3, s[12:15], s64 offen lds
    s_add_u32 m0, s33, 13312
    s_add_u32 s64, s32, 851968
    buffer_load_dwordx4 v3, s[12:15], s64 offen lds
    s_add_u32 m0, s33, 14336
    s_add_u32 s64, s32, 917504
    buffer_load_dwordx4 v3, s[12:15], s64 offen lds
    s_add_u32 m0, s33, 15360
    s_add_u32 s64, s32, 983040
    buffer_load_dwordx4 v3, s[12:15], s64 offen lds
    s_add_u32 m0, s33, 16384
    s_add_u32 s64, s32, 1048576
    buffer_load_dwordx4 v3, s[12:15], s64 offen lds
    s_add_u32 m0, s33, 17408
    s_add_u32 s64, s32, 1114112
    buffer_load_dwordx4 v3, s[12:15], s64 offen lds
    s_add_u32 m0, s33, 18432
    s_add_u32 s64, s32, 1179648
    buffer_load_dwordx4 v3, s[12:15], s64 offen lds
    s_add_u32 m0, s33, 19456
    s_add_u32 s64, s32, 1245184
    buffer_load_dwordx4 v3, s[12:15], s64 offen lds
    s_add_u32 m0, s33, 20480
    s_add_u32 s64, s32, 1310720
    buffer_load_dwordx4 v3, s[12:15], s64 offen lds
    s_add_u32 m0, s33, 21504
    s_add_u32 s64, s32, 1376256
    buffer_load_dwordx4 v3, s[12:15], s64 offen lds
    s_add_u32 m0, s33, 22528
    s_add_u32 s64, s32, 1441792
    buffer_load_dwordx4 v3, s[12:15], s64 offen lds
    s_add_u32 m0, s33, 23552
    s_add_u32 s64, s32, 1507328
    buffer_load_dwordx4 v3, s[12:15], s64 offen lds
    s_cmp_ge_u32 s38, 6
    s_cbranch_scc1 P_done
    s_add_u32 s66, s8, s37
    s_addc_u32 s67, s9, 0
    s_mov_b32 s65, 0
    s_waitcnt vmcnt(24)
    s_mov_b32 s68, 0
    s_mov_b32 s69, 0
    s_load_dword s69, s[66:67], 8192 glc
    s_load_dword s68, s[66:67], 0 glc
    s_waitcnt lgkmcnt(1)
    s_waitcnt lgkmcnt(0)
    s_mov_b32 s68, 0
    s_mov_b32 s69, 0
    s_load_dword s68, s[66:67], 128 glc
    s_load_dword s69, s[66:67], 8320 glc
    s_waitcnt lgkmcnt(1)
    s_sub_u32 s64, s69, s68
    s_add_u32 s65, s65, s64
    s_waitcnt lgkmcnt(0)
    s_mov_b32 s68, 0
    s_mov_b32 s69, 0
    s_load_dword s69, s[66:67], 8448 glc
    s_load_dword s68, s[66:67], 256 glc
    s_waitcnt lgkmcnt(1)
    s_sub_u32 s64, s69, s68
    s_add_u32 s65, s65, s64
    s_waitcnt lgkmcnt(0)
    s_mov_b32 s68, 0
    s_mov_b32 s69, 0
    s_load_dword s68, s[66:67], 384 glc
    s_load_dword s69, s[66:67], 8576 glc
    s_waitcnt lgkmcnt(1)
    s_sub_u32 s64, s69, s68
    s_add_u32 s65, s65, s64
    s_waitcnt lgkmcnt(0)
    s_mov_b32 s68, 0
    s_mov_b32 s69, 0
    s_load_dword s69, s[66:67], 8704 glc
    s_load_dword s68, s[66:67], 512 glc
    s_waitcnt lgkmcnt(1)
    s_sub_u32 s64, s69, s68
    s_add_u32 s65, s65, s64
    s_waitcnt lgkmcnt(0)
    s_mov_b32 s68, 0
    s_mov_b32 s69, 0
    s_load_dword s68, s[66:67], 640 glc
    s_load_dword s69, s[66:67], 8832 glc
    s_waitcnt lgkmcnt(1)
    s_sub_u32 s64, s69, s68
    s_add_u32 s65, s65, s64
    s_waitcnt lgkmcnt(0)
    s_mov_b32 s68, 0
    s_mov_b32 s69, 0
    s_load_dword s69, s[66:67], 8960 glc
    s_load_dword s68, s[66:67], 768 glc
    s_waitcnt lgkmcnt(1)
    s_sub_u32 s64, s69, s68
    s_add_u32 s65, s65, s64
    s_waitcnt lgkmcnt(0)
    s_mov_b32 s68, 0
    s_mov_b32 s69, 0
    s_load_dword s68, s[66:67], 896 glc
    s_load_dword s69, s[66:67], 9088 glc
    s_waitcnt lgkmcnt(1)
    s_sub_u32 s64, s69, s68
    s_add_u32 s65, s65, s64
    s_waitcnt lgkmcnt(0)
    s_mov_b32 s68, 0
    s_mov_b32 s69, 0
    s_load_dword s69, s[66:67], 9216 glc
    s_load_dword s68, s[66:67], 1024 glc
    s_waitcnt lgkmcnt(1)
    s_sub_u32 s64, s69, s68
    s_add_u32 s65, s65, s64
    s_waitcnt lgkmcnt(0)
    s_getreg_b32 s64, hwreg(HW_REG_XCC_ID)
    s_sub_u32 s66, 0, s65
    s_bitcmp1_b32 s64, 2
    s_cselect_b32 s65, s66, s65
    s_add_u32 s65, s65, 65544
    v_mov_b32 v9, s65
    s_mov_b64 exec, 1
    buffer_atomic_add v9, off, s[92:95], 0 offset:0 sc1
    s_mov_b64 exec, -1
P_done:
    s_lshl_b32 s64, s36, 9
    s_add_u32 s64, s64, 109051904
    v_mov_b64 v[72:73], 0
    v_mov_b64 v[74:75], 0
    s_cmp_lg_u32 s4, 3
    s_cbranch_scc1 KV_noz
    s_mov_b32 exec_hi, 0
    buffer_store_dwordx4 v[72:75], v0, s[8:11], s64 offen sc1
    s_mov_b32 exec_hi, -1
KV_noz:
    s_cmp_ge_u32 s36, 128
    s_cbranch_scc1 KV_noln1
    s_waitcnt vmcnt(24)
    v_lshlrev_b32 v32, 16, v96
    v_and_b32 v33, 0xffff0000, v96
    v_lshlrev_b32 v34, 16, v97
    v_and_b32 v35, 0xffff0000, v97
    v_lshlrev_b32 v36, 16, v98
    v_and_b32 v37, 0xffff0000, v98
    v_lshlrev_b32 v38, 16, v99
    v_and_b32 v39, 0xffff0000, v99
    v_lshlrev_b32 v40, 16, v100
    v_and_b32 v41, 0xffff0000, v100
    v_lshlrev_b32 v42, 16, v101
    v_and_b32 v43, 0xffff0000, v101
    v_lshlrev_b32 v44, 16, v102
    v_and_b32 v45, 0xffff0000, v102
    v_lshlrev_b32 v46, 16, v103
    v_and_b32 v47, 0xffff0000, v103
    v_lshlrev_b32 v48, 16, v104
    v_and_b32 v49, 0xffff0000, v104
    v_lshlrev_b32 v50, 16, v105
    v_and_b32 v51, 0xffff0000, v105
    v_lshlrev_b32 v52, 16, v106
    v_and_b32 v53, 0xffff0000, v106
    v_lshlrev_b32 v54, 16, v107
    v_and_b32 v55, 0xffff0000, v107
    v_lshlrev_b32 v56, 16, v108
    v_and_b32 v57, 0xffff0000, v108
    v_lshlrev_b32 v58, 16, v109
    v_and_b32 v59, 0xffff0000, v109
    v_lshlrev_b32 v60, 16, v110
    v_and_b32 v61, 0xffff0000, v110
    v_lshlrev_b32 v62, 16, v111
    v_and_b32 v63, 0xffff0000, v111
    v_lshlrev_b32 v64, 16, v112
    v_and_b32 v65, 0xffff0000, v112
    v_lshlrev_b32 v66, 16, v113
    v_and_b32 v67, 0xffff0000, v113
    v_lshlrev_b32 v68, 16, v114
    v_and_b32 v69, 0xffff0000, v114
    v_lshlrev_b32 v70, 16, v115
    v_and_b32 v71, 0xffff0000, v115
    v_add_f32 v72, v32, v33
    v_add_f32 v72, v72, v34
    v_add_f32 v72, v72, v35
    v_add_f32 v72, v72, v36
    v_add_f32 v72, v72, v37
    v_add_f32 v72, v72, v38
    v_add_f32 v72, v72, v39
    v_add_f32 v72, v72, v40
    v_add_f32 v72, v72, v41
    v_add_f32 v72, v72, v42
    v_add_f32 v72, v72, v43
    v_add_f32 v72, v72, v44
    v_add_f32 v72, v72, v45
    v_add_f32 v72, v72, v46
    v_add_f32 v72, v72, v47
    v_add_f32 v72, v72, v48
    v_add_f32 v72, v72, v49
    v_add_f32 v72, v72, v50
    v_add_f32 v72, v72, v51
    v_add_f32 v72, v72, v52
    v_add_f32 v72, v72, v53
    v_add_f32 v72, v72, v54
    v_add_f32 v72, v72, v55
    v_add_f32 v72, v72, v56
    v_add_f32 v72, v72, v57
    v_add_f32 v72, v72, v58
    v_add_f32 v72, v72, v59
    v_add_f32 v72, v72, v60
    v_add_f32 v72, v72, v61
    v_add_f32 v72, v72, v62
    v_add_f32 v72, v72, v63
    v_add_f32 v72, v72, v64
    v_add_f32 v72, v72, v65
    v_add_f32 v72, v72, v66
    v_add_f32 v72, v72, v67
    v_add_f32 v72, v72, v68
    v_add_f32 v72, v72, v69
    v_add_f32 v72, v72, v70
    v_add_f32 v72, v72, v71
    s_nop 1
    v_add_f32_dpp v72, v72, v72 row_ror:8 row_mask:0xf bank_mask:0xf
    s_nop 1
    v_add_f32_dpp v72, v72, v72 row_ror:4 row_mask:0xf bank_mask:0xf
    s_nop 1
    v_add_f32_dpp v72, v72, v72 row_ror:2 row_mask:0xf bank_mask:0xf
    s_nop 1
    v_add_f32_dpp v72, v72, v72 row_ror:1 row_mask:0xf bank_mask:0xf
    s_mov_b32 s64, 0x3acccccd
    v_mul_f32 v72, s64, v72
    v_sub_f32 v74, v32, v72
    v_mul_f32 v73, v74, v74
    v_sub_f32 v74, v33, v72
    v_fmac_f32 v73, v74, v74
    v_sub_f32 v74, v34, v72
    v_fmac_f32 v73, v74, v74
    v_sub_f32 v74, v35, v72
    v_fmac_f32 v73, v74, v74
    v_sub_f32 v74, v36, v72
    v_fmac_f32 v73, v74, v74
    v_sub_f32 v74, v37, v72
    v_fmac_f32 v73, v74, v74
    v_sub_f32 v74, v38, v72
    v_fmac_f32 v73, v74, v74
    v_sub_f32 v74, v39, v72
    v_fmac_f32 v73, v74, v74
    v_sub_f32 v74, v40, v72
    v_fmac_f32 v73, v74, v74
    v_sub_f32 v74, v41, v72
    v_fmac_f32 v73, v74, v74
    v_sub_f32 v74, v42, v72
    v_fmac_f32 v73, v74, v74
    v_sub_f32 v74, v43, v72
    v_fmac_f32 v73, v74, v74
    v_sub_f32 v74, v44, v72
    v_fmac_f32 v73, v74, v74
    v_sub_f32 v74, v45, v72
    v_fmac_f32 v73, v74, v74
    v_sub_f32 v74, v46, v72
    v_fmac_f32 v73, v74, v74
    v_sub_f32 v74, v47, v72
    v_fmac_f32 v73, v74, v74
    v_sub_f32 v74, v48, v72
    v_fmac_f32 v73, v74, v74
    v_sub_f32 v74, v49, v72
    v_fmac_f32 v73, v74, v74
    v_sub_f32 v74, v50, v72
    v_fmac_f32 v73, v74, v74
    v_sub_f32 v74, v51, v72
    v_fmac_f32 v73, v74, v74
    v_sub_f32 v74, v52, v72
    v_fmac_f32 v73, v74, v74
    v_sub_f32 v74, v53, v72
    v_fmac_f32 v73, v74, v74
    v_sub_f32 v74, v54, v72
    v_fmac_f32 v73, v74, v74
    v_sub_f32 v74, v55, v72
    v_fmac_f32 v73, v74, v74
    v_sub_f32 v74, v56, v72
    v_fmac_f32 v73, v74, v74
    v_sub_f32 v74, v57, v72
    v_fmac_f32 v73, v74, v74
    v_sub_f32 v74, v58, v72
    v_fmac_f32 v73, v74, v74
    v_sub_f32 v74, v59, v72
    v_fmac_f32 v73, v74, v74
    v_sub_f32 v74, v60, v72
    v_fmac_f32 v73, v74, v74
    v_sub_f32 v74, v61, v72
    v_fmac_f32 v73, v74, v74
    v_sub_f32 v74, v62, v72
    v_fmac_f32 v73, v74, v74
    v_sub_f32 v74, v63, v72
    v_fmac_f32 v73, v74, v74
    v_sub_f32 v74, v64, v72
    v_fmac_f32 v73, v74, v74
    v_sub_f32 v74, v65, v72
    v_fmac_f32 v73, v74, v74
    v_sub_f32 v74, v66, v72
    v_fmac_f32 v73, v74, v74
    v_sub_f32 v74, v67, v72
    v_fmac_f32 v73, v74, v74
    v_sub_f32 v74, v68, v72
    v_fmac_f32 v73, v74, v74
    v_sub_f32 v74, v69, v72
    v_fmac_f32 v73, v74, v74
    v_sub_f32 v74, v70, v72
    v_fmac_f32 v73, v74, v74
    v_sub_f32 v74, v71, v72
    v_fmac_f32 v73, v74, v74
    s_nop 1
    v_add_f32_dpp v73, v73, v73 row_ror:8 row_mask:0xf bank_mask:0xf
    s_nop 1
    v_add_f32_dpp v73, v73, v73 row_ror:4 row_mask:0xf bank_mask:0xf
    s_nop 1
    v_add_f32_dpp v73, v73, v73 row_ror:2 row_mask:0xf bank_mask:0xf
    s_nop 1
    v_add_f32_dpp v73, v73, v73 row_ror:1 row_mask:0xf bank_mask:0xf
    v_mul_f32 v73, s64, v73
    v_cvt_pk_bf16_f32 v73, v73, v73
    v_lshlrev_b32 v73, 16, v73
    v_cvt_pk_bf16_f32 v72, v72, v72
    v_lshlrev_b32 v72, 16, v72
    v_add_f32 v73, 0x3727c5ac, v73
    v_cvt_pk_bf16_f32 v73, v73, v73
    v_lshlrev_b32 v73, 16, v73
    v_sqrt_f32 v73, v73
    s_nop 0
    v_cvt_pk_bf16_f32 v73, v73, v73
    v_lshlrev_b32 v73, 16, v73
    v_rcp_f32 v74, v73
    s_nop 0
    v_fma_f32 v73, -v73, v74, 1.0
    v_fmac_f32 v74, v73, v74
    v_sub_f32 v32, v32, v72
    v_sub_f32 v33, v33, v72
    v_cvt_pk_bf16_f32 v32, v32, v33
    v_and_b32 v33, 0xffff0000, v32
    v_lshlrev_b32 v32, 16, v32
    v_mul_f32 v32, v32, v74
    v_mul_f32 v33, v33, v74
    v_cvt_pk_bf16_f32 v96, v32, v33
    v_sub_f32 v34, v34, v72
    v_sub_f32 v35, v35, v72
    v_cvt_pk_bf16_f32 v34, v34, v35
    v_and_b32 v35, 0xffff0000, v34
    v_lshlrev_b32 v34, 16, v34
    v_mul_f32 v34, v34, v74
    v_mul_f32 v35, v35, v74
    v_cvt_pk_bf16_f32 v97, v34, v35
    v_sub_f32 v36, v36, v72
    v_sub_f32 v37, v37, v72
    v_cvt_pk_bf16_f32 v36, v36, v37
    v_and_b32 v37, 0xffff0000, v36
    v_lshlrev_b32 v36, 16, v36
    v_mul_f32 v36, v36, v74
    v_mul_f32 v37, v37, v74
    v_cvt_pk_bf16_f32 v98, v36, v37
    v_sub_f32 v38, v38, v72
    v_sub_f32 v39, v39, v72
    v_cvt_pk_bf16_f32 v38, v38, v39
    v_and_b32 v39, 0xffff0000, v38
    v_lshlrev_b32 v38, 16, v38
    v_mul_f32 v38, v38, v74
    v_mul_f32 v39, v39, v74
    v_cvt_pk_bf16_f32 v99, v38, v39
    v_sub_f32 v40, v40, v72
    v_sub_f32 v41, v41, v72
    v_cvt_pk_bf16_f32 v40, v40, v41
    v_and_b32 v41, 0xffff0000, v40
    v_lshlrev_b32 v40, 16, v40
    v_mul_f32 v40, v40, v74
    v_mul_f32 v41, v41, v74
    v_cvt_pk_bf16_f32 v100, v40, v41
    v_sub_f32 v42, v42, v72
    v_sub_f32 v43, v43, v72
    v_cvt_pk_bf16_f32 v42, v42, v43
    v_and_b32 v43, 0xffff0000, v42
    v_lshlrev_b32 v42, 16, v42
    v_mul_f32 v42, v42, v74
    v_mul_f32 v43, v43, v74
    v_cvt_pk_bf16_f32 v101, v42, v43
    v_sub_f32 v44, v44, v72
    v_sub_f32 v45, v45, v72
    v_cvt_pk_bf16_f32 v44, v44, v45
    v_and_b32 v45, 0xffff0000, v44
    v_lshlrev_b32 v44, 16, v44
    v_mul_f32 v44, v44, v74
    v_mul_f32 v45, v45, v74
    v_cvt_pk_bf16_f32 v102, v44, v45
    v_sub_f32 v46, v46, v72
    v_sub_f32 v47, v47, v72
    v_cvt_pk_bf16_f32 v46, v46, v47
    v_and_b32 v47, 0xffff0000, v46
    v_lshlrev_b32 v46, 16, v46
    v_mul_f32 v46, v46, v74
    v_mul_f32 v47, v47, v74
    v_cvt_pk_bf16_f32 v103, v46, v47
    v_sub_f32 v48, v48, v72
    v_sub_f32 v49, v49, v72
    v_cvt_pk_bf16_f32 v48, v48, v49
    v_and_b32 v49, 0xffff0000, v48
    v_lshlrev_b32 v48, 16, v48
    v_mul_f32 v48, v48, v74
    v_mul_f32 v49, v49, v74
    v_cvt_pk_bf16_f32 v104, v48, v49
    v_sub_f32 v50, v50, v72
    v_sub_f32 v51, v51, v72
    v_cvt_pk_bf16_f32 v50, v50, v51
    v_and_b32 v51, 0xffff0000, v50
    v_lshlrev_b32 v50, 16, v50
    v_mul_f32 v50, v50, v74
    v_mul_f32 v51, v51, v74
    v_cvt_pk_bf16_f32 v105, v50, v51
    v_sub_f32 v52, v52, v72
    v_sub_f32 v53, v53, v72
    v_cvt_pk_bf16_f32 v52, v52, v53
    v_and_b32 v53, 0xffff0000, v52
    v_lshlrev_b32 v52, 16, v52
    v_mul_f32 v52, v52, v74
    v_mul_f32 v53, v53, v74
    v_cvt_pk_bf16_f32 v106, v52, v53
    v_sub_f32 v54, v54, v72
    v_sub_f32 v55, v55, v72
    v_cvt_pk_bf16_f32 v54, v54, v55
    v_and_b32 v55, 0xffff0000, v54
    v_lshlrev_b32 v54, 16, v54
    v_mul_f32 v54, v54, v74
    v_mul_f32 v55, v55, v74
    v_cvt_pk_bf16_f32 v107, v54, v55
    v_sub_f32 v56, v56, v72
    v_sub_f32 v57, v57, v72
    v_cvt_pk_bf16_f32 v56, v56, v57
    v_and_b32 v57, 0xffff0000, v56
    v_lshlrev_b32 v56, 16, v56
    v_mul_f32 v56, v56, v74
    v_mul_f32 v57, v57, v74
    v_cvt_pk_bf16_f32 v108, v56, v57
    v_sub_f32 v58, v58, v72
    v_sub_f32 v59, v59, v72
    v_cvt_pk_bf16_f32 v58, v58, v59
    v_and_b32 v59, 0xffff0000, v58
    v_lshlrev_b32 v58, 16, v58
    v_mul_f32 v58, v58, v74
    v_mul_f32 v59, v59, v74
    v_cvt_pk_bf16_f32 v109, v58, v59
    v_sub_f32 v60, v60, v72
    v_sub_f32 v61, v61, v72
    v_cvt_pk_bf16_f32 v60, v60, v61
    v_and_b32 v61, 0xffff0000, v60
    v_lshlrev_b32 v60, 16, v60
    v_mul_f32 v60, v60, v74
    v_mul_f32 v61, v61, v74
    v_cvt_pk_bf16_f32 v110, v60, v61
    v_sub_f32 v62, v62, v72
    v_sub_f32 v63, v63, v72
    v_cvt_pk_bf16_f32 v62, v62, v63
    v_and_b32 v63, 0xffff0000, v62
    v_lshlrev_b32 v62, 16, v62
    v_mul_f32 v62, v62, v74
    v_mul_f32 v63, v63, v74
    v_cvt_pk_bf16_f32 v111, v62, v63
    v_sub_f32 v64, v64, v72
    v_sub_f32 v65, v65, v72
    v_cvt_pk_bf16_f32 v64, v64, v65
    v_and_b32 v65, 0xffff0000, v64
    v_lshlrev_b32 v64, 16, v64
    v_mul_f32 v64, v64, v74
    v_mul_f32 v65, v65, v74
    v_cvt_pk_bf16_f32 v112, v64, v65
    v_sub_f32 v66, v66, v72
    v_sub_f32 v67, v67, v72
    v_cvt_pk_bf16_f32 v66, v66, v67
    v_and_b32 v67, 0xffff0000, v66
    v_lshlrev_b32 v66, 16, v66
    v_mul_f32 v66, v66, v74
    v_mul_f32 v67, v67, v74
    v_cvt_pk_bf16_f32 v113, v66, v67
    v_sub_f32 v68, v68, v72
    v_sub_f32 v69, v69, v72
    v_cvt_pk_bf16_f32 v68, v68, v69
    v_and_b32 v69, 0xffff0000, v68
    v_lshlrev_b32 v68, 16, v68
    v_mul_f32 v68, v68, v74
    v_mul_f32 v69, v69, v74
    v_cvt_pk_bf16_f32 v114, v68, v69
    v_sub_f32 v70, v70, v72
    v_sub_f32 v71, v71, v72
    v_cvt_pk_bf16_f32 v70, v70, v71
    v_and_b32 v71, 0xffff0000, v70
    v_lshlrev_b32 v70, 16, v70
    v_mul_f32 v70, v70, v74
    v_mul_f32 v71, v71, v74
    v_cvt_pk_bf16_f32 v115, v70, v71
    v_lshrrev_b32 v118, 5, v116
    v_mul_u32_u24 v118, 40960, v118
    v_and_b32 v116, 31, v116
    v_lshl_add_u32 v118, v116, 4, v118
    v_lshrrev_b32 v116, 1, v117
    v_lshl_add_u32 v118, v116, 10, v118
    v_and_b32 v116, 1, v117
    v_lshl_add_u32 v118, v116, 9, v118
    s_mov_b32 s64, 67108864
    buffer_store_dwordx4 v[96:99], v118, s[8:11], s64 offen sc1
    s_mov_b32 s64, 67117056
    buffer_store_dwordx4 v[100:103], v118, s[8:11], s64 offen sc1
    s_mov_b32 s64, 67125248
    buffer_store_dwordx4 v[104:107], v118, s[8:11], s64 offen sc1
    s_mov_b32 s64, 67133440
    buffer_store_dwordx4 v[108:111], v118, s[8:11], s64 offen sc1
    s_mov_b32 s64, 67141632
    buffer_store_dwordx4 v[112:115], v118, s[8:11], s64 offen sc1
KV_noln1:
    s_waitcnt vmcnt(0)
    s_barrier
    s_cmp_lg_u32 s4, 0
    s_cbranch_scc1 KV_noc
    s_and_b32 s64, s36, 1
    s_lshl_b32 s64, s64, 6
    v_mov_b32 v5, 1
    s_mov_b64 exec, 1
    buffer_atomic_add v5, off, s[92:95], s64 offset:64 sc1
    s_mov_b64 exec, -1
KV_noc:
    ds_read_b64_tr_b16 a[0:1], v4 offset:0
    ds_read_b64_tr_b16 a[2:3], v4 offset:512
    ds_read_b64_tr_b16 a[160:161], v4 offset:64
    ds_read_b64_tr_b16 a[162:163], v4 offset:576
    ds_read_b64_tr_b16 a[4:5], v4 offset:2048
    ds_read_b64_tr_b16 a[6:7], v4 offset:2560
    ds_read_b64_tr_b16 a[164:165], v4 offset:2112
    ds_read_b64_tr_b16 a[166:167], v4 offset:2624
    s_waitcnt lgkmcnt(0)
    ds_read_b64_tr_b16 a[8:9], v4 offset:4096
    ds_read_b64_tr_b16 a[10:11], v4 offset:4608
    ds_read_b64_tr_b16 a[168:169], v4 offset:4160
    ds_read_b64_tr_b16 a[170:171], v4 offset:4672
    ds_read_b64_tr_b16 a[12:13], v4 offset:6144
    ds_read_b64_tr_b16 a[14:15], v4 offset:6656
    ds_read_b64_tr_b16 a[172:173], v4 offset:6208
    ds_read_b64_tr_b16 a[174:175], v4 offset:6720
    s_waitcnt lgkmcnt(0)
    s_add_u32 m0, s33, 0
    s_add_u32 s64, s32, 1572864
    buffer_load_dwordx4 v3, s[12:15], s64 offen lds
    s_add_u32 m0, s33, 1024
    s_add_u32 s64, s32, 1638400
    buffer_load_dwordx4 v3, s[12:15], s64 offen lds
    s_add_u32 m0, s33, 2048
    s_add_u32 s64, s32, 1703936
    buffer_load_dwordx4 v3, s[12:15], s64 offen lds
    s_add_u32 m0, s33, 3072
    s_add_u32 s64, s32, 1769472
    buffer_load_dwordx4 v3, s[12:15], s64 offen lds
    s_add_u32 m0, s33, 4096
    s_add_u32 s64, s32, 1835008
    buffer_load_dwordx4 v3, s[12:15], s64 offen lds
    s_add_u32 m0, s33, 5120
    s_add_u32 s64, s32, 1900544
    buffer_load_dwordx4 v3, s[12:15], s64 offen lds
    s_add_u32 m0, s33, 6144
    s_add_u32 s64, s32, 1966080
    buffer_load_dwordx4 v3, s[12:15], s64 offen lds
    s_add_u32 m0, s33, 7168
    s_add_u32 s64, s32, 2031616
    buffer_load_dwordx4 v3, s[12:15], s64 offen lds
    ds_read_b64_tr_b16 a[16:17], v4 offset:8192
    ds_read_b64_tr_b16 a[18:19], v4 offset:8704
    ds_read_b64_tr_b16 a[176:177], v4 offset:8256
    ds_read_b64_tr_b16 a[178:179], v4 offset:8768
    ds_read_b64_tr_b16 a[20:21], v4 offset:10240
    ds_read_b64_tr_b16 a[22:23], v4 offset:10752
    ds_read_b64_tr_b16 a[180:181], v4 offset:10304
    ds_read_b64_tr_b16 a[182:183], v4 offset:10816
    s_waitcnt lgkmcnt(0)
    ds_read_b64_tr_b16 a[24:25], v4 offset:12288
    ds_read_b64_tr_b16 a[26:27], v4 offset:12800
    ds_read_b64_tr_b16 a[184:185], v4 offset:12352
    ds_read_b64_tr_b16 a[186:187], v4 offset:12864
    ds_read_b64_tr_b16 a[28:29], v4 offset:14336
    ds_read_b64_tr_b16 a[30:31], v4 offset:14848
    ds_read_b64_tr_b16 a[188:189], v4 offset:14400
    ds_read_b64_tr_b16 a[190:191], v4 offset:14912
    s_waitcnt lgkmcnt(0)
    s_add_u32 m0, s33, 8192
    s_add_u32 s64, s32, 2097152
    buffer_load_dwordx4 v3, s[12:15], s64 offen lds
    s_add_u32 m0, s33, 9216
    s_add_u32 s64, s32, 2162688
    buffer_load_dwordx4 v3, s[12:15], s64 offen lds
    s_add_u32 m0, s33, 10240
    s_add_u32 s64, s32, 2228224
    buffer_load_dwordx4 v3, s[12:15], s64 offen lds
    s_add_u32 m0, s33, 11264
    s_add_u32 s64, s32, 2293760
    buffer_load_dwordx4 v3, s[12:15], s64 offen lds
    s_add_u32 m0, s33, 12288
    s_add_u32 s64, s32, 2359296
    buffer_load_dwordx4 v3, s[12:15], s64 offen lds
    s_add_u32 m0, s33, 13312
    s_add_u32 s64, s32, 2424832
    buffer_load_dwordx4 v3, s[12:15], s64 offen lds
    s_add_u32 m0, s33, 14336
    s_add_u32 s64, s32, 2490368
    buffer_load_dwordx4 v3, s[12:15], s64 offen lds
    s_add_u32 m0, s33, 15360
    s_add_u32 s64, s32, 2555904
    buffer_load_dwordx4 v3, s[12:15], s64 offen lds
    ds_read_b64_tr_b16 a[32:33], v4 offset:16384
    ds_read_b64_tr_b16 a[34:35], v4 offset:16896
    ds_read_b64_tr_b16 a[192:193], v4 offset:16448
    ds_read_b64_tr_b16 a[194:195], v4 offset:16960
    ds_read_b64_tr_b16 a[36:37], v4 offset:18432
    ds_read_b64_tr_b16 a[38:39], v4 offset:18944
    ds_read_b64_tr_b16 a[196:197], v4 offset:18496
    ds_read_b64_tr_b16 a[198:199], v4 offset:19008
    s_waitcnt lgkmcnt(0)
    ds_read_b64_tr_b16 a[40:41], v4 offset:20480
    ds_read_b64_tr_b16 a[42:43], v4 offset:20992
    ds_read_b64_tr_b16 a[200:201], v4 offset:20544
    ds_read_b64_tr_b16 a[202:203], v4 offset:21056
    ds_read_b64_tr_b16 a[44:45], v4 offset:22528
    ds_read_b64_tr_b16 a[46:47], v4 offset:23040
    ds_read_b64_tr_b16 a[204:205], v4 offset:22592
    ds_read_b64_tr_b16 a[206:207], v4 offset:23104
    s_waitcnt lgkmcnt(0)
    s_add_u32 m0, s33, 16384
    s_add_u32 s64, s32, 2621440
    buffer_load_dwordx4 v3, s[12:15], s64 offen lds
    s_add_u32 m0, s33, 17408
    s_add_u32 s64, s32, 2686976
    buffer_load_dwordx4 v3, s[12:15], s64 offen lds
    s_add_u32 m0, s33, 18432
    s_add_u32 s64, s32, 2752512
    buffer_load_dwordx4 v3, s[12:15], s64 offen lds
    s_add_u32 m0, s33, 19456
    s_add_u32 s64, s32, 2818048
    buffer_load_dwordx4 v3, s[12:15], s64 offen lds
    s_add_u32 m0, s33, 20480
    s_add_u32 s64, s32, 2883584
    buffer_load_dwordx4 v3, s[12:15], s64 offen lds
    s_add_u32 m0, s33, 21504
    s_add_u32 s64, s32, 2949120
    buffer_load_dwordx4 v3, s[12:15], s64 offen lds
    s_add_u32 m0, s33, 22528
    s_add_u32 s64, s32, 3014656
    buffer_load_dwordx4 v3, s[12:15], s64 offen lds
    s_add_u32 m0, s33, 23552
    s_add_u32 s64, s32, 3080192
    buffer_load_dwordx4 v3, s[12:15], s64 offen lds
    s_waitcnt vmcnt(16)
    ds_read_b64_tr_b16 a[48:49], v4 offset:0
    ds_read_b64_tr_b16 a[50:51], v4 offset:512
    ds_read_b64_tr_b16 a[208:209], v4 offset:64
    ds_read_b64_tr_b16 a[210:211], v4 offset:576
    ds_read_b64_tr_b16 a[52:53], v4 offset:2048
    ds_read_b64_tr_b16 a[54:55], v4 offset:2560
    ds_read_b64_tr_b16 a[212:213], v4 offset:2112
    ds_read_b64_tr_b16 a[214:215], v4 offset:2624
    s_waitcnt lgkmcnt(0)
    ds_read_b64_tr_b16 a[56:57], v4 offset:4096
    ds_read_b64_tr_b16 a[58:59], v4 offset:4608
    ds_read_b64_tr_b16 a[216:217], v4 offset:4160
    ds_read_b64_tr_b16 a[218:219], v4 offset:4672
    ds_read_b64_tr_b16 a[60:61], v4 offset:6144
    ds_read_b64_tr_b16 a[62:63], v4 offset:6656
    ds_read_b64_tr_b16 a[220:221], v4 offset:6208
    ds_read_b64_tr_b16 a[222:223], v4 offset:6720
    s_waitcnt lgkmcnt(0)
    s_add_u32 m0, s33, 0
    s_add_u32 s64, s32, 3145728
    buffer_load_dwordx4 v3, s[12:15], s64 offen lds
    s_add_u32 m0, s33, 1024
    s_add_u32 s64, s32, 3211264
    buffer_load_dwordx4 v3, s[12:15], s64 offen lds
    s_add_u32 m0, s33, 2048
    s_add_u32 s64, s32, 3276800
    buffer_load_dwordx4 v3, s[12:15], s64 offen lds
    s_add_u32 m0, s33, 3072
    s_add_u32 s64, s32, 3342336
    buffer_load_dwordx4 v3, s[12:15], s64 offen lds
    s_add_u32 m0, s33, 4096
    s_add_u32 s64, s32, 3407872
    buffer_load_dwordx4 v3, s[12:15], s64 offen lds
    s_add_u32 m0, s33, 5120
    s_add_u32 s64, s32, 3473408
    buffer_load_dwordx4 v3, s[12:15], s64 offen lds
    s_add_u32 m0, s33, 6144
    s_add_u32 s64, s32, 3538944
    buffer_load_dwordx4 v3, s[12:15], s64 offen lds
    s_add_u32 m0, s33, 7168
    s_add_u32 s64, s32, 3604480
    buffer_load_dwordx4 v3, s[12:15], s64 offen lds
    v_and_b32 v30, 1, v7
    v_lshlrev_b32 v30, 6, v30
KV_cnt:
    buffer_load_dword v31, v30, s[92:95], 0 offen offset:64 sc1
    s_sub_u32 s40, s40, 1
    s_cbranch_scc1 M_fin
    s_waitcnt vmcnt(0)
    v_cmp_gt_u32 vcc, 0x60, v31
    s_cbranch_vccz KV_cnt_ok
    s_sleep 4
    s_branch KV_cnt
KV_cnt_ok:
    s_add_u32 s16, s8, 67108864
    s_addc_u32 s17, s9, 0
    s_mov_b32 s18, 2621440
    s_mov_b32 m0, s27
    s_nop 0
    buffer_load_dwordx4 v0, s[16:19], s23 offen offset:0 sc1 lds
    buffer_load_dwordx4 v0, s[16:19], s23 offen offset:1024 sc1 lds
    buffer_load_dwordx4 v0, s[16:19], s23 offen offset:2048 sc1 lds
    buffer_load_dwordx4 v0, s[16:19], s23 offen offset:3072 sc1 lds
    s_add_u32 s23, s23, 8192
    s_add_u32 s27, s27, 16384
    s_and_b32 s27, s27, 0xffff
    s_add_u32 s22, s22, 1
    s_cmp_lt_u32 s22, 5
    s_cbranch_scc1 KV_p0
    s_mov_b32 s22, 0
    s_add_u32 s23, s23, 450560
KV_p0:
    s_mov_b32 m0, s27
    s_nop 0
    buffer_load_dwordx4 v0, s[16:19], s23 offen offset:0 sc1 lds
    buffer_load_dwordx4 v0, s[16:19], s23 offen offset:1024 sc1 lds
    buffer_load_dwordx4 v0, s[16:19], s23 offen offset:2048 sc1 lds
    buffer_load_dwordx4 v0, s[16:19], s23 offen offset:3072 sc1 lds
    s_add_u32 s23, s23, 8192
    s_add_u32 s27, s27, 16384
    s_and_b32 s27, s27, 0xffff
    s_add_u32 s22, s22, 1
    s_cmp_lt_u32 s22, 5
    s_cbranch_scc1 KV_p1
    s_mov_b32 s22, 0
    s_add_u32 s23, s23, 450560
KV_p1:
    s_mov_b32 m0, s27
    s_nop 0
    buffer_load_dwordx4 v0, s[16:19], s23 offen offset:0 sc1 lds
    buffer_load_dwordx4 v0, s[16:19], s23 offen offset:1024 sc1 lds
    buffer_load_dwordx4 v0, s[16:19], s23 offen offset:2048 sc1 lds
    buffer_load_dwordx4 v0, s[16:19], s23 offen offset:3072 sc1 lds
    s_add_u32 s23, s23, 8192
    s_add_u32 s27, s27, 16384
    s_and_b32 s27, s27, 0xffff
    s_add_u32 s22, s22, 1
    s_cmp_lt_u32 s22, 5
    s_cbranch_scc1 KV_p2
    s_mov_b32 s22, 0
    s_add_u32 s23, s23, 450560
KV_p2:
    ds_read_b64_tr_b16 a[64:65], v4 offset:8192
    ds_read_b64_tr_b16 a[66:67], v4 offset:8704
    ds_read_b64_tr_b16 a[224:225], v4 offset:8256
    ds_read_b64_tr_b16 a[226:227], v4 offset:8768
    ds_read_b64_tr_b16 a[68:69], v4 offset:10240
    ds_read_b64_tr_b16 a[70:71], v4 offset:10752
    ds_read_b64_tr_b16 a[228:229], v4 offset:10304
    ds_read_b64_tr_b16 a[230:231], v4 offset:10816
    s_waitcnt lgkmcnt(0)
    ds_read_b64_tr_b16 a[72:73], v4 offset:12288
    ds_read_b64_tr_b16 a[74:75], v4 offset:12800
    ds_read_b64_tr_b16 a[232:233], v4 offset:12352
    ds_read_b64_tr_b16 a[234:235], v4 offset:12864
    ds_read_b64_tr_b16 a[76:77], v4 offset:14336
    ds_read_b64_tr_b16 a[78:79], v4 offset:14848
    ds_read_b64_tr_b16 a[236:237], v4 offset:14400
    ds_read_b64_tr_b16 a[238:239], v4 offset:14912
    s_waitcnt lgkmcnt(0)
    s_add_u32 m0, s33, 8192
    s_add_u32 s64, s32, 3670016
    buffer_load_dwordx4 v3, s[12:15], s64 offen lds
    s_add_u32 m0, s33, 9216
    s_add_u32 s64, s32, 3735552
    buffer_load_dwordx4 v3, s[12:15], s64 offen lds
    s_add_u32 m0, s33, 10240
    s_add_u32 s64, s32, 3801088
    buffer_load_dwordx4 v3, s[12:15], s64 offen lds
    s_add_u32 m0, s33, 11264
    s_add_u32 s64, s32, 3866624
    buffer_load_dwordx4 v3, s[12:15], s64 offen lds
    s_add_u32 m0, s33, 12288
    s_add_u32 s64, s32, 3932160
    buffer_load_dwordx4 v3, s[12:15], s64 offen lds
    s_add_u32 m0, s33, 13312
    s_add_u32 s64, s32, 3997696
    buffer_load_dwordx4 v3, s[12:15], s64 offen lds
    s_add_u32 m0, s33, 14336
    s_add_u32 s64, s32, 4063232
    buffer_load_dwordx4 v3, s[12:15], s64 offen lds
    s_add_u32 m0, s33, 15360
    s_add_u32 s64, s32, 4128768
    buffer_load_dwordx4 v3, s[12:15], s64 offen lds
    ds_read_b64_tr_b16 a[80:81], v4 offset:16384
    ds_read_b64_tr_b16 a[82:83], v4 offset:16896
    ds_read_b64_tr_b16 a[240:241], v4 offset:16448
    ds_read_b64_tr_b16 a[242:243], v4 offset:16960
    ds_read_b64_tr_b16 a[84:85], v4 offset:18432
    ds_read_b64_tr_b16 a[86:87], v4 offset:18944
    ds_read_b64_tr_b16 a[244:245], v4 offset:18496
    ds_read_b64_tr_b16 a[246:247], v4 offset:19008
    s_waitcnt lgkmcnt(0)
    ds_read_b64_tr_b16 a[88:89], v4 offset:20480
    ds_read_b64_tr_b16 a[90:91], v4 offset:20992
    ds_read_b64_tr_b16 a[248:249], v4 offset:20544
    ds_read_b64_tr_b16 a[250:251], v4 offset:21056
    ds_read_b64_tr_b16 a[92:93], v4 offset:22528
    ds_read_b64_tr_b16 a[94:95], v4 offset:23040
    ds_read_b64_tr_b16 a[252:253], v4 offset:22592
    ds_read_b64_tr_b16 a[254:255], v4 offset:23104
    s_waitcnt lgkmcnt(0)
    s_add_u32 m0, s33, 16384
    s_add_u32 s64, s32, 4194304
    buffer_load_dwordx4 v3, s[12:15], s64 offen lds
    s_add_u32 m0, s33, 17408
    s_add_u32 s64, s32, 4259840
    buffer_load_dwordx4 v3, s[12:15], s64 offen lds
    s_add_u32 m0, s33, 18432
    s_add_u32 s64, s32, 4325376
    buffer_load_dwordx4 v3, s[12:15], s64 offen lds
    s_add_u32 m0, s33, 19456
    s_add_u32 s64, s32, 4390912
    buffer_load_dwordx4 v3, s[12:15], s64 offen lds
    s_add_u32 m0, s33, 20480
    s_add_u32 s64, s32, 4456448
    buffer_load_dwordx4 v3, s[12:15], s64 offen lds
    s_add_u32 m0, s33, 21504
    s_add_u32 s64, s32, 4521984
    buffer_load_dwordx4 v3, s[12:15], s64 offen lds
    s_add_u32 m0, s33, 22528
    s_add_u32 s64, s32, 4587520
    buffer_load_dwordx4 v3, s[12:15], s64 offen lds
    s_add_u32 m0, s33, 23552
    s_add_u32 s64, s32, 4653056
    buffer_load_dwordx4 v3, s[12:15], s64 offen lds
    ds_read_b64_tr_b16 a[96:97], v4 offset:0
    ds_read_b64_tr_b16 a[98:99], v4 offset:512
    ds_read_b64_tr_b16 v[192:193], v4 offset:64
    ds_read_b64_tr_b16 v[194:195], v4 offset:576
    ds_read_b64_tr_b16 a[100:101], v4 offset:2048
    ds_read_b64_tr_b16 a[102:103], v4 offset:2560
    ds_read_b64_tr_b16 v[196:197], v4 offset:2112
    ds_read_b64_tr_b16 v[198:199], v4 offset:2624
    s_waitcnt lgkmcnt(0)
    ds_read_b64_tr_b16 a[104:105], v4 offset:4096
    ds_read_b64_tr_b16 a[106:107], v4 offset:4608
    ds_read_b64_tr_b16 v[200:201], v4 offset:4160
    ds_read_b64_tr_b16 v[202:203], v4 offset:4672
    ds_read_b64_tr_b16 a[108:109], v4 offset:6144
    ds_read_b64_tr_b16 a[110:111], v4 offset:6656
    ds_read_b64_tr_b16 v[204:205], v4 offset:6208
    ds_read_b64_tr_b16 v[206:207], v4 offset:6720
    s_waitcnt lgkmcnt(0)
    s_add_u32 m0, s33, 0
    s_add_u32 s64, s32, 4718592
    buffer_load_dwordx4 v3, s[12:15], s64 offen lds
    s_add_u32 m0, s33, 1024
    s_add_u32 s64, s32, 4784128
    buffer_load_dwordx4 v3, s[12:15], s64 offen lds
    s_add_u32 m0, s33, 2048
    s_add_u32 s64, s32, 4849664
    buffer_load_dwordx4 v3, s[12:15], s64 offen lds
    s_add_u32 m0, s33, 3072
    s_add_u32 s64, s32, 4915200
    buffer_load_dwordx4 v3, s[12:15], s64 offen lds
    s_add_u32 m0, s33, 4096
    s_add_u32 s64, s32, 4980736
    buffer_load_dwordx4 v3, s[12:15], s64 offen lds
    s_add_u32 m0, s33, 5120
    s_add_u32 s64, s32, 5046272
    buffer_load_dwordx4 v3, s[12:15], s64 offen lds
    s_add_u32 m0, s33, 6144
    s_add_u32 s64, s32, 5111808
    buffer_load_dwordx4 v3, s[12:15], s64 offen lds
    s_add_u32 m0, s33, 7168
    s_add_u32 s64, s32, 5177344
    buffer_load_dwordx4 v3, s[12:15], s64 offen lds
    s_waitcnt vmcnt(16)
    ds_read_b64_tr_b16 a[112:113], v4 offset:8192
    ds_read_b64_tr_b16 a[114:115], v4 offset:8704
    ds_read_b64_tr_b16 v[208:209], v4 offset:8256
    ds_read_b64_tr_b16 v[210:211], v4 offset:8768
    ds_read_b64_tr_b16 a[116:117], v4 offset:10240
    ds_read_b64_tr_b16 a[118:119], v4 offset:10752
    ds_read_b64_tr_b16 v[212:213], v4 offset:10304
    ds_read_b64_tr_b16 v[214:215], v4 offset:10816
    s_waitcnt lgkmcnt(0)
    ds_read_b64_tr_b16 a[120:121], v4 offset:12288
    ds_read_b64_tr_b16 a[122:123], v4 offset:12800
    ds_read_b64_tr_b16 v[216:217], v4 offset:12352
    ds_read_b64_tr_b16 v[218:219], v4 offset:12864
    ds_read_b64_tr_b16 a[124:125], v4 offset:14336
    ds_read_b64_tr_b16 a[126:127], v4 offset:14848
    ds_read_b64_tr_b16 v[220:221], v4 offset:14400
    ds_read_b64_tr_b16 v[222:223], v4 offset:14912
    s_waitcnt lgkmcnt(0)
    s_waitcnt vmcnt(8)
    ds_read_b64_tr_b16 a[128:129], v4 offset:16384
    ds_read_b64_tr_b16 a[130:131], v4 offset:16896
    ds_read_b64_tr_b16 v[224:225], v4 offset:16448
    ds_read_b64_tr_b16 v[226:227], v4 offset:16960
    ds_read_b64_tr_b16 a[132:133], v4 offset:18432
    ds_read_b64_tr_b16 a[134:135], v4 offset:18944
    ds_read_b64_tr_b16 v[228:229], v4 offset:18496
    ds_read_b64_tr_b16 v[230:231], v4 offset:19008
    s_waitcnt lgkmcnt(0)
    ds_read_b64_tr_b16 a[136:137], v4 offset:20480
    ds_read_b64_tr_b16 a[138:139], v4 offset:20992
    ds_read_b64_tr_b16 v[232:233], v4 offset:20544
    ds_read_b64_tr_b16 v[234:235], v4 offset:21056
    ds_read_b64_tr_b16 a[140:141], v4 offset:22528
    ds_read_b64_tr_b16 a[142:143], v4 offset:23040
    ds_read_b64_tr_b16 v[236:237], v4 offset:22592
    ds_read_b64_tr_b16 v[238:239], v4 offset:23104
    s_waitcnt lgkmcnt(0)
    s_waitcnt vmcnt(0)
    ds_read_b64_tr_b16 a[144:145], v4 offset:0
    ds_read_b64_tr_b16 a[146:147], v4 offset:512
    ds_read_b64_tr_b16 v[240:241], v4 offset:64
    ds_read_b64_tr_b16 v[242:243], v4 offset:576
    ds_read_b64_tr_b16 a[148:149], v4 offset:2048
    ds_read_b64_tr_b16 a[150:151], v4 offset:2560
    ds_read_b64_tr_b16 v[244:245], v4 offset:2112
    ds_read_b64_tr_b16 v[246:247], v4 offset:2624
    s_waitcnt lgkmcnt(0)
    ds_read_b64_tr_b16 a[152:153], v4 offset:4096
    ds_read_b64_tr_b16 a[154:155], v4 offset:4608
    ds_read_b64_tr_b16 v[248:249], v4 offset:4160
    ds_read_b64_tr_b16 v[250:251], v4 offset:4672
    ds_read_b64_tr_b16 a[156:157], v4 offset:6144
    ds_read_b64_tr_b16 a[158:159], v4 offset:6656
    ds_read_b64_tr_b16 v[252:253], v4 offset:6208
    ds_read_b64_tr_b16 v[254:255], v4 offset:6720
    s_waitcnt lgkmcnt(0)
    v_mov_b32 v1, v0
    s_and_b32 s64, s26, 15
    s_lshl_b32 s64, s64, 15
    s_lshr_b32 s65, s4, 1
    s_lshl_b32 s65, s65, 14
    s_add_u32 s64, s64, s65
    s_and_b32 s65, s4, 1
    s_lshl_b32 s65, s65, 12
    s_add_u32 s64, s64, s65
    s_lshr_b32 s65, s26, 4
    s_lshl_b32 s65, s65, 13
    s_add_u32 s34, s64, s65
    s_lshl_b32 s35, s26, 7
    s_add_u32 s35, s35, 109064192
    s_waitcnt vmcnt(0)
    s_barrier
    ds_read_b128 v[8:11], v1 offset:0
    ds_read_b128 v[12:15], v1 offset:8192
    s_cmp_ge_u32 s26, 16
    s_cbranch_scc1 KV_loopV
KV_loopT:
    s_waitcnt lgkmcnt(1)
    v_mfma_f32_32x32x16_bf16 v[32:47], a[0:3], v[8:11], 0
    ds_read_b128 v[16:19], v1 offset:1024
    s_mov_b32 m0, s27
    s_nop 0
    buffer_load_dwordx4 v0, s[16:19], s23 offen offset:0 sc1 lds
    v_mfma_f32_32x32x16_bf16 v[48:63], a[160:163], v[8:11], 0
    ds_read_b128 v[20:23], v1 offset:9216
    buffer_load_dwordx4 v0, s[16:19], s23 offen offset:1024 sc1 lds
    s_waitcnt lgkmcnt(2)
    v_mfma_f32_32x32x16_bf16 v[64:79], a[0:3], v[12:15], 0
    buffer_load_dwordx4 v0, s[16:19], s23 offen offset:2048 sc1 lds
    v_mfma_f32_32x32x16_bf16 v[80:95], a[160:163], v[12:15], 0
    buffer_load_dwordx4 v0, s[16:19], s23 offen offset:3072 sc1 lds
    s_waitcnt lgkmcnt(1)
    v_mfma_f32_32x32x16_bf16 v[32:47], a[4:7], v[16:19], v[32:47]
    ds_read_b128 v[8:11], v1 offset:2048
    s_add_u32 s23, s23, 8192
    s_add_u32 s27, s27, 16384
    s_and_b32 s27, s27, 0xffff
    s_add_u32 s22, s22, 1
    s_cmp_lt_u32 s22, 5
    s_cbranch_scc1 KV_T_a0
    s_mov_b32 s22, 0
    s_add_u32 s23, s23, 450560
KV_T_a0:
    v_mfma_f32_32x32x16_bf16 v[48:63], a[164:167], v[16:19], v[48:63]
    ds_read_b128 v[12:15], v1 offset:10240
    s_waitcnt lgkmcnt(2)
    v_mfma_f32_32x32x16_bf16 v[64:79], a[4:7], v[20:23], v[64:79]
    v_mfma_f32_32x32x16_bf16 v[80:95], a[164:167], v[20:23], v[80:95]
    s_waitcnt lgkmcnt(1)
    v_mfma_f32_32x32x16_bf16 v[32:47], a[8:11], v[8:11], v[32:47]
    ds_read_b128 v[16:19], v1 offset:3072
    v_mfma_f32_32x32x16_bf16 v[48:63], a[168:171], v[8:11], v[48:63]
    ds_read_b128 v[20:23], v1 offset:11264
    s_waitcnt lgkmcnt(2)
    v_mfma_f32_32x32x16_bf16 v[64:79], a[8:11], v[12:15], v[64:79]
    v_mfma_f32_32x32x16_bf16 v[80:95], a[168:171], v[12:15], v[80:95]
    s_waitcnt lgkmcnt(1)
    v_mfma_f32_32x32x16_bf16 v[32:47], a[12:15], v[16:19], v[32:47]
    ds_read_b128 v[8:11], v1 offset:4096
    v_mfma_f32_32x32x16_bf16 v[48:63], a[172:175], v[16:19], v[48:63]
    ds_read_b128 v[12:15], v1 offset:12288
    s_waitcnt lgkmcnt(2)
    v_mfma_f32_32x32x16_bf16 v[64:79], a[12:15], v[20:23], v[64:79]
    v_mfma_f32_32x32x16_bf16 v[80:95], a[172:175], v[20:23], v[80:95]
    s_waitcnt lgkmcnt(1)
    v_mfma_f32_32x32x16_bf16 v[32:47], a[16:19], v[8:11], v[32:47]
    ds_read_b128 v[16:19], v1 offset:5120
    v_mfma_f32_32x32x16_bf16 v[48:63], a[176:179], v[8:11], v[48:63]
    ds_read_b128 v[20:23], v1 offset:13312
    s_waitcnt lgkmcnt(2)
    v_mfma_f32_32x32x16_bf16 v[64:79], a[16:19], v[12:15], v[64:79]
    v_mfma_f32_32x32x16_bf16 v[80:95], a[176:179], v[12:15], v[80:95]
    s_waitcnt lgkmcnt(1)
    v_mfma_f32_32x32x16_bf16 v[32:47], a[20:23], v[16:19], v[32:47]
    ds_read_b128 v[8:11], v1 offset:6144
    v_mfma_f32_32x32x16_bf16 v[48:63], a[180:183], v[16:19], v[48:63]
    ds_read_b128 v[12:15], v1 offset:14336
    s_waitcnt lgkmcnt(2)
    v_mfma_f32_32x32x16_bf16 v[64:79], a[20:23], v[20:23], v[64:79]
    v_mfma_f32_32x32x16_bf16 v[80:95], a[180:183], v[20:23], v[80:95]
    s_waitcnt lgkmcnt(1)
    v_mfma_f32_32x32x16_bf16 v[32:47], a[24:27], v[8:11], v[32:47]
    ds_read_b128 v[16:19], v1 offset:7168
    v_mfma_f32_32x32x16_bf16 v[48:63], a[184:187], v[8:11], v[48:63]
    ds_read_b128 v[20:23], v1 offset:15360
    s_waitcnt lgkmcnt(2)
    v_mfma_f32_32x32x16_bf16 v[64:79], a[24:27], v[12:15], v[64:79]
    v_mfma_f32_32x32x16_bf16 v[80:95], a[184:187], v[12:15], v[80:95]
    s_waitcnt lgkmcnt(1)
    v_mfma_f32_32x32x16_bf16 v[32:47], a[28:31], v[16:19], v[32:47]
    s_waitcnt vmcnt(8) lgkmcnt(0)
    v_add_u32 v1, 0x4000, v1
    s_barrier
    v_and_b32 v1, 0xffff, v1
    ds_read_b128 v[8:11], v1 offset:0
    v_mfma_f32_32x32x16_bf16 v[48:63], a[188:191], v[16:19], v[48:63]
    ds_read_b128 v[12:15], v1 offset:8192
    v_mfma_f32_32x32x16_bf16 v[64:79], a[28:31], v[20:23], v[64:79]
    v_mfma_f32_32x32x16_bf16 v[80:95], a[188:191], v[20:23], v[80:95]
    s_waitcnt lgkmcnt(1)
    v_mfma_f32_32x32x16_bf16 v[32:47], a[32:35], v[8:11], v[32:47]
    ds_read_b128 v[16:19], v1 offset:1024
    s_mov_b32 m0, s27
    s_nop 0
    buffer_load_dwordx4 v0, s[16:19], s23 offen offset:0 sc1 lds
    v_mfma_f32_32x32x16_bf16 v[48:63], a[192:195], v[8:11], v[48:63]
    ds_read_b128 v[20:23], v1 offset:9216
    buffer_load_dwordx4 v0, s[16:19], s23 offen offset:1024 sc1 lds
    s_waitcnt lgkmcnt(2)
    v_mfma_f32_32x32x16_bf16 v[64:79], a[32:35], v[12:15], v[64:79]
    buffer_load_dwordx4 v0, s[16:19], s23 offen offset:2048 sc1 lds
    v_mfma_f32_32x32x16_bf16 v[80:95], a[192:195], v[12:15], v[80:95]
    buffer_load_dwordx4 v0, s[16:19], s23 offen offset:3072 sc1 lds
    s_waitcnt lgkmcnt(1)
    v_mfma_f32_32x32x16_bf16 v[32:47], a[36:39], v[16:19], v[32:47]
    ds_read_b128 v[8:11], v1 offset:2048
    s_add_u32 s23, s23, 8192
    s_add_u32 s27, s27, 16384
    s_and_b32 s27, s27, 0xffff
    s_add_u32 s22, s22, 1
    s_cmp_lt_u32 s22, 5
    s_cbranch_scc1 KV_T_a1
    s_mov_b32 s22, 0
    s_add_u32 s23, s23, 450560
KV_T_a1:
    v_mfma_f32_32x32x16_bf16 v[48:63], a[196:199], v[16:19], v[48:63]
    ds_read_b128 v[12:15], v1 offset:10240
    s_waitcnt lgkmcnt(2)
    v_mfma_f32_32x32x16_bf16 v[64:79], a[36:39], v[20:23], v[64:79]
    v_mfma_f32_32x32x16_bf16 v[80:95], a[196:199], v[20:23], v[80:95]
    s_waitcnt lgkmcnt(1)
    v_mfma_f32_32x32x16_bf16 v[32:47], a[40:43], v[8:11], v[32:47]
    ds_read_b128 v[16:19], v1 offset:3072
    v_mfma_f32_32x32x16_bf16 v[48:63], a[200:203], v[8:11], v[48:63]
    ds_read_b128 v[20:23], v1 offset:11264
    s_waitcnt lgkmcnt(2)
    v_mfma_f32_32x32x16_bf16 v[64:79], a[40:43], v[12:15], v[64:79]
    v_mfma_f32_32x32x16_bf16 v[80:95], a[200:203], v[12:15], v[80:95]
    s_waitcnt lgkmcnt(1)
    v_mfma_f32_32x32x16_bf16 v[32:47], a[44:47], v[16:19], v[32:47]
    ds_read_b128 v[8:11], v1 offset:4096
    v_mfma_f32_32x32x16_bf16 v[48:63], a[204:207], v[16:19], v[48:63]
    ds_read_b128 v[12:15], v1 offset:12288
    s_waitcnt lgkmcnt(2)
    v_mfma_f32_32x32x16_bf16 v[64:79], a[44:47], v[20:23], v[64:79]
    v_mfma_f32_32x32x16_bf16 v[80:95], a[204:207], v[20:23], v[80:95]
    s_waitcnt lgkmcnt(1)
    v_mfma_f32_32x32x16_bf16 v[32:47], a[48:51], v[8:11], v[32:47]
    ds_read_b128 v[16:19], v1 offset:5120
    v_mfma_f32_32x32x16_bf16 v[48:63], a[208:211], v[8:11], v[48:63]
    ds_read_b128 v[20:23], v1 offset:13312
    s_waitcnt lgkmcnt(2)
    v_mfma_f32_32x32x16_bf16 v[64:79], a[48:51], v[12:15], v[64:79]
    v_mfma_f32_32x32x16_bf16 v[80:95], a[208:211], v[12:15], v[80:95]
    s_waitcnt lgkmcnt(1)
    v_mfma_f32_32x32x16_bf16 v[32:47], a[52:55], v[16:19], v[32:47]
    ds_read_b128 v[8:11], v1 offset:6144
    v_mfma_f32_32x32x16_bf16 v[48:63], a[212:215], v[16:19], v[48:63]
    ds_read_b128 v[12:15], v1 offset:14336
    s_waitcnt lgkmcnt(2)
    v_mfma_f32_32x32x16_bf16 v[64:79], a[52:55], v[20:23], v[64:79]
    v_mfma_f32_32x32x16_bf16 v[80:95], a[212:215], v[20:23], v[80:95]
    s_waitcnt lgkmcnt(1)
    v_mfma_f32_32x32x16_bf16 v[32:47], a[56:59], v[8:11], v[32:47]
    ds_read_b128 v[16:19], v1 offset:7168
    v_mfma_f32_32x32x16_bf16 v[48:63], a[216:219], v[8:11], v[48:63]
    ds_read_b128 v[20:23], v1 offset:15360
    s_waitcnt lgkmcnt(2)
    v_mfma_f32_32x32x16_bf16 v[64:79], a[56:59], v[12:15], v[64:79]
    v_mfma_f32_32x32x16_bf16 v[80:95], a[216:219], v[12:15], v[80:95]
    s_waitcnt lgkmcnt(1)
    v_mfma_f32_32x32x16_bf16 v[32:47], a[60:63], v[16:19], v[32:47]
    s_waitcnt vmcnt(8) lgkmcnt(0)
    v_add_u32 v1, 0x4000, v1
    s_barrier
    v_and_b32 v1, 0xffff, v1
    ds_read_b128 v[8:11], v1 offset:0
    v_mfma_f32_32x32x16_bf16 v[48:63], a[220:223], v[16:19], v[48:63]
    ds_read_b128 v[12:15], v1 offset:8192
    v_mfma_f32_32x32x16_bf16 v[64:79], a[60:63], v[20:23], v[64:79]
    v_mfma_f32_32x32x16_bf16 v[80:95], a[220:223], v[20:23], v[80:95]
    s_waitcnt lgkmcnt(1)
    v_mfma_f32_32x32x16_bf16 v[32:47], a[64:67], v[8:11], v[32:47]
    ds_read_b128 v[16:19], v1 offset:1024
    s_mov_b32 m0, s27
    s_nop 0
    buffer_load_dwordx4 v0, s[16:19], s23 offen offset:0 sc1 lds
    v_mfma_f32_32x32x16_bf16 v[48:63], a[224:227], v[8:11], v[48:63]
    ds_read_b128 v[20:23], v1 offset:9216
    buffer_load_dwordx4 v0, s[16:19], s23 offen offset:1024 sc1 lds
    s_waitcnt lgkmcnt(2)
    v_mfma_f32_32x32x16_bf16 v[64:79], a[64:67], v[12:15], v[64:79]
    buffer_load_dwordx4 v0, s[16:19], s23 offen offset:2048 sc1 lds
    v_mfma_f32_32x32x16_bf16 v[80:95], a[224:227], v[12:15], v[80:95]
    buffer_load_dwordx4 v0, s[16:19], s23 offen offset:3072 sc1 lds
    s_waitcnt lgkmcnt(1)
    v_mfma_f32_32x32x16_bf16 v[32:47], a[68:71], v[16:19], v[32:47]
    ds_read_b128 v[8:11], v1 offset:2048
    s_add_u32 s23, s23, 8192
    s_add_u32 s27, s27, 16384
    s_and_b32 s27, s27, 0xffff
    s_add_u32 s22, s22, 1
    s_cmp_lt_u32 s22, 5
    s_cbranch_scc1 KV_T_a2
    s_mov_b32 s22, 0
    s_add_u32 s23, s23, 450560
KV_T_a2:
    s_cmp_eq_u32 s29, 0
    s_cbranch_scc1 KV_T_np
    v_mov_b32 v5, 1
    s_mov_b64 exec, 1
    buffer_store_dword v5, off, s[8:11], s29 sc1
    s_mov_b64 exec, -1
KV_T_np:
    v_mfma_f32_32x32x16_bf16 v[48:63], a[228:231], v[16:19], v[48:63]
    ds_read_b128 v[12:15], v1 offset:10240
    s_waitcnt lgkmcnt(2)
    v_mfma_f32_32x32x16_bf16 v[64:79], a[68:71], v[20:23], v[64:79]
    v_mfma_f32_32x32x16_bf16 v[80:95], a[228:231], v[20:23], v[80:95]
    s_waitcnt lgkmcnt(1)
    v_mfma_f32_32x32x16_bf16 v[32:47], a[72:75], v[8:11], v[32:47]
    ds_read_b128 v[16:19], v1 offset:3072
    v_mfma_f32_32x32x16_bf16 v[48:63], a[232:235], v[8:11], v[48:63]
    ds_read_b128 v[20:23], v1 offset:11264
    s_waitcnt lgkmcnt(2)
    v_mfma_f32_32x32x16_bf16 v[64:79], a[72:75], v[12:15], v[64:79]
    v_mfma_f32_32x32x16_bf16 v[80:95], a[232:235], v[12:15], v[80:95]
    s_waitcnt lgkmcnt(1)
    v_mfma_f32_32x32x16_bf16 v[32:47], a[76:79], v[16:19], v[32:47]
    ds_read_b128 v[8:11], v1 offset:4096
    v_mfma_f32_32x32x16_bf16 v[48:63], a[236:239], v[16:19], v[48:63]
    ds_read_b128 v[12:15], v1 offset:12288
    s_waitcnt lgkmcnt(2)
    v_mfma_f32_32x32x16_bf16 v[64:79], a[76:79], v[20:23], v[64:79]
    v_mfma_f32_32x32x16_bf16 v[80:95], a[236:239], v[20:23], v[80:95]
    s_waitcnt lgkmcnt(1)
    v_mfma_f32_32x32x16_bf16 v[32:47], a[80:83], v[8:11], v[32:47]
    ds_read_b128 v[16:19], v1 offset:5120
    v_mfma_f32_32x32x16_bf16 v[48:63], a[240:243], v[8:11], v[48:63]
    ds_read_b128 v[20:23], v1 offset:13312
    s_waitcnt lgkmcnt(2)
    v_mfma_f32_32x32x16_bf16 v[64:79], a[80:83], v[12:15], v[64:79]
    v_mfma_f32_32x32x16_bf16 v[80:95], a[240:243], v[12:15], v[80:95]
    s_waitcnt lgkmcnt(1)
    v_mfma_f32_32x32x16_bf16 v[32:47], a[84:87], v[16:19], v[32:47]
    ds_read_b128 v[8:11], v1 offset:6144
    v_mfma_f32_32x32x16_bf16 v[48:63], a[244:247], v[16:19], v[48:63]
    ds_read_b128 v[12:15], v1 offset:14336
    s_waitcnt lgkmcnt(2)
    v_mfma_f32_32x32x16_bf16 v[64:79], a[84:87], v[20:23], v[64:79]
    v_mfma_f32_32x32x16_bf16 v[80:95], a[244:247], v[20:23], v[80:95]
    s_waitcnt lgkmcnt(1)
    v_mfma_f32_32x32x16_bf16 v[32:47], a[88:91], v[8:11], v[32:47]
    ds_read_b128 v[16:19], v1 offset:7168
    v_mfma_f32_32x32x16_bf16 v[48:63], a[248:251], v[8:11], v[48:63]
    ds_read_b128 v[20:23], v1 offset:15360
    s_waitcnt lgkmcnt(2)
    v_mfma_f32_32x32x16_bf16 v[64:79], a[88:91], v[12:15], v[64:79]
    v_mfma_f32_32x32x16_bf16 v[80:95], a[248:251], v[12:15], v[80:95]
    s_waitcnt lgkmcnt(1)
    v_mfma_f32_32x32x16_bf16 v[32:47], a[92:95], v[16:19], v[32:47]
    s_waitcnt vmcnt(8) lgkmcnt(0)
    v_add_u32 v1, 0x4000, v1
    s_barrier
    v_and_b32 v1, 0xffff, v1
    ds_read_b128 v[8:11], v1 offset:0
    v_mfma_f32_32x32x16_bf16 v[48:63], a[252:255], v[16:19], v[48:63]
    ds_read_b128 v[12:15], v1 offset:8192
    v_mfma_f32_32x32x16_bf16 v[64:79], a[92:95], v[20:23], v[64:79]
    v_mfma_f32_32x32x16_bf16 v[80:95], a[252:255], v[20:23], v[80:95]
    s_waitcnt lgkmcnt(1)
    v_mfma_f32_32x32x16_bf16 v[32:47], a[96:99], v[8:11], v[32:47]
    ds_read_b128 v[16:19], v1 offset:1024
    s_mov_b32 m0, s27
    s_nop 0
    buffer_load_dwordx4 v0, s[16:19], s23 offen offset:0 sc1 lds
    v_mfma_f32_32x32x16_bf16 v[48:63], v[192:195], v[8:11], v[48:63]
    ds_read_b128 v[20:23], v1 offset:9216
    buffer_load_dwordx4 v0, s[16:19], s23 offen offset:1024 sc1 lds
    s_waitcnt lgkmcnt(2)
    v_mfma_f32_32x32x16_bf16 v[64:79], a[96:99], v[12:15], v[64:79]
    buffer_load_dwordx4 v0, s[16:19], s23 offen offset:2048 sc1 lds
    v_mfma_f32_32x32x16_bf16 v[80:95], v[192:195], v[12:15], v[80:95]
    buffer_load_dwordx4 v0, s[16:19], s23 offen offset:3072 sc1 lds
    s_waitcnt lgkmcnt(1)
    v_mfma_f32_32x32x16_bf16 v[32:47], a[100:103], v[16:19], v[32:47]
    ds_read_b128 v[8:11], v1 offset:2048
    s_add_u32 s23, s23, 8192
    s_add_u32 s27, s27, 16384
    s_and_b32 s27, s27, 0xffff
    s_add_u32 s22, s22, 1
    s_cmp_lt_u32 s22, 5
    s_cbranch_scc1 KV_T_a3
    s_mov_b32 s22, 0
    s_add_u32 s23, s23, 450560
KV_T_a3:
    v_mfma_f32_32x32x16_bf16 v[48:63], v[196:199], v[16:19], v[48:63]
    ds_read_b128 v[12:15], v1 offset:10240
    s_waitcnt lgkmcnt(2)
    v_mfma_f32_32x32x16_bf16 v[64:79], a[100:103], v[20:23], v[64:79]
    v_mfma_f32_32x32x16_bf16 v[80:95], v[196:199], v[20:23], v[80:95]
    s_waitcnt lgkmcnt(1)
    v_mfma_f32_32x32x16_bf16 v[32:47], a[104:107], v[8:11], v[32:47]
    ds_read_b128 v[16:19], v1 offset:3072
    v_mfma_f32_32x32x16_bf16 v[48:63], v[200:203], v[8:11], v[48:63]
    ds_read_b128 v[20:23], v1 offset:11264
    s_waitcnt lgkmcnt(2)
    v_mfma_f32_32x32x16_bf16 v[64:79], a[104:107], v[12:15], v[64:79]
    v_mfma_f32_32x32x16_bf16 v[80:95], v[200:203], v[12:15], v[80:95]
    s_waitcnt lgkmcnt(1)
    v_mfma_f32_32x32x16_bf16 v[32:47], a[108:111], v[16:19], v[32:47]
    ds_read_b128 v[8:11], v1 offset:4096
    v_mfma_f32_32x32x16_bf16 v[48:63], v[204:207], v[16:19], v[48:63]
    ds_read_b128 v[12:15], v1 offset:12288
    s_waitcnt lgkmcnt(2)
    v_mfma_f32_32x32x16_bf16 v[64:79], a[108:111], v[20:23], v[64:79]
    v_mfma_f32_32x32x16_bf16 v[80:95], v[204:207], v[20:23], v[80:95]
    s_waitcnt lgkmcnt(1)
    v_mfma_f32_32x32x16_bf16 v[32:47], a[112:115], v[8:11], v[32:47]
    ds_read_b128 v[16:19], v1 offset:5120
    v_mfma_f32_32x32x16_bf16 v[48:63], v[208:211], v[8:11], v[48:63]
    ds_read_b128 v[20:23], v1 offset:13312
    s_waitcnt lgkmcnt(2)
    v_mfma_f32_32x32x16_bf16 v[64:79], a[112:115], v[12:15], v[64:79]
    v_mfma_f32_32x32x16_bf16 v[80:95], v[208:211], v[12:15], v[80:95]
    s_waitcnt lgkmcnt(1)
    v_mfma_f32_32x32x16_bf16 v[32:47], a[116:119], v[16:19], v[32:47]
    ds_read_b128 v[8:11], v1 offset:6144
    v_mfma_f32_32x32x16_bf16 v[48:63], v[212:215], v[16:19], v[48:63]
    ds_read_b128 v[12:15], v1 offset:14336
    s_waitcnt lgkmcnt(2)
    v_mfma_f32_32x32x16_bf16 v[64:79], a[116:119], v[20:23], v[64:79]
    v_mfma_f32_32x32x16_bf16 v[80:95], v[212:215], v[20:23], v[80:95]
    s_waitcnt lgkmcnt(1)
    v_mfma_f32_32x32x16_bf16 v[32:47], a[120:123], v[8:11], v[32:47]
    ds_read_b128 v[16:19], v1 offset:7168
    v_mfma_f32_32x32x16_bf16 v[48:63], v[216:219], v[8:11], v[48:63]
    ds_read_b128 v[20:23], v1 offset:15360
    s_waitcnt lgkmcnt(2)
    v_mfma_f32_32x32x16_bf16 v[64:79], a[120:123], v[12:15], v[64:79]
    v_mfma_f32_32x32x16_bf16 v[80:95], v[216:219], v[12:15], v[80:95]
    s_waitcnt lgkmcnt(1)
    v_mfma_f32_32x32x16_bf16 v[32:47], a[124:127], v[16:19], v[32:47]
    s_waitcnt vmcnt(8) lgkmcnt(0)
    v_add_u32 v1, 0x4000, v1
    s_barrier
    v_and_b32 v1, 0xffff, v1
    ds_read_b128 v[8:11], v1 offset:0
    v_mfma_f32_32x32x16_bf16 v[48:63], v[220:223], v[16:19], v[48:63]
    ds_read_b128 v[12:15], v1 offset:8192
    v_mfma_f32_32x32x16_bf16 v[64:79], a[124:127], v[20:23], v[64:79]
    v_mfma_f32_32x32x16_bf16 v[80:95], v[220:223], v[20:23], v[80:95]
    s_waitcnt lgkmcnt(1)
    v_mfma_f32_32x32x16_bf16 v[32:47], a[128:131], v[8:11], v[32:47]
    ds_read_b128 v[16:19], v1 offset:1024
    s_mov_b32 m0, s27
    s_nop 0
    buffer_load_dwordx4 v0, s[16:19], s23 offen offset:0 sc1 lds
    v_mfma_f32_32x32x16_bf16 v[48:63], v[224:227], v[8:11], v[48:63]
    ds_read_b128 v[20:23], v1 offset:9216
    buffer_load_dwordx4 v0, s[16:19], s23 offen offset:1024 sc1 lds
    s_waitcnt lgkmcnt(2)
    v_mfma_f32_32x32x16_bf16 v[64:79], a[128:131], v[12:15], v[64:79]
    buffer_load_dwordx4 v0, s[16:19], s23 offen offset:2048 sc1 lds
    v_mfma_f32_32x32x16_bf16 v[80:95], v[224:227], v[12:15], v[80:95]
    buffer_load_dwordx4 v0, s[16:19], s23 offen offset:3072 sc1 lds
    s_waitcnt lgkmcnt(1)
    v_mfma_f32_32x32x16_bf16 v[32:47], a[132:135], v[16:19], v[32:47]
    ds_read_b128 v[8:11], v1 offset:2048
    s_add_u32 s23, s23, 8192
    s_add_u32 s27, s27, 16384
    s_and_b32 s27, s27, 0xffff
    s_add_u32 s22, s22, 1
    s_cmp_lt_u32 s22, 5
    s_cbranch_scc1 KV_T_a4
    s_mov_b32 s22, 0
    s_add_u32 s23, s23, 450560
KV_T_a4:
    v_mfma_f32_32x32x16_bf16 v[48:63], v[228:231], v[16:19], v[48:63]
    ds_read_b128 v[12:15], v1 offset:10240
    s_waitcnt lgkmcnt(2)
    v_mfma_f32_32x32x16_bf16 v[64:79], a[132:135], v[20:23], v[64:79]
    v_mfma_f32_32x32x16_bf16 v[80:95], v[228:231], v[20:23], v[80:95]
    s_waitcnt lgkmcnt(1)
    v_mfma_f32_32x32x16_bf16 v[32:47], a[136:139], v[8:11], v[32:47]
    ds_read_b128 v[16:19], v1 offset:3072
    v_mfma_f32_32x32x16_bf16 v[48:63], v[232:235], v[8:11], v[48:63]
    ds_read_b128 v[20:23], v1 offset:11264
    s_waitcnt lgkmcnt(2)
    v_mfma_f32_32x32x16_bf16 v[64:79], a[136:139], v[12:15], v[64:79]
    v_mfma_f32_32x32x16_bf16 v[80:95], v[232:235], v[12:15], v[80:95]
    s_waitcnt lgkmcnt(1)
    v_mfma_f32_32x32x16_bf16 v[32:47], a[140:143], v[16:19], v[32:47]
    ds_read_b128 v[8:11], v1 offset:4096
    v_mfma_f32_32x32x16_bf16 v[48:63], v[236:239], v[16:19], v[48:63]
    ds_read_b128 v[12:15], v1 offset:12288
    s_waitcnt lgkmcnt(2)
    v_mfma_f32_32x32x16_bf16 v[64:79], a[140:143], v[20:23], v[64:79]
    v_mfma_f32_32x32x16_bf16 v[80:95], v[236:239], v[20:23], v[80:95]
    s_waitcnt lgkmcnt(1)
    v_mfma_f32_32x32x16_bf16 v[32:47], a[144:147], v[8:11], v[32:47]
    ds_read_b128 v[16:19], v1 offset:5120
    v_mfma_f32_32x32x16_bf16 v[48:63], v[240:243], v[8:11], v[48:63]
    ds_read_b128 v[20:23], v1 offset:13312
    s_waitcnt lgkmcnt(2)
    v_mfma_f32_32x32x16_bf16 v[64:79], a[144:147], v[12:15], v[64:79]
    v_mfma_f32_32x32x16_bf16 v[80:95], v[240:243], v[12:15], v[80:95]
    s_waitcnt lgkmcnt(1)
    v_mfma_f32_32x32x16_bf16 v[32:47], a[148:151], v[16:19], v[32:47]
    ds_read_b128 v[8:11], v1 offset:6144
    v_mfma_f32_32x32x16_bf16 v[48:63], v[244:247], v[16:19], v[48:63]
    ds_read_b128 v[12:15], v1 offset:14336
    s_waitcnt lgkmcnt(2)
    v_mfma_f32_32x32x16_bf16 v[64:79], a[148:151], v[20:23], v[64:79]
    v_mfma_f32_32x32x16_bf16 v[80:95], v[244:247], v[20:23], v[80:95]
    s_waitcnt lgkmcnt(1)
    v_mfma_f32_32x32x16_bf16 v[32:47], a[152:155], v[8:11], v[32:47]
    ds_read_b128 v[16:19], v1 offset:7168
    v_mfma_f32_32x32x16_bf16 v[48:63], v[248:251], v[8:11], v[48:63]
    ds_read_b128 v[20:23], v1 offset:15360
    s_waitcnt lgkmcnt(2)
    v_mfma_f32_32x32x16_bf16 v[64:79], a[152:155], v[12:15], v[64:79]
    v_mfma_f32_32x32x16_bf16 v[80:95], v[248:251], v[12:15], v[80:95]
    s_waitcnt lgkmcnt(1)
    v_mfma_f32_32x32x16_bf16 v[32:47], a[156:159], v[16:19], v[32:47]
    s_waitcnt vmcnt(8) lgkmcnt(0)
    v_add_u32 v1, 0x4000, v1
    s_barrier
    v_and_b32 v1, 0xffff, v1
    ds_read_b128 v[8:11], v1 offset:0
    v_mfma_f32_32x32x16_bf16 v[48:63], v[252:255], v[16:19], v[48:63]
    ds_read_b128 v[12:15], v1 offset:8192
    v_mfma_f32_32x32x16_bf16 v[64:79], a[156:159], v[20:23], v[64:79]
    v_mfma_f32_32x32x16_bf16 v[80:95], v[252:255], v[20:23], v[80:95]
    s_lshl_b32 s28, s20, 20
    s_add_u32 s28, s28, s34
    s_mov_b32 s65, 0x80000
    s_lshl_b32 s29, s20, 2
    s_add_u32 s29, s29, s35
    s_cmp_eq_u32 s4, 0
    s_cselect_b32 s29, s29, 0
    s_nop 4
    v_cvt_pk_bf16_f32 v96, v32, v33
    v_cvt_pk_bf16_f32 v97, v34, v35
    v_cvt_pk_bf16_f32 v98, v36, v37
    v_cvt_pk_bf16_f32 v99, v38, v39
    v_cvt_pk_bf16_f32 v100, v40, v41
    v_cvt_pk_bf16_f32 v101, v42, v43
    v_cvt_pk_bf16_f32 v102, v44, v45
    v_cvt_pk_bf16_f32 v103, v46, v47
    buffer_store_dwordx4 v[96:99], v0, s[8:11], s28 offen offset:0 sc1
    buffer_store_dwordx4 v[100:103], v0, s[8:11], s28 offen offset:1024 sc1
    v_cvt_pk_bf16_f32 v104, v48, v49
    v_cvt_pk_bf16_f32 v105, v50, v51
    v_cvt_pk_bf16_f32 v106, v52, v53
    v_cvt_pk_bf16_f32 v107, v54, v55
    v_cvt_pk_bf16_f32 v108, v56, v57
    v_cvt_pk_bf16_f32 v109, v58, v59
    v_cvt_pk_bf16_f32 v110, v60, v61
    v_cvt_pk_bf16_f32 v111, v62, v63
    buffer_store_dwordx4 v[104:107], v0, s[8:11], s28 offen offset:2048 sc1
    buffer_store_dwordx4 v[108:111], v0, s[8:11], s28 offen offset:3072 sc1
    s_add_u32 s28, s28, s65
    v_cvt_pk_bf16_f32 v112, v64, v65
    v_cvt_pk_bf16_f32 v113, v66, v67
    v_cvt_pk_bf16_f32 v114, v68, v69
    v_cvt_pk_bf16_f32 v115, v70, v71
    v_cvt_pk_bf16_f32 v116, v72, v73
    v_cvt_pk_bf16_f32 v117, v74, v75
    v_cvt_pk_bf16_f32 v118, v76, v77
    v_cvt_pk_bf16_f32 v119, v78, v79
    buffer_store_dwordx4 v[112:115], v0, s[8:11], s28 offen offset:0 sc1
    buffer_store_dwordx4 v[116:119], v0, s[8:11], s28 offen offset:1024 sc1
    v_cvt_pk_bf16_f32 v120, v80, v81
    v_cvt_pk_bf16_f32 v121, v82, v83
    v_cvt_pk_bf16_f32 v122, v84, v85
    v_cvt_pk_bf16_f32 v123, v86, v87
    v_cvt_pk_bf16_f32 v124, v88, v89
    v_cvt_pk_bf16_f32 v125, v90, v91
    v_cvt_pk_bf16_f32 v126, v92, v93
    v_cvt_pk_bf16_f32 v127, v94, v95
    buffer_store_dwordx4 v[120:123], v0, s[8:11], s28 offen offset:2048 sc1
    buffer_store_dwordx4 v[124:127], v0, s[8:11], s28 offen offset:3072 sc1
    s_add_u32 s20, s20, 6
    s_cmp_lt_u32 s20, 32
    s_cbranch_scc1 KV_loopT
    s_branch KV_fin
KV_loopV:
    s_waitcnt lgkmcnt(1)
    v_mfma_f32_32x32x16_bf16 v[32:47], v[8:11], a[0:3], 0
    ds_read_b128 v[16:19], v1 offset:1024
    s_mov_b32 m0, s27
    s_nop 0
    buffer_load_dwordx4 v0, s[16:19], s23 offen offset:0 sc1 lds
    v_mfma_f32_32x32x16_bf16 v[48:63], v[8:11], a[160:163], 0
    ds_read_b128 v[20:23], v1 offset:9216
    buffer_load_dwordx4 v0, s[16:19], s23 offen offset:1024 sc1 lds
    s_waitcnt lgkmcnt(2)
    v_mfma_f32_32x32x16_bf16 v[64:79], v[12:15], a[0:3], 0
    buffer_load_dwordx4 v0, s[16:19], s23 offen offset:2048 sc1 lds
    v_mfma_f32_32x32x16_bf16 v[80:95], v[12:15], a[160:163], 0
    buffer_load_dwordx4 v0, s[16:19], s23 offen offset:3072 sc1 lds
    s_waitcnt lgkmcnt(1)
    v_mfma_f32_32x32x16_bf16 v[32:47], v[16:19], a[4:7], v[32:47]
    ds_read_b128 v[8:11], v1 offset:2048
    s_add_u32 s23, s23, 8192
    s_add_u32 s27, s27, 16384
    s_and_b32 s27, s27, 0xffff
    s_add_u32 s22, s22, 1
    s_cmp_lt_u32 s22, 5
    s_cbranch_scc1 KV_V_a0
    s_mov_b32 s22, 0
    s_add_u32 s23, s23, 450560
KV_V_a0:
    v_mfma_f32_32x32x16_bf16 v[48:63], v[16:19], a[164:167], v[48:63]
    ds_read_b128 v[12:15], v1 offset:10240
    s_waitcnt lgkmcnt(2)
    v_mfma_f32_32x32x16_bf16 v[64:79], v[20:23], a[4:7], v[64:79]
    v_mfma_f32_32x32x16_bf16 v[80:95], v[20:23], a[164:167], v[80:95]
    s_waitcnt lgkmcnt(1)
    v_mfma_f32_32x32x16_bf16 v[32:47], v[8:11], a[8:11], v[32:47]
    ds_read_b128 v[16:19], v1 offset:3072
    v_mfma_f32_32x32x16_bf16 v[48:63], v[8:11], a[168:171], v[48:63]
    ds_read_b128 v[20:23], v1 offset:11264
    s_waitcnt lgkmcnt(2)
    v_mfma_f32_32x32x16_bf16 v[64:79], v[12:15], a[8:11], v[64:79]
    v_mfma_f32_32x32x16_bf16 v[80:95], v[12:15], a[168:171], v[80:95]
    s_waitcnt lgkmcnt(1)
    v_mfma_f32_32x32x16_bf16 v[32:47], v[16:19], a[12:15], v[32:47]
    ds_read_b128 v[8:11], v1 offset:4096
    v_mfma_f32_32x32x16_bf16 v[48:63], v[16:19], a[172:175], v[48:63]
    ds_read_b128 v[12:15], v1 offset:12288
    s_waitcnt lgkmcnt(2)
    v_mfma_f32_32x32x16_bf16 v[64:79], v[20:23], a[12:15], v[64:79]
    v_mfma_f32_32x32x16_bf16 v[80:95], v[20:23], a[172:175], v[80:95]
    s_waitcnt lgkmcnt(1)
    v_mfma_f32_32x32x16_bf16 v[32:47], v[8:11], a[16:19], v[32:47]
    ds_read_b128 v[16:19], v1 offset:5120
    v_mfma_f32_32x32x16_bf16 v[48:63], v[8:11], a[176:179], v[48:63]
    ds_read_b128 v[20:23], v1 offset:13312
    s_waitcnt lgkmcnt(2)
    v_mfma_f32_32x32x16_bf16 v[64:79], v[12:15], a[16:19], v[64:79]
    v_mfma_f32_32x32x16_bf16 v[80:95], v[12:15], a[176:179], v[80:95]
    s_waitcnt lgkmcnt(1)
    v_mfma_f32_32x32x16_bf16 v[32:47], v[16:19], a[20:23], v[32:47]
    ds_read_b128 v[8:11], v1 offset:6144
    v_mfma_f32_32x32x16_bf16 v[48:63], v[16:19], a[180:183], v[48:63]
    ds_read_b128 v[12:15], v1 offset:14336
    s_waitcnt lgkmcnt(2)
    v_mfma_f32_32x32x16_bf16 v[64:79], v[20:23], a[20:23], v[64:79]
    v_mfma_f32_32x32x16_bf16 v[80:95], v[20:23], a[180:183], v[80:95]
    s_waitcnt lgkmcnt(1)
    v_mfma_f32_32x32x16_bf16 v[32:47], v[8:11], a[24:27], v[32:47]
    ds_read_b128 v[16:19], v1 offset:7168
    v_mfma_f32_32x32x16_bf16 v[48:63], v[8:11], a[184:187], v[48:63]
    ds_read_b128 v[20:23], v1 offset:15360
    s_waitcnt lgkmcnt(2)
    v_mfma_f32_32x32x16_bf16 v[64:79], v[12:15], a[24:27], v[64:79]
    v_mfma_f32_32x32x16_bf16 v[80:95], v[12:15], a[184:187], v[80:95]
    s_waitcnt lgkmcnt(1)
    v_mfma_f32_32x32x16_bf16 v[32:47], v[16:19], a[28:31], v[32:47]
    s_waitcnt vmcnt(8) lgkmcnt(0)
    v_add_u32 v1, 0x4000, v1
    s_barrier
    v_and_b32 v1, 0xffff, v1
    ds_read_b128 v[8:11], v1 offset:0
    v_mfma_f32_32x32x16_bf16 v[48:63], v[16:19], a[188:191], v[48:63]
    ds_read_b128 v[12:15], v1 offset:8192
    v_mfma_f32_32x32x16_bf16 v[64:79], v[20:23], a[28:31], v[64:79]
    v_mfma_f32_32x32x16_bf16 v[80:95], v[20:23], a[188:191], v[80:95]
    s_waitcnt lgkmcnt(1)
    v_mfma_f32_32x32x16_bf16 v[32:47], v[8:11], a[32:35], v[32:47]
    ds_read_b128 v[16:19], v1 offset:1024
    s_mov_b32 m0, s27
    s_nop 0
    buffer_load_dwordx4 v0, s[16:19], s23 offen offset:0 sc1 lds
    v_mfma_f32_32x32x16_bf16 v[48:63], v[8:11], a[192:195], v[48:63]
    ds_read_b128 v[20:23], v1 offset:9216
    buffer_load_dwordx4 v0, s[16:19], s23 offen offset:1024 sc1 lds
    s_waitcnt lgkmcnt(2)
    v_mfma_f32_32x32x16_bf16 v[64:79], v[12:15], a[32:35], v[64:79]
    buffer_load_dwordx4 v0, s[16:19], s23 offen offset:2048 sc1 lds
    v_mfma_f32_32x32x16_bf16 v[80:95], v[12:15], a[192:195], v[80:95]
    buffer_load_dwordx4 v0, s[16:19], s23 offen offset:3072 sc1 lds
    s_waitcnt lgkmcnt(1)
    v_mfma_f32_32x32x16_bf16 v[32:47], v[16:19], a[36:39], v[32:47]
    ds_read_b128 v[8:11], v1 offset:2048
    s_add_u32 s23, s23, 8192
    s_add_u32 s27, s27, 16384
    s_and_b32 s27, s27, 0xffff
    s_add_u32 s22, s22, 1
    s_cmp_lt_u32 s22, 5
    s_cbranch_scc1 KV_V_a1
    s_mov_b32 s22, 0
    s_add_u32 s23, s23, 450560
KV_V_a1:
    v_mfma_f32_32x32x16_bf16 v[48:63], v[16:19], a[196:199], v[48:63]
    ds_read_b128 v[12:15], v1 offset:10240
    s_waitcnt lgkmcnt(2)
    v_mfma_f32_32x32x16_bf16 v[64:79], v[20:23], a[36:39], v[64:79]
    v_mfma_f32_32x32x16_bf16 v[80:95], v[20:23], a[196:199], v[80:95]
    s_waitcnt lgkmcnt(1)
    v_mfma_f32_32x32x16_bf16 v[32:47], v[8:11], a[40:43], v[32:47]
    ds_read_b128 v[16:19], v1 offset:3072
    v_mfma_f32_32x32x16_bf16 v[48:63], v[8:11], a[200:203], v[48:63]
    ds_read_b128 v[20:23], v1 offset:11264
    s_waitcnt lgkmcnt(2)
    v_mfma_f32_32x32x16_bf16 v[64:79], v[12:15], a[40:43], v[64:79]
    v_mfma_f32_32x32x16_bf16 v[80:95], v[12:15], a[200:203], v[80:95]
    s_waitcnt lgkmcnt(1)
    v_mfma_f32_32x32x16_bf16 v[32:47], v[16:19], a[44:47], v[32:47]
    ds_read_b128 v[8:11], v1 offset:4096
    v_mfma_f32_32x32x16_bf16 v[48:63], v[16:19], a[204:207], v[48:63]
    ds_read_b128 v[12:15], v1 offset:12288
    s_waitcnt lgkmcnt(2)
    v_mfma_f32_32x32x16_bf16 v[64:79], v[20:23], a[44:47], v[64:79]
    v_mfma_f32_32x32x16_bf16 v[80:95], v[20:23], a[204:207], v[80:95]
    s_waitcnt lgkmcnt(1)
    v_mfma_f32_32x32x16_bf16 v[32:47], v[8:11], a[48:51], v[32:47]
    ds_read_b128 v[16:19], v1 offset:5120
    v_mfma_f32_32x32x16_bf16 v[48:63], v[8:11], a[208:211], v[48:63]
    ds_read_b128 v[20:23], v1 offset:13312
    s_waitcnt lgkmcnt(2)
    v_mfma_f32_32x32x16_bf16 v[64:79], v[12:15], a[48:51], v[64:79]
    v_mfma_f32_32x32x16_bf16 v[80:95], v[12:15], a[208:211], v[80:95]
    s_waitcnt lgkmcnt(1)
    v_mfma_f32_32x32x16_bf16 v[32:47], v[16:19], a[52:55], v[32:47]
    ds_read_b128 v[8:11], v1 offset:6144
    v_mfma_f32_32x32x16_bf16 v[48:63], v[16:19], a[212:215], v[48:63]
    ds_read_b128 v[12:15], v1 offset:14336
    s_waitcnt lgkmcnt(2)
    v_mfma_f32_32x32x16_bf16 v[64:79], v[20:23], a[52:55], v[64:79]
    v_mfma_f32_32x32x16_bf16 v[80:95], v[20:23], a[212:215], v[80:95]
    s_waitcnt lgkmcnt(1)
    v_mfma_f32_32x32x16_bf16 v[32:47], v[8:11], a[56:59], v[32:47]
    ds_read_b128 v[16:19], v1 offset:7168
    v_mfma_f32_32x32x16_bf16 v[48:63], v[8:11], a[216:219], v[48:63]
    ds_read_b128 v[20:23], v1 offset:15360
    s_waitcnt lgkmcnt(2)
    v_mfma_f32_32x32x16_bf16 v[64:79], v[12:15], a[56:59], v[64:79]
    v_mfma_f32_32x32x16_bf16 v[80:95], v[12:15], a[216:219], v[80:95]
    s_waitcnt lgkmcnt(1)
    v_mfma_f32_32x32x16_bf16 v[32:47], v[16:19], a[60:63], v[32:47]
    s_waitcnt vmcnt(8) lgkmcnt(0)
    v_add_u32 v1, 0x4000, v1
    s_barrier
    v_and_b32 v1, 0xffff, v1
    ds_read_b128 v[8:11], v1 offset:0
    v_mfma_f32_32x32x16_bf16 v[48:63], v[16:19], a[220:223], v[48:63]
    ds_read_b128 v[12:15], v1 offset:8192
    v_mfma_f32_32x32x16_bf16 v[64:79], v[20:23], a[60:63], v[64:79]
    v_mfma_f32_32x32x16_bf16 v[80:95], v[20:23], a[220:223], v[80:95]
    s_waitcnt lgkmcnt(1)
    v_mfma_f32_32x32x16_bf16 v[32:47], v[8:11], a[64:67], v[32:47]
    ds_read_b128 v[16:19], v1 offset:1024
    s_mov_b32 m0, s27
    s_nop 0
    buffer_load_dwordx4 v0, s[16:19], s23 offen offset:0 sc1 lds
    v_mfma_f32_32x32x16_bf16 v[48:63], v[8:11], a[224:227], v[48:63]
    ds_read_b128 v[20:23], v1 offset:9216
    buffer_load_dwordx4 v0, s[16:19], s23 offen offset:1024 sc1 lds
    s_waitcnt lgkmcnt(2)
    v_mfma_f32_32x32x16_bf16 v[64:79], v[12:15], a[64:67], v[64:79]
    buffer_load_dwordx4 v0, s[16:19], s23 offen offset:2048 sc1 lds
    v_mfma_f32_32x32x16_bf16 v[80:95], v[12:15], a[224:227], v[80:95]
    buffer_load_dwordx4 v0, s[16:19], s23 offen offset:3072 sc1 lds
    s_waitcnt lgkmcnt(1)
    v_mfma_f32_32x32x16_bf16 v[32:47], v[16:19], a[68:71], v[32:47]
    ds_read_b128 v[8:11], v1 offset:2048
    s_add_u32 s23, s23, 8192
    s_add_u32 s27, s27, 16384
    s_and_b32 s27, s27, 0xffff
    s_add_u32 s22, s22, 1
    s_cmp_lt_u32 s22, 5
    s_cbranch_scc1 KV_V_a2
    s_mov_b32 s22, 0
    s_add_u32 s23, s23, 450560
KV_V_a2:
    s_cmp_eq_u32 s29, 0
    s_cbranch_scc1 KV_V_np
    v_mov_b32 v5, 1
    s_mov_b64 exec, 1
    buffer_store_dword v5, off, s[8:11], s29 sc1
    s_mov_b64 exec, -1
KV_V_np:
    v_mfma_f32_32x32x16_bf16 v[48:63], v[16:19], a[228:231], v[48:63]
    ds_read_b128 v[12:15], v1 offset:10240
    s_waitcnt lgkmcnt(2)
    v_mfma_f32_32x32x16_bf16 v[64:79], v[20:23], a[68:71], v[64:79]
    v_mfma_f32_32x32x16_bf16 v[80:95], v[20:23], a[228:231], v[80:95]
    s_waitcnt lgkmcnt(1)
    v_mfma_f32_32x32x16_bf16 v[32:47], v[8:11], a[72:75], v[32:47]
    ds_read_b128 v[16:19], v1 offset:3072
    v_mfma_f32_32x32x16_bf16 v[48:63], v[8:11], a[232:235], v[48:63]
    ds_read_b128 v[20:23], v1 offset:11264
    s_waitcnt lgkmcnt(2)
    v_mfma_f32_32x32x16_bf16 v[64:79], v[12:15], a[72:75], v[64:79]
    v_mfma_f32_32x32x16_bf16 v[80:95], v[12:15], a[232:235], v[80:95]
    s_waitcnt lgkmcnt(1)
    v_mfma_f32_32x32x16_bf16 v[32:47], v[16:19], a[76:79], v[32:47]
    ds_read_b128 v[8:11], v1 offset:4096
    v_mfma_f32_32x32x16_bf16 v[48:63], v[16:19], a[236:239], v[48:63]
    ds_read_b128 v[12:15], v1 offset:12288
    s_waitcnt lgkmcnt(2)
    v_mfma_f32_32x32x16_bf16 v[64:79], v[20:23], a[76:79], v[64:79]
    v_mfma_f32_32x32x16_bf16 v[80:95], v[20:23], a[236:239], v[80:95]
    s_waitcnt lgkmcnt(1)
    v_mfma_f32_32x32x16_bf16 v[32:47], v[8:11], a[80:83], v[32:47]
    ds_read_b128 v[16:19], v1 offset:5120
    v_mfma_f32_32x32x16_bf16 v[48:63], v[8:11], a[240:243], v[48:63]
    ds_read_b128 v[20:23], v1 offset:13312
    s_waitcnt lgkmcnt(2)
    v_mfma_f32_32x32x16_bf16 v[64:79], v[12:15], a[80:83], v[64:79]
    v_mfma_f32_32x32x16_bf16 v[80:95], v[12:15], a[240:243], v[80:95]
    s_waitcnt lgkmcnt(1)
    v_mfma_f32_32x32x16_bf16 v[32:47], v[16:19], a[84:87], v[32:47]
    ds_read_b128 v[8:11], v1 offset:6144
    v_mfma_f32_32x32x16_bf16 v[48:63], v[16:19], a[244:247], v[48:63]
    ds_read_b128 v[12:15], v1 offset:14336
    s_waitcnt lgkmcnt(2)
    v_mfma_f32_32x32x16_bf16 v[64:79], v[20:23], a[84:87], v[64:79]
    v_mfma_f32_32x32x16_bf16 v[80:95], v[20:23], a[244:247], v[80:95]
    s_waitcnt lgkmcnt(1)
    v_mfma_f32_32x32x16_bf16 v[32:47], v[8:11], a[88:91], v[32:47]
    ds_read_b128 v[16:19], v1 offset:7168
    v_mfma_f32_32x32x16_bf16 v[48:63], v[8:11], a[248:251], v[48:63]
    ds_read_b128 v[20:23], v1 offset:15360
    s_waitcnt lgkmcnt(2)
    v_mfma_f32_32x32x16_bf16 v[64:79], v[12:15], a[88:91], v[64:79]
    v_mfma_f32_32x32x16_bf16 v[80:95], v[12:15], a[248:251], v[80:95]
    s_waitcnt lgkmcnt(1)
    v_mfma_f32_32x32x16_bf16 v[32:47], v[16:19], a[92:95], v[32:47]
    s_waitcnt vmcnt(8) lgkmcnt(0)
    v_add_u32 v1, 0x4000, v1
    s_barrier
    v_and_b32 v1, 0xffff, v1
    ds_read_b128 v[8:11], v1 offset:0
    v_mfma_f32_32x32x16_bf16 v[48:63], v[16:19], a[252:255], v[48:63]
    ds_read_b128 v[12:15], v1 offset:8192
    v_mfma_f32_32x32x16_bf16 v[64:79], v[20:23], a[92:95], v[64:79]
    v_mfma_f32_32x32x16_bf16 v[80:95], v[20:23], a[252:255], v[80:95]
    s_waitcnt lgkmcnt(1)
    v_mfma_f32_32x32x16_bf16 v[32:47], v[8:11], a[96:99], v[32:47]
    ds_read_b128 v[16:19], v1 offset:1024
    s_mov_b32 m0, s27
    s_nop 0
    buffer_load_dwordx4 v0, s[16:19], s23 offen offset:0 sc1 lds
    v_mfma_f32_32x32x16_bf16 v[48:63], v[8:11], v[192:195], v[48:63]
    ds_read_b128 v[20:23], v1 offset:9216
    buffer_load_dwordx4 v0, s[16:19], s23 offen offset:1024 sc1 lds
    s_waitcnt lgkmcnt(2)
    v_mfma_f32_32x32x16_bf16 v[64:79], v[12:15], a[96:99], v[64:79]
    buffer_load_dwordx4 v0, s[16:19], s23 offen offset:2048 sc1 lds
    v_mfma_f32_32x32x16_bf16 v[80:95], v[12:15], v[192:195], v[80:95]
    buffer_load_dwordx4 v0, s[16:19], s23 offen offset:3072 sc1 lds
    s_waitcnt lgkmcnt(1)
    v_mfma_f32_32x32x16_bf16 v[32:47], v[16:19], a[100:103], v[32:47]
    ds_read_b128 v[8:11], v1 offset:2048
    s_add_u32 s23, s23, 8192
    s_add_u32 s27, s27, 16384
    s_and_b32 s27, s27, 0xffff
    s_add_u32 s22, s22, 1
    s_cmp_lt_u32 s22, 5
    s_cbranch_scc1 KV_V_a3
    s_mov_b32 s22, 0
    s_add_u32 s23, s23, 450560
KV_V_a3:
    v_mfma_f32_32x32x16_bf16 v[48:63], v[16:19], v[196:199], v[48:63]
    ds_read_b128 v[12:15], v1 offset:10240
    s_waitcnt lgkmcnt(2)
    v_mfma_f32_32x32x16_bf16 v[64:79], v[20:23], a[100:103], v[64:79]
    v_mfma_f32_32x32x16_bf16 v[80:95], v[20:23], v[196:199], v[80:95]
    s_waitcnt lgkmcnt(1)
    v_mfma_f32_32x32x16_bf16 v[32:47], v[8:11], a[104:107], v[32:47]
    ds_read_b128 v[16:19], v1 offset:3072
    v_mfma_f32_32x32x16_bf16 v[48:63], v[8:11], v[200:203], v[48:63]
    ds_read_b128 v[20:23], v1 offset:11264
    s_waitcnt lgkmcnt(2)
    v_mfma_f32_32x32x16_bf16 v[64:79], v[12:15], a[104:107], v[64:79]
    v_mfma_f32_32x32x16_bf16 v[80:95], v[12:15], v[200:203], v[80:95]
    s_waitcnt lgkmcnt(1)
    v_mfma_f32_32x32x16_bf16 v[32:47], v[16:19], a[108:111], v[32:47]
    ds_read_b128 v[8:11], v1 offset:4096
    v_mfma_f32_32x32x16_bf16 v[48:63], v[16:19], v[204:207], v[48:63]
    ds_read_b128 v[12:15], v1 offset:12288
    s_waitcnt lgkmcnt(2)
    v_mfma_f32_32x32x16_bf16 v[64:79], v[20:23], a[108:111], v[64:79]
    v_mfma_f32_32x32x16_bf16 v[80:95], v[20:23], v[204:207], v[80:95]
    s_waitcnt lgkmcnt(1)
    v_mfma_f32_32x32x16_bf16 v[32:47], v[8:11], a[112:115], v[32:47]
    ds_read_b128 v[16:19], v1 offset:5120
    v_mfma_f32_32x32x16_bf16 v[48:63], v[8:11], v[208:211], v[48:63]
    ds_read_b128 v[20:23], v1 offset:13312
    s_waitcnt lgkmcnt(2)
    v_mfma_f32_32x32x16_bf16 v[64:79], v[12:15], a[112:115], v[64:79]
    v_mfma_f32_32x32x16_bf16 v[80:95], v[12:15], v[208:211], v[80:95]
    s_waitcnt lgkmcnt(1)
    v_mfma_f32_32x32x16_bf16 v[32:47], v[16:19], a[116:119], v[32:47]
    ds_read_b128 v[8:11], v1 offset:6144
    v_mfma_f32_32x32x16_bf16 v[48:63], v[16:19], v[212:215], v[48:63]
    ds_read_b128 v[12:15], v1 offset:14336
    s_waitcnt lgkmcnt(2)
    v_mfma_f32_32x32x16_bf16 v[64:79], v[20:23], a[116:119], v[64:79]
    v_mfma_f32_32x32x16_bf16 v[80:95], v[20:23], v[212:215], v[80:95]
    s_waitcnt lgkmcnt(1)
    v_mfma_f32_32x32x16_bf16 v[32:47], v[8:11], a[120:123], v[32:47]
    ds_read_b128 v[16:19], v1 offset:7168
    v_mfma_f32_32x32x16_bf16 v[48:63], v[8:11], v[216:219], v[48:63]
    ds_read_b128 v[20:23], v1 offset:15360
    s_waitcnt lgkmcnt(2)
    v_mfma_f32_32x32x16_bf16 v[64:79], v[12:15], a[120:123], v[64:79]
    v_mfma_f32_32x32x16_bf16 v[80:95], v[12:15], v[216:219], v[80:95]
    s_waitcnt lgkmcnt(1)
    v_mfma_f32_32x32x16_bf16 v[32:47], v[16:19], a[124:127], v[32:47]
    s_waitcnt vmcnt(8) lgkmcnt(0)
    v_add_u32 v1, 0x4000, v1
    s_barrier
    v_and_b32 v1, 0xffff, v1
    ds_read_b128 v[8:11], v1 offset:0
    v_mfma_f32_32x32x16_bf16 v[48:63], v[16:19], v[220:223], v[48:63]
    ds_read_b128 v[12:15], v1 offset:8192
    v_mfma_f32_32x32x16_bf16 v[64:79], v[20:23], a[124:127], v[64:79]
    v_mfma_f32_32x32x16_bf16 v[80:95], v[20:23], v[220:223], v[80:95]
    s_waitcnt lgkmcnt(1)
    v_mfma_f32_32x32x16_bf16 v[32:47], v[8:11], a[128:131], v[32:47]
    ds_read_b128 v[16:19], v1 offset:1024
    s_mov_b32 m0, s27
    s_nop 0
    buffer_load_dwordx4 v0, s[16:19], s23 offen offset:0 sc1 lds
    v_mfma_f32_32x32x16_bf16 v[48:63], v[8:11], v[224:227], v[48:63]
    ds_read_b128 v[20:23], v1 offset:9216
    buffer_load_dwordx4 v0, s[16:19], s23 offen offset:1024 sc1 lds
    s_waitcnt lgkmcnt(2)
    v_mfma_f32_32x32x16_bf16 v[64:79], v[12:15], a[128:131], v[64:79]
    buffer_load_dwordx4 v0, s[16:19], s23 offen offset:2048 sc1 lds
    v_mfma_f32_32x32x16_bf16 v[80:95], v[12:15], v[224:227], v[80:95]
    buffer_load_dwordx4 v0, s[16:19], s23 offen offset:3072 sc1 lds
    s_waitcnt lgkmcnt(1)
    v_mfma_f32_32x32x16_bf16 v[32:47], v[16:19], a[132:135], v[32:47]
    ds_read_b128 v[8:11], v1 offset:2048
    s_add_u32 s23, s23, 8192
    s_add_u32 s27, s27, 16384
    s_and_b32 s27, s27, 0xffff
    s_add_u32 s22, s22, 1
    s_cmp_lt_u32 s22, 5
    s_cbranch_scc1 KV_V_a4
    s_mov_b32 s22, 0
    s_add_u32 s23, s23, 450560
KV_V_a4:
    v_mfma_f32_32x32x16_bf16 v[48:63], v[16:19], v[228:231], v[48:63]
    ds_read_b128 v[12:15], v1 offset:10240
    s_waitcnt lgkmcnt(2)
    v_mfma_f32_32x32x16_bf16 v[64:79], v[20:23], a[132:135], v[64:79]
    v_mfma_f32_32x32x16_bf16 v[80:95], v[20:23], v[228:231], v[80:95]
    s_waitcnt lgkmcnt(1)
    v_mfma_f32_32x32x16_bf16 v[32:47], v[8:11], a[136:139], v[32:47]
    ds_read_b128 v[16:19], v1 offset:3072
    v_mfma_f32_32x32x16_bf16 v[48:63], v[8:11], v[232:235], v[48:63]
    ds_read_b128 v[20:23], v1 offset:11264
    s_waitcnt lgkmcnt(2)
    v_mfma_f32_32x32x16_bf16 v[64:79], v[12:15], a[136:139], v[64:79]
    v_mfma_f32_32x32x16_bf16 v[80:95], v[12:15], v[232:235], v[80:95]
    s_waitcnt lgkmcnt(1)
    v_mfma_f32_32x32x16_bf16 v[32:47], v[16:19], a[140:143], v[32:47]
    ds_read_b128 v[8:11], v1 offset:4096
    v_mfma_f32_32x32x16_bf16 v[48:63], v[16:19], v[236:239], v[48:63]
    ds_read_b128 v[12:15], v1 offset:12288
    s_waitcnt lgkmcnt(2)
    v_mfma_f32_32x32x16_bf16 v[64:79], v[20:23], a[140:143], v[64:79]
    v_mfma_f32_32x32x16_bf16 v[80:95], v[20:23], v[236:239], v[80:95]
    s_waitcnt lgkmcnt(1)
    v_mfma_f32_32x32x16_bf16 v[32:47], v[8:11], a[144:147], v[32:47]
    ds_read_b128 v[16:19], v1 offset:5120
    v_mfma_f32_32x32x16_bf16 v[48:63], v[8:11], v[240:243], v[48:63]
    ds_read_b128 v[20:23], v1 offset:13312
    s_waitcnt lgkmcnt(2)
    v_mfma_f32_32x32x16_bf16 v[64:79], v[12:15], a[144:147], v[64:79]
    v_mfma_f32_32x32x16_bf16 v[80:95], v[12:15], v[240:243], v[80:95]
    s_waitcnt lgkmcnt(1)
    v_mfma_f32_32x32x16_bf16 v[32:47], v[16:19], a[148:151], v[32:47]
    ds_read_b128 v[8:11], v1 offset:6144
    v_mfma_f32_32x32x16_bf16 v[48:63], v[16:19], v[244:247], v[48:63]
    ds_read_b128 v[12:15], v1 offset:14336
    s_waitcnt lgkmcnt(2)
    v_mfma_f32_32x32x16_bf16 v[64:79], v[20:23], a[148:151], v[64:79]
    v_mfma_f32_32x32x16_bf16 v[80:95], v[20:23], v[244:247], v[80:95]
    s_waitcnt lgkmcnt(1)
    v_mfma_f32_32x32x16_bf16 v[32:47], v[8:11], a[152:155], v[32:47]
    ds_read_b128 v[16:19], v1 offset:7168
    v_mfma_f32_32x32x16_bf16 v[48:63], v[8:11], v[248:251], v[48:63]
    ds_read_b128 v[20:23], v1 offset:15360
    s_waitcnt lgkmcnt(2)
    v_mfma_f32_32x32x16_bf16 v[64:79], v[12:15], a[152:155], v[64:79]
    v_mfma_f32_32x32x16_bf16 v[80:95], v[12:15], v[248:251], v[80:95]
    s_waitcnt lgkmcnt(1)
    v_mfma_f32_32x32x16_bf16 v[32:47], v[16:19], a[156:159], v[32:47]
    s_waitcnt vmcnt(8) lgkmcnt(0)
    v_add_u32 v1, 0x4000, v1
    s_barrier
    v_and_b32 v1, 0xffff, v1
    ds_read_b128 v[8:11], v1 offset:0
    v_mfma_f32_32x32x16_bf16 v[48:63], v[16:19], v[252:255], v[48:63]
    ds_read_b128 v[12:15], v1 offset:8192
    v_mfma_f32_32x32x16_bf16 v[64:79], v[20:23], a[156:159], v[64:79]
    v_mfma_f32_32x32x16_bf16 v[80:95], v[20:23], v[252:255], v[80:95]
    s_lshl_b32 s28, s20, 20
    s_add_u32 s28, s28, s34
    s_mov_b32 s65, 0x80000
    s_lshl_b32 s29, s20, 2
    s_add_u32 s29, s29, s35
    s_cmp_eq_u32 s4, 0
    s_cselect_b32 s29, s29, 0
    s_nop 4
    v_cvt_pk_bf16_f32 v96, v32, v33
    v_cvt_pk_bf16_f32 v97, v34, v35
    v_cvt_pk_bf16_f32 v98, v36, v37
    v_cvt_pk_bf16_f32 v99, v38, v39
    v_cvt_pk_bf16_f32 v100, v40, v41
    v_cvt_pk_bf16_f32 v101, v42, v43
    v_cvt_pk_bf16_f32 v102, v44, v45
    v_cvt_pk_bf16_f32 v103, v46, v47
    buffer_store_dwordx4 v[96:99], v0, s[8:11], s28 offen offset:0 sc1
    buffer_store_dwordx4 v[100:103], v0, s[8:11], s28 offen offset:1024 sc1
    v_cvt_pk_bf16_f32 v104, v48, v49
    v_cvt_pk_bf16_f32 v105, v50, v51
    v_cvt_pk_bf16_f32 v106, v52, v53
    v_cvt_pk_bf16_f32 v107, v54, v55
    v_cvt_pk_bf16_f32 v108, v56, v57
    v_cvt_pk_bf16_f32 v109, v58, v59
    v_cvt_pk_bf16_f32 v110, v60, v61
    v_cvt_pk_bf16_f32 v111, v62, v63
    buffer_store_dwordx4 v[104:107], v0, s[8:11], s28 offen offset:2048 sc1
    buffer_store_dwordx4 v[108:111], v0, s[8:11], s28 offen offset:3072 sc1
    s_add_u32 s28, s28, s65
    v_cvt_pk_bf16_f32 v112, v64, v65
    v_cvt_pk_bf16_f32 v113, v66, v67
    v_cvt_pk_bf16_f32 v114, v68, v69
    v_cvt_pk_bf16_f32 v115, v70, v71
    v_cvt_pk_bf16_f32 v116, v72, v73
    v_cvt_pk_bf16_f32 v117, v74, v75
    v_cvt_pk_bf16_f32 v118, v76, v77
    v_cvt_pk_bf16_f32 v119, v78, v79
    buffer_store_dwordx4 v[112:115], v0, s[8:11], s28 offen offset:0 sc1
    buffer_store_dwordx4 v[116:119], v0, s[8:11], s28 offen offset:1024 sc1
    v_cvt_pk_bf16_f32 v120, v80, v81
    v_cvt_pk_bf16_f32 v121, v82, v83
    v_cvt_pk_bf16_f32 v122, v84, v85
    v_cvt_pk_bf16_f32 v123, v86, v87
    v_cvt_pk_bf16_f32 v124, v88, v89
    v_cvt_pk_bf16_f32 v125, v90, v91
    v_cvt_pk_bf16_f32 v126, v92, v93
    v_cvt_pk_bf16_f32 v127, v94, v95
    buffer_store_dwordx4 v[120:123], v0, s[8:11], s28 offen offset:2048 sc1
    buffer_store_dwordx4 v[124:127], v0, s[8:11], s28 offen offset:3072 sc1
    s_add_u32 s20, s20, 6
    s_cmp_lt_u32 s20, 32
    s_cbranch_scc1 KV_loopV
KV_fin:
    s_waitcnt vmcnt(0) lgkmcnt(0)
    s_barrier
    s_cmp_eq_u32 s29, 0
    s_cbranch_scc1 KV_end
    v_mov_b32 v5, 1
    s_mov_b64 exec, 1
    buffer_store_dword v5, off, s[8:11], s29 sc1
    s_mov_b64 exec, -1
KV_end:
    s_cmp_lt_u32 s5, 16
    s_cbranch_scc1 G_end
    s_and_b32 s25, s5, 7
    s_lshr_b32 s26, s5, 3
    s_sub_u32 s26, s26, 2
    s_mul_i32 s64, s3, 2
    s_add_u32 s26, s26, s64
    v_lshrrev_b32 v8, 2, v7
    v_and_b32 v9, 3, v7
    v_lshlrev_b32 v3, 13, v8
    v_lshl_add_u32 v3, v9, 4, v3
    v_mul_u32_u24 v4, 3456, v8
    v_lshl_add_u32 v4, v9, 4, v4
    v_lshrrev_b32 v8, 5, v7
    v_lshlrev_b32 v8, 9, v8
    v_bfe_u32 v10, v7, 2, 2
    v_lshl_add_u32 v8, v10, 6, v8
    v_bfe_u32 v10, v7, 4, 1
    v_lshl_add_u32 v8, v10, 5, v8
    v_lshl_add_u32 v1, v9, 3, v8
    s_add_u32 s20, s26, 128
    s_mov_b32 s21, s20
    s_lshl_b32 s27, s4, 11
    s_mov_b32 s29, 0
    s_mov_b32 s22, 0
    s_cmp_ge_u32 s21, 192
    s_cbranch_scc1 G_p0_f
    s_mov_b32 s12, s72
    s_mov_b32 s13, s73
    s_and_b32 s23, s21, 63
    s_lshl_b32 s23, s23, 7
    s_lshl_b32 s64, s4, 18
    s_add_u32 s23, s23, s64
    s_add_u32 s24, s23, 64
    s_mov_b32 s16, s12
    s_mov_b32 s17, s13
    s_mov_b32 s14, 5242880
    s_mov_b32 s18, 5242880
    s_mov_b32 s30, 131072
    v_mov_b32 v2, v3
    s_branch G_p0_d
G_p0_f:
    s_sub_u32 s23, s21, 192
    s_lshl_b32 s23, s23, 6
    s_mul_i32 s64, s4, 110592
    s_add_u32 s23, s23, s64
    s_mov_b32 s24, s23
    s_mov_b32 s12, s80
    s_mov_b32 s13, s81
    s_mov_b32 s16, s82
    s_mov_b32 s17, s83
    s_cmp_lt_u32 s21, 246
    s_cselect_b32 s14, 2211840, 0
    s_mov_b32 s18, s14
    s_mov_b32 s30, 55296
    v_mov_b32 v2, v4
G_p0_d:
    s_add_u32 m0, s27, 0
    s_nop 0
    buffer_load_dwordx4 v2, s[12:15], s23 offen lds
    s_add_u32 m0, s27, 8192
    s_nop 0
    buffer_load_dwordx4 v2, s[16:19], s24 offen lds
    s_add_u32 m0, s27, 1024
    s_add_u32 s64, s23, s30
    buffer_load_dwordx4 v2, s[12:15], s64 offen lds
    s_add_u32 m0, s27, 9216
    s_add_u32 s64, s24, s30
    buffer_load_dwordx4 v2, s[16:19], s64 offen lds
    s_lshl_b32 s64, s30, 3
    s_add_u32 s23, s23, s64
    s_add_u32 s24, s24, s64
    s_add_u32 s27, s27, 16384
    s_and_b32 s27, s27, 0xffff
    s_add_u32 s22, s22, 1
    s_cmp_lt_u32 s22, 5
    s_cbranch_scc1 G_p1_n
    s_add_u32 s21, s21, 12
    s_mov_b32 s22, 0
    s_cmp_ge_u32 s21, 192
    s_cbranch_scc1 G_p1_f
    s_mov_b32 s12, s72
    s_mov_b32 s13, s73
    s_and_b32 s23, s21, 63
    s_lshl_b32 s23, s23, 7
    s_lshl_b32 s64, s4, 18
    s_add_u32 s23, s23, s64
    s_add_u32 s24, s23, 64
    s_mov_b32 s16, s12
    s_mov_b32 s17, s13
    s_mov_b32 s14, 5242880
    s_mov_b32 s18, 5242880
    s_mov_b32 s30, 131072
    v_mov_b32 v2, v3
    s_branch G_p1_d
G_p1_f:
    s_sub_u32 s23, s21, 192
    s_lshl_b32 s23, s23, 6
    s_mul_i32 s64, s4, 110592
    s_add_u32 s23, s23, s64
    s_mov_b32 s24, s23
    s_mov_b32 s12, s80
    s_mov_b32 s13, s81
    s_mov_b32 s16, s82
    s_mov_b32 s17, s83
    s_cmp_lt_u32 s21, 246
    s_cselect_b32 s14, 2211840, 0
    s_mov_b32 s18, s14
    s_mov_b32 s30, 55296
    v_mov_b32 v2, v4
G_p1_d:
G_p1_n:
    s_add_u32 m0, s27, 0
    s_nop 0
    buffer_load_dwordx4 v2, s[12:15], s23 offen lds
    s_add_u32 m0, s27, 8192
    s_nop 0
    buffer_load_dwordx4 v2, s[16:19], s24 offen lds
    s_add_u32 m0, s27, 1024
    s_add_u32 s64, s23, s30
    buffer_load_dwordx4 v2, s[12:15], s64 offen lds
    s_add_u32 m0, s27, 9216
    s_add_u32 s64, s24, s30
    buffer_load_dwordx4 v2, s[16:19], s64 offen lds
    s_lshl_b32 s64, s30, 3
    s_add_u32 s23, s23, s64
    s_add_u32 s24, s24, s64
    s_add_u32 s27, s27, 16384
    s_and_b32 s27, s27, 0xffff
    s_add_u32 s22, s22, 1
    s_cmp_lt_u32 s22, 5
    s_cbranch_scc1 G_p2_n
    s_add_u32 s21, s21, 12
    s_mov_b32 s22, 0
    s_cmp_ge_u32 s21, 192
    s_cbranch_scc1 G_p2_f
    s_mov_b32 s12, s72
    s_mov_b32 s13, s73
    s_and_b32 s23, s21, 63
    s_lshl_b32 s23, s23, 7
    s_lshl_b32 s64, s4, 18
    s_add_u32 s23, s23, s64
    s_add_u32 s24, s23, 64
    s_mov_b32 s16, s12
    s_mov_b32 s17, s13
    s_mov_b32 s14, 5242880
    s_mov_b32 s18, 5242880
    s_mov_b32 s30, 131072
    v_mov_b32 v2, v3
    s_branch G_p2_d
G_p2_f:
    s_sub_u32 s23, s21, 192
    s_lshl_b32 s23, s23, 6
    s_mul_i32 s64, s4, 110592
    s_add_u32 s23, s23, s64
    s_mov_b32 s24, s23
    s_mov_b32 s12, s80
    s_mov_b32 s13, s81
    s_mov_b32 s16, s82
    s_mov_b32 s17, s83
    s_cmp_lt_u32 s21, 246
    s_cselect_b32 s14, 2211840, 0
    s_mov_b32 s18, s14
    s_mov_b32 s30, 55296
    v_mov_b32 v2, v4
G_p2_d:
G_p2_n:
    s_add_u32 m0, s27, 0
    s_nop 0
    buffer_load_dwordx4 v2, s[12:15], s23 offen lds
    s_add_u32 m0, s27, 8192
    s_nop 0
    buffer_load_dwordx4 v2, s[16:19], s24 offen lds
    s_add_u32 m0, s27, 1024
    s_add_u32 s64, s23, s30
    buffer_load_dwordx4 v2, s[12:15], s64 offen lds
    s_add_u32 m0, s27, 9216
    s_add_u32 s64, s24, s30
    buffer_load_dwordx4 v2, s[16:19], s64 offen lds
    s_lshl_b32 s64, s30, 3
    s_add_u32 s23, s23, s64
    s_add_u32 s24, s24, s64
    s_add_u32 s27, s27, 16384
    s_and_b32 s27, s27, 0xffff
    s_add_u32 s22, s22, 1
    s_cmp_lt_u32 s22, 5
    s_cbranch_scc1 G_p3_n
    s_add_u32 s21, s21, 12
    s_mov_b32 s22, 0
    s_cmp_ge_u32 s21, 192
    s_cbranch_scc1 G_p3_f
    s_mov_b32 s12, s72
    s_mov_b32 s13, s73
    s_and_b32 s23, s21, 63
    s_lshl_b32 s23, s23, 7
    s_lshl_b32 s64, s4, 18
    s_add_u32 s23, s23, s64
    s_add_u32 s24, s23, 64
    s_mov_b32 s16, s12
    s_mov_b32 s17, s13
    s_mov_b32 s14, 5242880
    s_mov_b32 s18, 5242880
    s_mov_b32 s30, 131072
    v_mov_b32 v2, v3
    s_branch G_p3_d
G_p3_f:
    s_sub_u32 s23, s21, 192
    s_lshl_b32 s23, s23, 6
    s_mul_i32 s64, s4, 110592
    s_add_u32 s23, s23, s64
    s_mov_b32 s24, s23
    s_mov_b32 s12, s80
    s_mov_b32 s13, s81
    s_mov_b32 s16, s82
    s_mov_b32 s17, s83
    s_cmp_lt_u32 s21, 246
    s_cselect_b32 s14, 2211840, 0
    s_mov_b32 s18, s14
    s_mov_b32 s30, 55296
    v_mov_b32 v2, v4
G_p3_d:
G_p3_n:
    s_lshl_b32 s64, s25, 3
    s_lshl_b32 s65, s4, 1
    s_add_u32 s31, s64, s65
    s_mul_i32 s64, s31, 40960
    s_add_u32 s64, s64, 67108864
    buffer_load_dwordx4 a[0:3], v0, s[8:11], s64 offen offset:0 sc1
    buffer_load_dwordx4 a[4:7], v0, s[8:11], s64 offen offset:1024 sc1
    buffer_load_dwordx4 a[8:11], v0, s[8:11], s64 offen offset:2048 sc1
    buffer_load_dwordx4 a[12:15], v0, s[8:11], s64 offen offset:3072 sc1
    s_add_u32 s64, s64, 4096
    buffer_load_dwordx4 a[16:19], v0, s[8:11], s64 offen offset:0 sc1
    buffer_load_dwordx4 a[20:23], v0, s[8:11], s64 offen offset:1024 sc1
    buffer_load_dwordx4 a[24:27], v0, s[8:11], s64 offen offset:2048 sc1
    buffer_load_dwordx4 a[28:31], v0, s[8:11], s64 offen offset:3072 sc1
    s_add_u32 s64, s64, 4096
    buffer_load_dwordx4 a[32:35], v0, s[8:11], s64 offen offset:0 sc1
    buffer_load_dwordx4 a[36:39], v0, s[8:11], s64 offen offset:1024 sc1
    buffer_load_dwordx4 a[40:43], v0, s[8:11], s64 offen offset:2048 sc1
    buffer_load_dwordx4 a[44:47], v0, s[8:11], s64 offen offset:3072 sc1
    s_add_u32 s64, s64, 4096
    buffer_load_dwordx4 a[48:51], v0, s[8:11], s64 offen offset:0 sc1
    buffer_load_dwordx4 a[52:55], v0, s[8:11], s64 offen offset:1024 sc1
    buffer_load_dwordx4 a[56:59], v0, s[8:11], s64 offen offset:2048 sc1
    buffer_load_dwordx4 a[60:63], v0, s[8:11], s64 offen offset:3072 sc1
    s_add_u32 s64, s64, 4096
    buffer_load_dwordx4 a[64:67], v0, s[8:11], s64 offen offset:0 sc1
    buffer_load_dwordx4 a[68:71], v0, s[8:11], s64 offen offset:1024 sc1
    buffer_load_dwordx4 a[72:75], v0, s[8:11], s64 offen offset:2048 sc1
    buffer_load_dwordx4 a[76:79], v0, s[8:11], s64 offen offset:3072 sc1
    s_add_u32 s64, s64, 4096
    buffer_load_dwordx4 a[80:83], v0, s[8:11], s64 offen offset:0 sc1
    buffer_load_dwordx4 a[84:87], v0, s[8:11], s64 offen offset:1024 sc1
    buffer_load_dwordx4 a[88:91], v0, s[8:11], s64 offen offset:2048 sc1
    buffer_load_dwordx4 a[92:95], v0, s[8:11], s64 offen offset:3072 sc1
    s_add_u32 s64, s64, 4096
    buffer_load_dwordx4 a[96:99], v0, s[8:11], s64 offen offset:0 sc1
    buffer_load_dwordx4 a[100:103], v0, s[8:11], s64 offen offset:1024 sc1
    buffer_load_dwordx4 a[104:107], v0, s[8:11], s64 offen offset:2048 sc1
    buffer_load_dwordx4 a[108:111], v0, s[8:11], s64 offen offset:3072 sc1
    s_add_u32 s64, s64, 4096
    buffer_load_dwordx4 a[112:115], v0, s[8:11], s64 offen offset:0 sc1
    buffer_load_dwordx4 a[116:119], v0, s[8:11], s64 offen offset:1024 sc1
    buffer_load_dwordx4 a[120:123], v0, s[8:11], s64 offen offset:2048 sc1
    buffer_load_dwordx4 a[124:127], v0, s[8:11], s64 offen offset:3072 sc1
    s_add_u32 s64, s64, 4096
    buffer_load_dwordx4 a[128:131], v0, s[8:11], s64 offen offset:0 sc1
    buffer_load_dwordx4 a[132:135], v0, s[8:11], s64 offen offset:1024 sc1
    buffer_load_dwordx4 a[136:139], v0, s[8:11], s64 offen offset:2048 sc1
    buffer_load_dwordx4 a[140:143], v0, s[8:11], s64 offen offset:3072 sc1
    s_add_u32 s64, s64, 4096
    buffer_load_dwordx4 a[144:147], v0, s[8:11], s64 offen offset:0 sc1
    buffer_load_dwordx4 a[148:151], v0, s[8:11], s64 offen offset:1024 sc1
    buffer_load_dwordx4 a[152:155], v0, s[8:11], s64 offen offset:2048 sc1
    buffer_load_dwordx4 a[156:159], v0, s[8:11], s64 offen offset:3072 sc1
    s_add_u32 s64, s64, 4096
    buffer_load_dwordx4 a[160:163], v0, s[8:11], s64 offen offset:0 sc1
    buffer_load_dwordx4 a[164:167], v0, s[8:11], s64 offen offset:1024 sc1
    buffer_load_dwordx4 a[168:171], v0, s[8:11], s64 offen offset:2048 sc1
    buffer_load_dwordx4 a[172:175], v0, s[8:11], s64 offen offset:3072 sc1
    s_add_u32 s64, s64, 4096
    buffer_load_dwordx4 a[176:179], v0, s[8:11], s64 offen offset:0 sc1
    buffer_load_dwordx4 a[180:183], v0, s[8:11], s64 offen offset:1024 sc1
    buffer_load_dwordx4 a[184:187], v0, s[8:11], s64 offen offset:2048 sc1
    buffer_load_dwordx4 a[188:191], v0, s[8:11], s64 offen offset:3072 sc1
    s_add_u32 s64, s64, 4096
    s_waitcnt vmcnt(32)
    buffer_load_dwordx4 a[192:195], v0, s[8:11], s64 offen offset:0 sc1
    buffer_load_dwordx4 a[196:199], v0, s[8:11], s64 offen offset:1024 sc1
    buffer_load_dwordx4 a[200:203], v0, s[8:11], s64 offen offset:2048 sc1
    buffer_load_dwordx4 a[204:207], v0, s[8:11], s64 offen offset:3072 sc1
    s_add_u32 s64, s64, 4096
    buffer_load_dwordx4 a[208:211], v0, s[8:11], s64 offen offset:0 sc1
    buffer_load_dwordx4 a[212:215], v0, s[8:11], s64 offen offset:1024 sc1
    buffer_load_dwordx4 a[216:219], v0, s[8:11], s64 offen offset:2048 sc1
    buffer_load_dwordx4 a[220:223], v0, s[8:11], s64 offen offset:3072 sc1
    s_add_u32 s64, s64, 4096
    buffer_load_dwordx4 a[224:227], v0, s[8:11], s64 offen offset:0 sc1
    buffer_load_dwordx4 a[228:231], v0, s[8:11], s64 offen offset:1024 sc1
    buffer_load_dwordx4 a[232:235], v0, s[8:11], s64 offen offset:2048 sc1
    buffer_load_dwordx4 a[236:239], v0, s[8:11], s64 offen offset:3072 sc1
    s_add_u32 s64, s64, 4096
    buffer_load_dwordx4 a[240:243], v0, s[8:11], s64 offen offset:0 sc1
    buffer_load_dwordx4 a[244:247], v0, s[8:11], s64 offen offset:1024 sc1
    buffer_load_dwordx4 a[248:251], v0, s[8:11], s64 offen offset:2048 sc1
    buffer_load_dwordx4 a[252:255], v0, s[8:11], s64 offen offset:3072 sc1
    s_add_u32 s64, s64, 4096
    buffer_load_dwordx4 v[192:195], v0, s[8:11], s64 offen offset:0 sc1
    buffer_load_dwordx4 v[196:199], v0, s[8:11], s64 offen offset:1024 sc1
    buffer_load_dwordx4 v[200:203], v0, s[8:11], s64 offen offset:2048 sc1
    buffer_load_dwordx4 v[204:207], v0, s[8:11], s64 offen offset:3072 sc1
    s_add_u32 s64, s64, 4096
    buffer_load_dwordx4 v[208:211], v0, s[8:11], s64 offen offset:0 sc1
    buffer_load_dwordx4 v[212:215], v0, s[8:11], s64 offen offset:1024 sc1
    buffer_load_dwordx4 v[216:219], v0, s[8:11], s64 offen offset:2048 sc1
    buffer_load_dwordx4 v[220:223], v0, s[8:11], s64 offen offset:3072 sc1
    s_add_u32 s64, s64, 4096
    buffer_load_dwordx4 v[224:227], v0, s[8:11], s64 offen offset:0 sc1
    buffer_load_dwordx4 v[228:231], v0, s[8:11], s64 offen offset:1024 sc1
    buffer_load_dwordx4 v[232:235], v0, s[8:11], s64 offen offset:2048 sc1
    buffer_load_dwordx4 v[236:239], v0, s[8:11], s64 offen offset:3072 sc1
    s_add_u32 s64, s64, 4096
    buffer_load_dwordx4 v[240:243], v0, s[8:11], s64 offen offset:0 sc1
    buffer_load_dwordx4 v[244:247], v0, s[8:11], s64 offen offset:1024 sc1
    buffer_load_dwordx4 v[248:251], v0, s[8:11], s64 offen offset:2048 sc1
    buffer_load_dwordx4 v[252:255], v0, s[8:11], s64 offen offset:3072 sc1
    s_waitcnt vmcnt(0)
    s_barrier
    ds_read_b64_tr_b16 v[8:9], v1 offset:0
    ds_read_b64_tr_b16 v[10:11], v1 offset:256
    ds_read_b64_tr_b16 v[12:13], v1 offset:8192
    ds_read_b64_tr_b16 v[14:15], v1 offset:8448
G_loop:
    s_waitcnt lgkmcnt(2)
    v_mfma_f32_32x32x16_bf16 v[32:47], v[8:11], a[0:3], 0
    ds_read_b64_tr_b16 v[16:17], v1 offset:1024
    s_add_u32 m0, s27, 0
    s_nop 0
    buffer_load_dwordx4 v2, s[12:15], s23 offen lds
    v_mfma_f32_32x32x16_bf16 v[64:79], v[8:11], a[160:163], 0
    ds_read_b64_tr_b16 v[18:19], v1 offset:1280
    s_add_u32 m0, s27, 8192
    s_nop 0
    buffer_load_dwordx4 v2, s[16:19], s24 offen lds
    s_waitcnt lgkmcnt(2)
    v_mfma_f32_32x32x16_bf16 v[48:63], v[12:15], a[0:3], 0
    ds_read_b64_tr_b16 v[20:21], v1 offset:9216
    s_add_u32 m0, s27, 1024
    s_add_u32 s64, s23, s30
    buffer_load_dwordx4 v2, s[12:15], s64 offen lds
    v_mfma_f32_32x32x16_bf16 v[80:95], v[12:15], a[160:163], 0
    ds_read_b64_tr_b16 v[22:23], v1 offset:9472
    s_add_u32 m0, s27, 9216
    s_add_u32 s64, s24, s30
    buffer_load_dwordx4 v2, s[16:19], s64 offen lds
    s_waitcnt lgkmcnt(2)
    v_mfma_f32_32x32x16_bf16 v[32:47], v[16:19], a[4:7], v[32:47]
    ds_read_b64_tr_b16 v[8:9], v1 offset:2048
    s_lshl_b32 s64, s30, 3
    s_add_u32 s23, s23, s64
    s_add_u32 s24, s24, s64
    s_add_u32 s27, s27, 16384
    s_and_b32 s27, s27, 0xffff
    s_add_u32 s22, s22, 1
    s_cmp_lt_u32 s22, 5
    s_cbranch_scc1 G_T_a0_n
    s_add_u32 s21, s21, 12
    s_mov_b32 s22, 0
    s_cmp_ge_u32 s21, 192
    s_cbranch_scc1 G_T_a0_f
    s_mov_b32 s12, s72
    s_mov_b32 s13, s73
    s_and_b32 s23, s21, 63
    s_lshl_b32 s23, s23, 7
    s_lshl_b32 s64, s4, 18
    s_add_u32 s23, s23, s64
    s_add_u32 s24, s23, 64
    s_mov_b32 s16, s12
    s_mov_b32 s17, s13
    s_mov_b32 s14, 5242880
    s_mov_b32 s18, 5242880
    s_mov_b32 s30, 131072
    v_mov_b32 v2, v3
    s_branch G_T_a0_d
G_T_a0_f:
    s_sub_u32 s23, s21, 192
    s_lshl_b32 s23, s23, 6
    s_mul_i32 s64, s4, 110592
    s_add_u32 s23, s23, s64
    s_mov_b32 s24, s23
    s_mov_b32 s12, s80
    s_mov_b32 s13, s81
    s_mov_b32 s16, s82
    s_mov_b32 s17, s83
    s_cmp_lt_u32 s21, 246
    s_cselect_b32 s14, 2211840, 0
    s_mov_b32 s18, s14
    s_mov_b32 s30, 55296
    v_mov_b32 v2, v4
G_T_a0_d:
G_T_a0_n:
    v_mfma_f32_32x32x16_bf16 v[64:79], v[16:19], a[164:167], v[64:79]
    ds_read_b64_tr_b16 v[10:11], v1 offset:2304
    s_waitcnt lgkmcnt(2)
    v_mfma_f32_32x32x16_bf16 v[48:63], v[20:23], a[4:7], v[48:63]
    ds_read_b64_tr_b16 v[12:13], v1 offset:10240
    v_mfma_f32_32x32x16_bf16 v[80:95], v[20:23], a[164:167], v[80:95]
    ds_read_b64_tr_b16 v[14:15], v1 offset:10496
    s_waitcnt lgkmcnt(2)
    v_mfma_f32_32x32x16_bf16 v[32:47], v[8:11], a[8:11], v[32:47]
    ds_read_b64_tr_b16 v[16:17], v1 offset:3072
    v_mfma_f32_32x32x16_bf16 v[64:79], v[8:11], a[168:171], v[64:79]
    ds_read_b64_tr_b16 v[18:19], v1 offset:3328
    s_waitcnt lgkmcnt(2)
    v_mfma_f32_32x32x16_bf16 v[48:63], v[12:15], a[8:11], v[48:63]
    ds_read_b64_tr_b16 v[20:21], v1 offset:11264
    v_mfma_f32_32x32x16_bf16 v[80:95], v[12:15], a[168:171], v[80:95]
    ds_read_b64_tr_b16 v[22:23], v1 offset:11520
    s_waitcnt lgkmcnt(2)
    v_mfma_f32_32x32x16_bf16 v[32:47], v[16:19], a[12:15], v[32:47]
    ds_read_b64_tr_b16 v[8:9], v1 offset:4096
    v_mfma_f32_32x32x16_bf16 v[64:79], v[16:19], a[172:175], v[64:79]
    ds_read_b64_tr_b16 v[10:11], v1 offset:4352
    s_waitcnt lgkmcnt(2)
    v_mfma_f32_32x32x16_bf16 v[48:63], v[20:23], a[12:15], v[48:63]
    ds_read_b64_tr_b16 v[12:13], v1 offset:12288
    v_mfma_f32_32x32x16_bf16 v[80:95], v[20:23], a[172:175], v[80:95]
    ds_read_b64_tr_b16 v[14:15], v1 offset:12544
    s_waitcnt lgkmcnt(2)
    v_mfma_f32_32x32x16_bf16 v[32:47], v[8:11], a[16:19], v[32:47]
    ds_read_b64_tr_b16 v[16:17], v1 offset:5120
    v_mfma_f32_32x32x16_bf16 v[64:79], v[8:11], a[176:179], v[64:79]
    ds_read_b64_tr_b16 v[18:19], v1 offset:5376
    s_waitcnt lgkmcnt(2)
    v_mfma_f32_32x32x16_bf16 v[48:63], v[12:15], a[16:19], v[48:63]
    ds_read_b64_tr_b16 v[20:21], v1 offset:13312
    v_mfma_f32_32x32x16_bf16 v[80:95], v[12:15], a[176:179], v[80:95]
    ds_read_b64_tr_b16 v[22:23], v1 offset:13568
    s_waitcnt lgkmcnt(2)
    v_mfma_f32_32x32x16_bf16 v[32:47], v[16:19], a[20:23], v[32:47]
    ds_read_b64_tr_b16 v[8:9], v1 offset:6144
    v_mfma_f32_32x32x16_bf16 v[64:79], v[16:19], a[180:183], v[64:79]
    ds_read_b64_tr_b16 v[10:11], v1 offset:6400
    s_waitcnt lgkmcnt(2)
    v_mfma_f32_32x32x16_bf16 v[48:63], v[20:23], a[20:23], v[48:63]
    ds_read_b64_tr_b16 v[12:13], v1 offset:14336
    v_mfma_f32_32x32x16_bf16 v[80:95], v[20:23], a[180:183], v[80:95]
    ds_read_b64_tr_b16 v[14:15], v1 offset:14592
    s_waitcnt lgkmcnt(2)
    v_mfma_f32_32x32x16_bf16 v[32:47], v[8:11], a[24:27], v[32:47]
    ds_read_b64_tr_b16 v[16:17], v1 offset:7168
    v_mfma_f32_32x32x16_bf16 v[64:79], v[8:11], a[184:187], v[64:79]
    ds_read_b64_tr_b16 v[18:19], v1 offset:7424
    s_waitcnt lgkmcnt(2)
    v_mfma_f32_32x32x16_bf16 v[48:63], v[12:15], a[24:27], v[48:63]
    ds_read_b64_tr_b16 v[20:21], v1 offset:15360
    v_mfma_f32_32x32x16_bf16 v[80:95], v[12:15], a[184:187], v[80:95]
    ds_read_b64_tr_b16 v[22:23], v1 offset:15616
    s_waitcnt lgkmcnt(2)
    v_mfma_f32_32x32x16_bf16 v[32:47], v[16:19], a[28:31], v[32:47]
    s_waitcnt vmcnt(8) lgkmcnt(0)
    v_add_u32 v1, 0x4000, v1
    s_barrier
    v_and_b32 v1, 0xffff, v1
    ds_read_b64_tr_b16 v[8:9], v1 offset:0
    v_mfma_f32_32x32x16_bf16 v[64:79], v[16:19], a[188:191], v[64:79]
    ds_read_b64_tr_b16 v[10:11], v1 offset:256
    v_mfma_f32_32x32x16_bf16 v[48:63], v[20:23], a[28:31], v[48:63]
    ds_read_b64_tr_b16 v[12:13], v1 offset:8192
    v_mfma_f32_32x32x16_bf16 v[80:95], v[20:23], a[188:191], v[80:95]
    ds_read_b64_tr_b16 v[14:15], v1 offset:8448
    s_waitcnt lgkmcnt(2)
    v_mfma_f32_32x32x16_bf16 v[32:47], v[8:11], a[32:35], v[32:47]
    ds_read_b64_tr_b16 v[16:17], v1 offset:1024
    s_add_u32 m0, s27, 0
    s_nop 0
    buffer_load_dwordx4 v2, s[12:15], s23 offen lds
    v_mfma_f32_32x32x16_bf16 v[64:79], v[8:11], a[192:195], v[64:79]
    ds_read_b64_tr_b16 v[18:19], v1 offset:1280
    s_add_u32 m0, s27, 8192
    s_nop 0
    buffer_load_dwordx4 v2, s[16:19], s24 offen lds
    s_waitcnt lgkmcnt(2)
    v_mfma_f32_32x32x16_bf16 v[48:63], v[12:15], a[32:35], v[48:63]
    ds_read_b64_tr_b16 v[20:21], v1 offset:9216
    s_add_u32 m0, s27, 1024
    s_add_u32 s64, s23, s30
    buffer_load_dwordx4 v2, s[12:15], s64 offen lds
    v_mfma_f32_32x32x16_bf16 v[80:95], v[12:15], a[192:195], v[80:95]
    ds_read_b64_tr_b16 v[22:23], v1 offset:9472
    s_add_u32 m0, s27, 9216
    s_add_u32 s64, s24, s30
    buffer_load_dwordx4 v2, s[16:19], s64 offen lds
    s_waitcnt lgkmcnt(2)
    v_mfma_f32_32x32x16_bf16 v[32:47], v[16:19], a[36:39], v[32:47]
    ds_read_b64_tr_b16 v[8:9], v1 offset:2048
    s_lshl_b32 s64, s30, 3
    s_add_u32 s23, s23, s64
    s_add_u32 s24, s24, s64
    s_add_u32 s27, s27, 16384
    s_and_b32 s27, s27, 0xffff
    s_add_u32 s22, s22, 1
    s_cmp_lt_u32 s22, 5
    s_cbranch_scc1 G_T_a1_n
    s_add_u32 s21, s21, 12
    s_mov_b32 s22, 0
    s_cmp_ge_u32 s21, 192
    s_cbranch_scc1 G_T_a1_f
    s_mov_b32 s12, s72
    s_mov_b32 s13, s73
    s_and_b32 s23, s21, 63
    s_lshl_b32 s23, s23, 7
    s_lshl_b32 s64, s4, 18
    s_add_u32 s23, s23, s64
    s_add_u32 s24, s23, 64
    s_mov_b32 s16, s12
    s_mov_b32 s17, s13
    s_mov_b32 s14, 5242880
    s_mov_b32 s18, 5242880
    s_mov_b32 s30, 131072
    v_mov_b32 v2, v3
    s_branch G_T_a1_d
G_T_a1_f:
    s_sub_u32 s23, s21, 192
    s_lshl_b32 s23, s23, 6
    s_mul_i32 s64, s4, 110592
    s_add_u32 s23, s23, s64
    s_mov_b32 s24, s23
    s_mov_b32 s12, s80
    s_mov_b32 s13, s81
    s_mov_b32 s16, s82
    s_mov_b32 s17, s83
    s_cmp_lt_u32 s21, 246
    s_cselect_b32 s14, 2211840, 0
    s_mov_b32 s18, s14
    s_mov_b32 s30, 55296
    v_mov_b32 v2, v4
G_T_a1_d:
G_T_a1_n:
    v_mfma_f32_32x32x16_bf16 v[64:79], v[16:19], a[196:199], v[64:79]
    ds_read_b64_tr_b16 v[10:11], v1 offset:2304
    s_waitcnt lgkmcnt(2)
    v_mfma_f32_32x32x16_bf16 v[48:63], v[20:23], a[36:39], v[48:63]
    ds_read_b64_tr_b16 v[12:13], v1 offset:10240
    v_mfma_f32_32x32x16_bf16 v[80:95], v[20:23], a[196:199], v[80:95]
    ds_read_b64_tr_b16 v[14:15], v1 offset:10496
    s_waitcnt lgkmcnt(2)
    v_mfma_f32_32x32x16_bf16 v[32:47], v[8:11], a[40:43], v[32:47]
    ds_read_b64_tr_b16 v[16:17], v1 offset:3072
    v_mfma_f32_32x32x16_bf16 v[64:79], v[8:11], a[200:203], v[64:79]
    ds_read_b64_tr_b16 v[18:19], v1 offset:3328
    s_waitcnt lgkmcnt(2)
    v_mfma_f32_32x32x16_bf16 v[48:63], v[12:15], a[40:43], v[48:63]
    ds_read_b64_tr_b16 v[20:21], v1 offset:11264
    v_mfma_f32_32x32x16_bf16 v[80:95], v[12:15], a[200:203], v[80:95]
    ds_read_b64_tr_b16 v[22:23], v1 offset:11520
    s_waitcnt lgkmcnt(2)
    v_mfma_f32_32x32x16_bf16 v[32:47], v[16:19], a[44:47], v[32:47]
    ds_read_b64_tr_b16 v[8:9], v1 offset:4096
    v_mfma_f32_32x32x16_bf16 v[64:79], v[16:19], a[204:207], v[64:79]
    ds_read_b64_tr_b16 v[10:11], v1 offset:4352
    s_waitcnt lgkmcnt(2)
    v_mfma_f32_32x32x16_bf16 v[48:63], v[20:23], a[44:47], v[48:63]
    ds_read_b64_tr_b16 v[12:13], v1 offset:12288
    v_mfma_f32_32x32x16_bf16 v[80:95], v[20:23], a[204:207], v[80:95]
    ds_read_b64_tr_b16 v[14:15], v1 offset:12544
    s_waitcnt lgkmcnt(2)
    v_mfma_f32_32x32x16_bf16 v[32:47], v[8:11], a[48:51], v[32:47]
    ds_read_b64_tr_b16 v[16:17], v1 offset:5120
    v_mfma_f32_32x32x16_bf16 v[64:79], v[8:11], a[208:211], v[64:79]
    ds_read_b64_tr_b16 v[18:19], v1 offset:5376
    s_waitcnt lgkmcnt(2)
    v_mfma_f32_32x32x16_bf16 v[48:63], v[12:15], a[48:51], v[48:63]
    ds_read_b64_tr_b16 v[20:21], v1 offset:13312
    v_mfma_f32_32x32x16_bf16 v[80:95], v[12:15], a[208:211], v[80:95]
    ds_read_b64_tr_b16 v[22:23], v1 offset:13568
    s_waitcnt lgkmcnt(2)
    v_mfma_f32_32x32x16_bf16 v[32:47], v[16:19], a[52:55], v[32:47]
    ds_read_b64_tr_b16 v[8:9], v1 offset:6144
    v_mfma_f32_32x32x16_bf16 v[64:79], v[16:19], a[212:215], v[64:79]
    ds_read_b64_tr_b16 v[10:11], v1 offset:6400
    s_waitcnt lgkmcnt(2)
    v_mfma_f32_32x32x16_bf16 v[48:63], v[20:23], a[52:55], v[48:63]
    ds_read_b64_tr_b16 v[12:13], v1 offset:14336
    v_mfma_f32_32x32x16_bf16 v[80:95], v[20:23], a[212:215], v[80:95]
    ds_read_b64_tr_b16 v[14:15], v1 offset:14592
    s_waitcnt lgkmcnt(2)
    v_mfma_f32_32x32x16_bf16 v[32:47], v[8:11], a[56:59], v[32:47]
    ds_read_b64_tr_b16 v[16:17], v1 offset:7168
    v_mfma_f32_32x32x16_bf16 v[64:79], v[8:11], a[216:219], v[64:79]
    ds_read_b64_tr_b16 v[18:19], v1 offset:7424
    s_waitcnt lgkmcnt(2)
    v_mfma_f32_32x32x16_bf16 v[48:63], v[12:15], a[56:59], v[48:63]
    ds_read_b64_tr_b16 v[20:21], v1 offset:15360
    v_mfma_f32_32x32x16_bf16 v[80:95], v[12:15], a[216:219], v[80:95]
    ds_read_b64_tr_b16 v[22:23], v1 offset:15616
    s_waitcnt lgkmcnt(2)
    v_mfma_f32_32x32x16_bf16 v[32:47], v[16:19], a[60:63], v[32:47]
    s_waitcnt vmcnt(8) lgkmcnt(0)
    v_add_u32 v1, 0x4000, v1
    s_barrier
    v_and_b32 v1, 0xffff, v1
    ds_read_b64_tr_b16 v[8:9], v1 offset:0
    v_mfma_f32_32x32x16_bf16 v[64:79], v[16:19], a[220:223], v[64:79]
    ds_read_b64_tr_b16 v[10:11], v1 offset:256
    v_mfma_f32_32x32x16_bf16 v[48:63], v[20:23], a[60:63], v[48:63]
    ds_read_b64_tr_b16 v[12:13], v1 offset:8192
    v_mfma_f32_32x32x16_bf16 v[80:95], v[20:23], a[220:223], v[80:95]
    ds_read_b64_tr_b16 v[14:15], v1 offset:8448
    s_waitcnt lgkmcnt(2)
    v_mfma_f32_32x32x16_bf16 v[32:47], v[8:11], a[64:67], v[32:47]
    ds_read_b64_tr_b16 v[16:17], v1 offset:1024
    s_add_u32 m0, s27, 0
    s_nop 0
    buffer_load_dwordx4 v2, s[12:15], s23 offen lds
    v_mfma_f32_32x32x16_bf16 v[64:79], v[8:11], a[224:227], v[64:79]
    ds_read_b64_tr_b16 v[18:19], v1 offset:1280
    s_add_u32 m0, s27, 8192
    s_nop 0
    buffer_load_dwordx4 v2, s[16:19], s24 offen lds
    s_waitcnt lgkmcnt(2)
    v_mfma_f32_32x32x16_bf16 v[48:63], v[12:15], a[64:67], v[48:63]
    ds_read_b64_tr_b16 v[20:21], v1 offset:9216
    s_add_u32 m0, s27, 1024
    s_add_u32 s64, s23, s30
    buffer_load_dwordx4 v2, s[12:15], s64 offen lds
    v_mfma_f32_32x32x16_bf16 v[80:95], v[12:15], a[224:227], v[80:95]
    ds_read_b64_tr_b16 v[22:23], v1 offset:9472
    s_add_u32 m0, s27, 9216
    s_add_u32 s64, s24, s30
    buffer_load_dwordx4 v2, s[16:19], s64 offen lds
    s_waitcnt lgkmcnt(2)
    v_mfma_f32_32x32x16_bf16 v[32:47], v[16:19], a[68:71], v[32:47]
    ds_read_b64_tr_b16 v[8:9], v1 offset:2048
    s_lshl_b32 s64, s30, 3
    s_add_u32 s23, s23, s64
    s_add_u32 s24, s24, s64
    s_add_u32 s27, s27, 16384
    s_and_b32 s27, s27, 0xffff
    s_add_u32 s22, s22, 1
    s_cmp_lt_u32 s22, 5
    s_cbranch_scc1 G_T_a2_n
    s_add_u32 s21, s21, 12
    s_mov_b32 s22, 0
    s_cmp_ge_u32 s21, 192
    s_cbranch_scc1 G_T_a2_f
    s_mov_b32 s12, s72
    s_mov_b32 s13, s73
    s_and_b32 s23, s21, 63
    s_lshl_b32 s23, s23, 7
    s_lshl_b32 s64, s4, 18
    s_add_u32 s23, s23, s64
    s_add_u32 s24, s23, 64
    s_mov_b32 s16, s12
    s_mov_b32 s17, s13
    s_mov_b32 s14, 5242880
    s_mov_b32 s18, 5242880
    s_mov_b32 s30, 131072
    v_mov_b32 v2, v3
    s_branch G_T_a2_d
G_T_a2_f:
    s_sub_u32 s23, s21, 192
    s_lshl_b32 s23, s23, 6
    s_mul_i32 s64, s4, 110592
    s_add_u32 s23, s23, s64
    s_mov_b32 s24, s23
    s_mov_b32 s12, s80
    s_mov_b32 s13, s81
    s_mov_b32 s16, s82
    s_mov_b32 s17, s83
    s_cmp_lt_u32 s21, 246
    s_cselect_b32 s14, 2211840, 0
    s_mov_b32 s18, s14
    s_mov_b32 s30, 55296
    v_mov_b32 v2, v4
G_T_a2_d:
G_T_a2_n:
    v_mfma_f32_32x32x16_bf16 v[64:79], v[16:19], a[228:231], v[64:79]
    ds_read_b64_tr_b16 v[10:11], v1 offset:2304
    s_waitcnt lgkmcnt(2)
    v_mfma_f32_32x32x16_bf16 v[48:63], v[20:23], a[68:71], v[48:63]
    ds_read_b64_tr_b16 v[12:13], v1 offset:10240
    v_mfma_f32_32x32x16_bf16 v[80:95], v[20:23], a[228:231], v[80:95]
    ds_read_b64_tr_b16 v[14:15], v1 offset:10496
    s_waitcnt lgkmcnt(2)
    v_mfma_f32_32x32x16_bf16 v[32:47], v[8:11], a[72:75], v[32:47]
    ds_read_b64_tr_b16 v[16:17], v1 offset:3072
    v_mfma_f32_32x32x16_bf16 v[64:79], v[8:11], a[232:235], v[64:79]
    ds_read_b64_tr_b16 v[18:19], v1 offset:3328
    s_waitcnt lgkmcnt(2)
    v_mfma_f32_32x32x16_bf16 v[48:63], v[12:15], a[72:75], v[48:63]
    ds_read_b64_tr_b16 v[20:21], v1 offset:11264
    v_mfma_f32_32x32x16_bf16 v[80:95], v[12:15], a[232:235], v[80:95]
    ds_read_b64_tr_b16 v[22:23], v1 offset:11520
    s_waitcnt lgkmcnt(2)
    v_mfma_f32_32x32x16_bf16 v[32:47], v[16:19], a[76:79], v[32:47]
    ds_read_b64_tr_b16 v[8:9], v1 offset:4096
    v_mfma_f32_32x32x16_bf16 v[64:79], v[16:19], a[236:239], v[64:79]
    ds_read_b64_tr_b16 v[10:11], v1 offset:4352
    s_waitcnt lgkmcnt(2)
    v_mfma_f32_32x32x16_bf16 v[48:63], v[20:23], a[76:79], v[48:63]
    ds_read_b64_tr_b16 v[12:13], v1 offset:12288
    v_mfma_f32_32x32x16_bf16 v[80:95], v[20:23], a[236:239], v[80:95]
    ds_read_b64_tr_b16 v[14:15], v1 offset:12544
    s_waitcnt lgkmcnt(2)
    v_mfma_f32_32x32x16_bf16 v[32:47], v[8:11], a[80:83], v[32:47]
    ds_read_b64_tr_b16 v[16:17], v1 offset:5120
    v_mfma_f32_32x32x16_bf16 v[64:79], v[8:11], a[240:243], v[64:79]
    ds_read_b64_tr_b16 v[18:19], v1 offset:5376
    s_waitcnt lgkmcnt(2)
    v_mfma_f32_32x32x16_bf16 v[48:63], v[12:15], a[80:83], v[48:63]
    ds_read_b64_tr_b16 v[20:21], v1 offset:13312
    v_mfma_f32_32x32x16_bf16 v[80:95], v[12:15], a[240:243], v[80:95]
    ds_read_b64_tr_b16 v[22:23], v1 offset:13568
    s_waitcnt lgkmcnt(2)
    v_mfma_f32_32x32x16_bf16 v[32:47], v[16:19], a[84:87], v[32:47]
    ds_read_b64_tr_b16 v[8:9], v1 offset:6144
    v_mfma_f32_32x32x16_bf16 v[64:79], v[16:19], a[244:247], v[64:79]
    ds_read_b64_tr_b16 v[10:11], v1 offset:6400
    s_waitcnt lgkmcnt(2)
    v_mfma_f32_32x32x16_bf16 v[48:63], v[20:23], a[84:87], v[48:63]
    ds_read_b64_tr_b16 v[12:13], v1 offset:14336
    v_mfma_f32_32x32x16_bf16 v[80:95], v[20:23], a[244:247], v[80:95]
    ds_read_b64_tr_b16 v[14:15], v1 offset:14592
    s_waitcnt lgkmcnt(2)
    v_mfma_f32_32x32x16_bf16 v[32:47], v[8:11], a[88:91], v[32:47]
    ds_read_b64_tr_b16 v[16:17], v1 offset:7168
    v_mfma_f32_32x32x16_bf16 v[64:79], v[8:11], a[248:251], v[64:79]
    ds_read_b64_tr_b16 v[18:19], v1 offset:7424
    s_waitcnt lgkmcnt(2)
    v_mfma_f32_32x32x16_bf16 v[48:63], v[12:15], a[88:91], v[48:63]
    ds_read_b64_tr_b16 v[20:21], v1 offset:15360
    v_mfma_f32_32x32x16_bf16 v[80:95], v[12:15], a[248:251], v[80:95]
    ds_read_b64_tr_b16 v[22:23], v1 offset:15616
    s_waitcnt lgkmcnt(2)
    v_mfma_f32_32x32x16_bf16 v[32:47], v[16:19], a[92:95], v[32:47]
    s_waitcnt vmcnt(8) lgkmcnt(0)
    v_add_u32 v1, 0x4000, v1
    s_barrier
    v_and_b32 v1, 0xffff, v1
    ds_read_b64_tr_b16 v[8:9], v1 offset:0
    v_mfma_f32_32x32x16_bf16 v[64:79], v[16:19], a[252:255], v[64:79]
    ds_read_b64_tr_b16 v[10:11], v1 offset:256
    v_mfma_f32_32x32x16_bf16 v[48:63], v[20:23], a[92:95], v[48:63]
    ds_read_b64_tr_b16 v[12:13], v1 offset:8192
    v_mfma_f32_32x32x16_bf16 v[80:95], v[20:23], a[252:255], v[80:95]
    ds_read_b64_tr_b16 v[14:15], v1 offset:8448
    s_waitcnt lgkmcnt(2)
    v_mfma_f32_32x32x16_bf16 v[32:47], v[8:11], a[96:99], v[32:47]
    ds_read_b64_tr_b16 v[16:17], v1 offset:1024
    s_add_u32 m0, s27, 0
    s_nop 0
    buffer_load_dwordx4 v2, s[12:15], s23 offen lds
    v_mfma_f32_32x32x16_bf16 v[64:79], v[8:11], v[192:195], v[64:79]
    ds_read_b64_tr_b16 v[18:19], v1 offset:1280
    s_add_u32 m0, s27, 8192
    s_nop 0
    buffer_load_dwordx4 v2, s[16:19], s24 offen lds
    s_waitcnt lgkmcnt(2)
    v_mfma_f32_32x32x16_bf16 v[48:63], v[12:15], a[96:99], v[48:63]
    ds_read_b64_tr_b16 v[20:21], v1 offset:9216
    s_add_u32 m0, s27, 1024
    s_add_u32 s64, s23, s30
    buffer_load_dwordx4 v2, s[12:15], s64 offen lds
    v_mfma_f32_32x32x16_bf16 v[80:95], v[12:15], v[192:195], v[80:95]
    ds_read_b64_tr_b16 v[22:23], v1 offset:9472
    s_add_u32 m0, s27, 9216
    s_add_u32 s64, s24, s30
    buffer_load_dwordx4 v2, s[16:19], s64 offen lds
    s_waitcnt lgkmcnt(2)
    v_mfma_f32_32x32x16_bf16 v[32:47], v[16:19], a[100:103], v[32:47]
    ds_read_b64_tr_b16 v[8:9], v1 offset:2048
    s_lshl_b32 s64, s30, 3
    s_add_u32 s23, s23, s64
    s_add_u32 s24, s24, s64
    s_add_u32 s27, s27, 16384
    s_and_b32 s27, s27, 0xffff
    s_add_u32 s22, s22, 1
    s_cmp_lt_u32 s22, 5
    s_cbranch_scc1 G_T_a3_n
    s_add_u32 s21, s21, 12
    s_mov_b32 s22, 0
    s_cmp_ge_u32 s21, 192
    s_cbranch_scc1 G_T_a3_f
    s_mov_b32 s12, s72
    s_mov_b32 s13, s73
    s_and_b32 s23, s21, 63
    s_lshl_b32 s23, s23, 7
    s_lshl_b32 s64, s4, 18
    s_add_u32 s23, s23, s64
    s_add_u32 s24, s23, 64
    s_mov_b32 s16, s12
    s_mov_b32 s17, s13
    s_mov_b32 s14, 5242880
    s_mov_b32 s18, 5242880
    s_mov_b32 s30, 131072
    v_mov_b32 v2, v3
    s_branch G_T_a3_d
G_T_a3_f:
    s_sub_u32 s23, s21, 192
    s_lshl_b32 s23, s23, 6
    s_mul_i32 s64, s4, 110592
    s_add_u32 s23, s23, s64
    s_mov_b32 s24, s23
    s_mov_b32 s12, s80
    s_mov_b32 s13, s81
    s_mov_b32 s16, s82
    s_mov_b32 s17, s83
    s_cmp_lt_u32 s21, 246
    s_cselect_b32 s14, 2211840, 0
    s_mov_b32 s18, s14
    s_mov_b32 s30, 55296
    v_mov_b32 v2, v4
G_T_a3_d:
G_T_a3_n:
    v_mfma_f32_32x32x16_bf16 v[64:79], v[16:19], v[196:199], v[64:79]
    ds_read_b64_tr_b16 v[10:11], v1 offset:2304
    s_waitcnt lgkmcnt(2)
    v_mfma_f32_32x32x16_bf16 v[48:63], v[20:23], a[100:103], v[48:63]
    ds_read_b64_tr_b16 v[12:13], v1 offset:10240
    v_mfma_f32_32x32x16_bf16 v[80:95], v[20:23], v[196:199], v[80:95]
    ds_read_b64_tr_b16 v[14:15], v1 offset:10496
    s_waitcnt lgkmcnt(2)
    v_mfma_f32_32x32x16_bf16 v[32:47], v[8:11], a[104:107], v[32:47]
    ds_read_b64_tr_b16 v[16:17], v1 offset:3072
    v_mfma_f32_32x32x16_bf16 v[64:79], v[8:11], v[200:203], v[64:79]
    ds_read_b64_tr_b16 v[18:19], v1 offset:3328
    s_waitcnt lgkmcnt(2)
    v_mfma_f32_32x32x16_bf16 v[48:63], v[12:15], a[104:107], v[48:63]
    ds_read_b64_tr_b16 v[20:21], v1 offset:11264
    v_mfma_f32_32x32x16_bf16 v[80:95], v[12:15], v[200:203], v[80:95]
    ds_read_b64_tr_b16 v[22:23], v1 offset:11520
    s_waitcnt lgkmcnt(2)
    v_mfma_f32_32x32x16_bf16 v[32:47], v[16:19], a[108:111], v[32:47]
    ds_read_b64_tr_b16 v[8:9], v1 offset:4096
    v_mfma_f32_32x32x16_bf16 v[64:79], v[16:19], v[204:207], v[64:79]
    ds_read_b64_tr_b16 v[10:11], v1 offset:4352
    s_waitcnt lgkmcnt(2)
    v_mfma_f32_32x32x16_bf16 v[48:63], v[20:23], a[108:111], v[48:63]
    ds_read_b64_tr_b16 v[12:13], v1 offset:12288
    v_mfma_f32_32x32x16_bf16 v[80:95], v[20:23], v[204:207], v[80:95]
    ds_read_b64_tr_b16 v[14:15], v1 offset:12544
    s_waitcnt lgkmcnt(2)
    v_mfma_f32_32x32x16_bf16 v[32:47], v[8:11], a[112:115], v[32:47]
    ds_read_b64_tr_b16 v[16:17], v1 offset:5120
    v_mfma_f32_32x32x16_bf16 v[64:79], v[8:11], v[208:211], v[64:79]
    ds_read_b64_tr_b16 v[18:19], v1 offset:5376
    s_waitcnt lgkmcnt(2)
    v_mfma_f32_32x32x16_bf16 v[48:63], v[12:15], a[112:115], v[48:63]
    ds_read_b64_tr_b16 v[20:21], v1 offset:13312
    v_mfma_f32_32x32x16_bf16 v[80:95], v[12:15], v[208:211], v[80:95]
    ds_read_b64_tr_b16 v[22:23], v1 offset:13568
    s_waitcnt lgkmcnt(2)
    v_mfma_f32_32x32x16_bf16 v[32:47], v[16:19], a[116:119], v[32:47]
    ds_read_b64_tr_b16 v[8:9], v1 offset:6144
    v_mfma_f32_32x32x16_bf16 v[64:79], v[16:19], v[212:215], v[64:79]
    ds_read_b64_tr_b16 v[10:11], v1 offset:6400
    s_waitcnt lgkmcnt(2)
    v_mfma_f32_32x32x16_bf16 v[48:63], v[20:23], a[116:119], v[48:63]
    ds_read_b64_tr_b16 v[12:13], v1 offset:14336
    v_mfma_f32_32x32x16_bf16 v[80:95], v[20:23], v[212:215], v[80:95]
    ds_read_b64_tr_b16 v[14:15], v1 offset:14592
    s_waitcnt lgkmcnt(2)
    v_mfma_f32_32x32x16_bf16 v[32:47], v[8:11], a[120:123], v[32:47]
    ds_read_b64_tr_b16 v[16:17], v1 offset:7168
    v_mfma_f32_32x32x16_bf16 v[64:79], v[8:11], v[216:219], v[64:79]
    ds_read_b64_tr_b16 v[18:19], v1 offset:7424
    s_waitcnt lgkmcnt(2)
    v_mfma_f32_32x32x16_bf16 v[48:63], v[12:15], a[120:123], v[48:63]
    ds_read_b64_tr_b16 v[20:21], v1 offset:15360
    v_mfma_f32_32x32x16_bf16 v[80:95], v[12:15], v[216:219], v[80:95]
    ds_read_b64_tr_b16 v[22:23], v1 offset:15616
    s_waitcnt lgkmcnt(2)
    v_mfma_f32_32x32x16_bf16 v[32:47], v[16:19], a[124:127], v[32:47]
    s_waitcnt vmcnt(8) lgkmcnt(0)
    v_add_u32 v1, 0x4000, v1
    s_barrier
    v_and_b32 v1, 0xffff, v1
    ds_read_b64_tr_b16 v[8:9], v1 offset:0
    v_mfma_f32_32x32x16_bf16 v[64:79], v[16:19], v[220:223], v[64:79]
    ds_read_b64_tr_b16 v[10:11], v1 offset:256
    v_mfma_f32_32x32x16_bf16 v[48:63], v[20:23], a[124:127], v[48:63]
    ds_read_b64_tr_b16 v[12:13], v1 offset:8192
    v_mfma_f32_32x32x16_bf16 v[80:95], v[20:23], v[220:223], v[80:95]
    ds_read_b64_tr_b16 v[14:15], v1 offset:8448
    s_waitcnt lgkmcnt(2)
    v_mfma_f32_32x32x16_bf16 v[32:47], v[8:11], a[128:131], v[32:47]
    ds_read_b64_tr_b16 v[16:17], v1 offset:1024
    s_add_u32 m0, s27, 0
    s_nop 0
    buffer_load_dwordx4 v2, s[12:15], s23 offen lds
    v_mfma_f32_32x32x16_bf16 v[64:79], v[8:11], v[224:227], v[64:79]
    ds_read_b64_tr_b16 v[18:19], v1 offset:1280
    s_add_u32 m0, s27, 8192
    s_nop 0
    buffer_load_dwordx4 v2, s[16:19], s24 offen lds
    s_waitcnt lgkmcnt(2)
    v_mfma_f32_32x32x16_bf16 v[48:63], v[12:15], a[128:131], v[48:63]
    ds_read_b64_tr_b16 v[20:21], v1 offset:9216
    s_add_u32 m0, s27, 1024
    s_add_u32 s64, s23, s30
    buffer_load_dwordx4 v2, s[12:15], s64 offen lds
    v_mfma_f32_32x32x16_bf16 v[80:95], v[12:15], v[224:227], v[80:95]
    ds_read_b64_tr_b16 v[22:23], v1 offset:9472
    s_add_u32 m0, s27, 9216
    s_add_u32 s64, s24, s30
    buffer_load_dwordx4 v2, s[16:19], s64 offen lds
    s_waitcnt lgkmcnt(2)
    v_mfma_f32_32x32x16_bf16 v[32:47], v[16:19], a[132:135], v[32:47]
    ds_read_b64_tr_b16 v[8:9], v1 offset:2048
    s_lshl_b32 s64, s30, 3
    s_add_u32 s23, s23, s64
    s_add_u32 s24, s24, s64
    s_add_u32 s27, s27, 16384
    s_and_b32 s27, s27, 0xffff
    s_add_u32 s22, s22, 1
    s_cmp_lt_u32 s22, 5
    s_cbranch_scc1 G_T_a4_n
    s_add_u32 s21, s21, 12
    s_mov_b32 s22, 0
    s_cmp_ge_u32 s21, 192
    s_cbranch_scc1 G_T_a4_f
    s_mov_b32 s12, s72
    s_mov_b32 s13, s73
    s_and_b32 s23, s21, 63
    s_lshl_b32 s23, s23, 7
    s_lshl_b32 s64, s4, 18
    s_add_u32 s23, s23, s64
    s_add_u32 s24, s23, 64
    s_mov_b32 s16, s12
    s_mov_b32 s17, s13
    s_mov_b32 s14, 5242880
    s_mov_b32 s18, 5242880
    s_mov_b32 s30, 131072
    v_mov_b32 v2, v3
    s_branch G_T_a4_d
G_T_a4_f:
    s_sub_u32 s23, s21, 192
    s_lshl_b32 s23, s23, 6
    s_mul_i32 s64, s4, 110592
    s_add_u32 s23, s23, s64
    s_mov_b32 s24, s23
    s_mov_b32 s12, s80
    s_mov_b32 s13, s81
    s_mov_b32 s16, s82
    s_mov_b32 s17, s83
    s_cmp_lt_u32 s21, 246
    s_cselect_b32 s14, 2211840, 0
    s_mov_b32 s18, s14
    s_mov_b32 s30, 55296
    v_mov_b32 v2, v4
G_T_a4_d:
G_T_a4_n:
    v_mfma_f32_32x32x16_bf16 v[64:79], v[16:19], v[228:231], v[64:79]
    ds_read_b64_tr_b16 v[10:11], v1 offset:2304
    s_waitcnt lgkmcnt(2)
    v_mfma_f32_32x32x16_bf16 v[48:63], v[20:23], a[132:135], v[48:63]
    ds_read_b64_tr_b16 v[12:13], v1 offset:10240
    v_mfma_f32_32x32x16_bf16 v[80:95], v[20:23], v[228:231], v[80:95]
    ds_read_b64_tr_b16 v[14:15], v1 offset:10496
    s_waitcnt lgkmcnt(2)
    v_mfma_f32_32x32x16_bf16 v[32:47], v[8:11], a[136:139], v[32:47]
    ds_read_b64_tr_b16 v[16:17], v1 offset:3072
    v_mfma_f32_32x32x16_bf16 v[64:79], v[8:11], v[232:235], v[64:79]
    ds_read_b64_tr_b16 v[18:19], v1 offset:3328
    s_waitcnt lgkmcnt(2)
    v_mfma_f32_32x32x16_bf16 v[48:63], v[12:15], a[136:139], v[48:63]
    ds_read_b64_tr_b16 v[20:21], v1 offset:11264
    v_mfma_f32_32x32x16_bf16 v[80:95], v[12:15], v[232:235], v[80:95]
    ds_read_b64_tr_b16 v[22:23], v1 offset:11520
    s_waitcnt lgkmcnt(2)
    v_mfma_f32_32x32x16_bf16 v[32:47], v[16:19], a[140:143], v[32:47]
    ds_read_b64_tr_b16 v[8:9], v1 offset:4096
    v_mfma_f32_32x32x16_bf16 v[64:79], v[16:19], v[236:239], v[64:79]
    ds_read_b64_tr_b16 v[10:11], v1 offset:4352
    s_waitcnt lgkmcnt(2)
    v_mfma_f32_32x32x16_bf16 v[48:63], v[20:23], a[140:143], v[48:63]
    ds_read_b64_tr_b16 v[12:13], v1 offset:12288
    v_mfma_f32_32x32x16_bf16 v[80:95], v[20:23], v[236:239], v[80:95]
    ds_read_b64_tr_b16 v[14:15], v1 offset:12544
    s_waitcnt lgkmcnt(2)
    v_mfma_f32_32x32x16_bf16 v[32:47], v[8:11], a[144:147], v[32:47]
    ds_read_b64_tr_b16 v[16:17], v1 offset:5120
    v_mfma_f32_32x32x16_bf16 v[64:79], v[8:11], v[240:243], v[64:79]
    ds_read_b64_tr_b16 v[18:19], v1 offset:5376
    s_waitcnt lgkmcnt(2)
    v_mfma_f32_32x32x16_bf16 v[48:63], v[12:15], a[144:147], v[48:63]
    ds_read_b64_tr_b16 v[20:21], v1 offset:13312
    v_mfma_f32_32x32x16_bf16 v[80:95], v[12:15], v[240:243], v[80:95]
    ds_read_b64_tr_b16 v[22:23], v1 offset:13568
    s_waitcnt lgkmcnt(2)
    v_mfma_f32_32x32x16_bf16 v[32:47], v[16:19], a[148:151], v[32:47]
    ds_read_b64_tr_b16 v[8:9], v1 offset:6144
    v_mfma_f32_32x32x16_bf16 v[64:79], v[16:19], v[244:247], v[64:79]
    ds_read_b64_tr_b16 v[10:11], v1 offset:6400
    s_waitcnt lgkmcnt(2)
    v_mfma_f32_32x32x16_bf16 v[48:63], v[20:23], a[148:151], v[48:63]
    ds_read_b64_tr_b16 v[12:13], v1 offset:14336
    v_mfma_f32_32x32x16_bf16 v[80:95], v[20:23], v[244:247], v[80:95]
    ds_read_b64_tr_b16 v[14:15], v1 offset:14592
    s_waitcnt lgkmcnt(2)
    v_mfma_f32_32x32x16_bf16 v[32:47], v[8:11], a[152:155], v[32:47]
    ds_read_b64_tr_b16 v[16:17], v1 offset:7168
    v_mfma_f32_32x32x16_bf16 v[64:79], v[8:11], v[248:251], v[64:79]
    ds_read_b64_tr_b16 v[18:19], v1 offset:7424
    s_waitcnt lgkmcnt(2)
    v_mfma_f32_32x32x16_bf16 v[48:63], v[12:15], a[152:155], v[48:63]
    ds_read_b64_tr_b16 v[20:21], v1 offset:15360
    v_mfma_f32_32x32x16_bf16 v[80:95], v[12:15], v[248:251], v[80:95]
    ds_read_b64_tr_b16 v[22:23], v1 offset:15616
    s_waitcnt lgkmcnt(2)
    v_mfma_f32_32x32x16_bf16 v[32:47], v[16:19], a[156:159], v[32:47]
    s_waitcnt vmcnt(8) lgkmcnt(0)
    v_add_u32 v1, 0x4000, v1
    s_barrier
    v_and_b32 v1, 0xffff, v1
    ds_read_b64_tr_b16 v[8:9], v1 offset:0
    v_mfma_f32_32x32x16_bf16 v[64:79], v[16:19], v[252:255], v[64:79]
    ds_read_b64_tr_b16 v[10:11], v1 offset:256
    v_mfma_f32_32x32x16_bf16 v[48:63], v[20:23], a[156:159], v[48:63]
    ds_read_b64_tr_b16 v[12:13], v1 offset:8192
    v_mfma_f32_32x32x16_bf16 v[80:95], v[20:23], v[252:255], v[80:95]
    ds_read_b64_tr_b16 v[14:15], v1 offset:8448
    s_cmp_ge_u32 s20, 192
    s_cbranch_scc1 G_isf
    s_lshl_b32 s64, s20, 12
    s_add_u32 s64, s64, 33030144
    s_mov_b32 s65, 0x40000
    s_lshl_b32 s28, s31, 18
    s_add_u32 s28, s28, s64
    s_nop 3
    v_cvt_pk_bf16_f32 v96, v32, v33
    v_cvt_pk_bf16_f32 v97, v34, v35
    v_cvt_pk_bf16_f32 v98, v36, v37
    v_cvt_pk_bf16_f32 v99, v38, v39
    v_cvt_pk_bf16_f32 v100, v40, v41
    v_cvt_pk_bf16_f32 v101, v42, v43
    v_cvt_pk_bf16_f32 v102, v44, v45
    v_cvt_pk_bf16_f32 v103, v46, v47
    buffer_store_dwordx4 v[96:99], v0, s[8:11], s28 offen offset:0 sc1
    buffer_store_dwordx4 v[100:103], v0, s[8:11], s28 offen offset:1024 sc1
    v_cvt_pk_bf16_f32 v104, v48, v49
    v_cvt_pk_bf16_f32 v105, v50, v51
    v_cvt_pk_bf16_f32 v106, v52, v53
    v_cvt_pk_bf16_f32 v107, v54, v55
    v_cvt_pk_bf16_f32 v108, v56, v57
    v_cvt_pk_bf16_f32 v109, v58, v59
    v_cvt_pk_bf16_f32 v110, v60, v61
    v_cvt_pk_bf16_f32 v111, v62, v63
    buffer_store_dwordx4 v[104:107], v0, s[8:11], s28 offen offset:2048 sc1
    buffer_store_dwordx4 v[108:111], v0, s[8:11], s28 offen offset:3072 sc1
    s_add_u32 s28, s28, s65
    v_cvt_pk_bf16_f32 v112, v64, v65
    v_cvt_pk_bf16_f32 v113, v66, v67
    v_cvt_pk_bf16_f32 v114, v68, v69
    v_cvt_pk_bf16_f32 v115, v70, v71
    v_cvt_pk_bf16_f32 v116, v72, v73
    v_cvt_pk_bf16_f32 v117, v74, v75
    v_cvt_pk_bf16_f32 v118, v76, v77
    v_cvt_pk_bf16_f32 v119, v78, v79
    buffer_store_dwordx4 v[112:115], v0, s[8:11], s28 offen offset:0 sc1
    buffer_store_dwordx4 v[116:119], v0, s[8:11], s28 offen offset:1024 sc1
    v_cvt_pk_bf16_f32 v120, v80, v81
    v_cvt_pk_bf16_f32 v121, v82, v83
    v_cvt_pk_bf16_f32 v122, v84, v85
    v_cvt_pk_bf16_f32 v123, v86, v87
    v_cvt_pk_bf16_f32 v124, v88, v89
    v_cvt_pk_bf16_f32 v125, v90, v91
    v_cvt_pk_bf16_f32 v126, v92, v93
    v_cvt_pk_bf16_f32 v127, v94, v95
    buffer_store_dwordx4 v[120:123], v0, s[8:11], s28 offen offset:2048 sc1
    buffer_store_dwordx4 v[124:127], v0, s[8:11], s28 offen offset:3072 sc1
    s_branch G_next
G_isf:
    s_mul_i32 s28, s31, 110592
    s_lshl_b32 s64, s20, 11
    s_add_u32 s28, s28, s64
    s_add_u32 s28, s28, 70909952
    s_nop 7
    s_mov_b32 s66, 0xc0135761
    s_mov_b32 s67, 0xbdd2d3e8
    v_mov_b32 v5, s66
    v_cvt_pk_bf16_f32 v120, v32, v33
    v_cvt_pk_bf16_f32 v121, v34, v35
    v_cvt_pk_bf16_f32 v122, v36, v37
    v_cvt_pk_bf16_f32 v123, v38, v39
    v_lshlrev_b32 v32, 16, v120
    v_and_b32 v33, 0xffff0000, v120
    v_lshlrev_b32 v34, 16, v121
    v_and_b32 v35, 0xffff0000, v121
    v_lshlrev_b32 v36, 16, v122
    v_and_b32 v37, 0xffff0000, v122
    v_lshlrev_b32 v38, 16, v123
    v_and_b32 v39, 0xffff0000, v123
    v_cvt_pk_bf16_f32 v120, v48, v49
    v_cvt_pk_bf16_f32 v121, v50, v51
    v_cvt_pk_bf16_f32 v122, v52, v53
    v_cvt_pk_bf16_f32 v123, v54, v55
    v_lshlrev_b32 v48, 16, v120
    v_and_b32 v49, 0xffff0000, v120
    v_lshlrev_b32 v50, 16, v121
    v_and_b32 v51, 0xffff0000, v121
    v_lshlrev_b32 v52, 16, v122
    v_and_b32 v53, 0xffff0000, v122
    v_lshlrev_b32 v54, 16, v123
    v_and_b32 v55, 0xffff0000, v123
    v_mul_f32 v112, v32, v32
    v_mul_f32 v113, v33, v33
    v_mul_f32 v114, v34, v34
    v_mul_f32 v115, v35, v35
    v_mul_f32 v116, v36, v36
    v_mul_f32 v117, v37, v37
    v_mul_f32 v118, v38, v38
    v_mul_f32 v119, v39, v39
    v_fma_f32 v112, v112, s67, v5
    v_fma_f32 v113, v113, s67, v5
    v_fma_f32 v114, v114, s67, v5
    v_fma_f32 v115, v115, s67, v5
    v_fma_f32 v116, v116, s67, v5
    v_fma_f32 v117, v117, s67, v5
    v_fma_f32 v118, v118, s67, v5
    v_fma_f32 v119, v119, s67, v5
    v_mul_f32 v112, v112, v32
    v_mul_f32 v113, v113, v33
    v_mul_f32 v114, v114, v34
    v_mul_f32 v115, v115, v35
    v_mul_f32 v116, v116, v36
    v_mul_f32 v117, v117, v37
    v_mul_f32 v118, v118, v38
    v_mul_f32 v119, v119, v39
    v_exp_f32 v112, v112
    v_exp_f32 v113, v113
    v_exp_f32 v114, v114
    v_exp_f32 v115, v115
    v_exp_f32 v116, v116
    v_exp_f32 v117, v117
    v_exp_f32 v118, v118
    v_exp_f32 v119, v119
    v_add_f32 v112, 1.0, v112
    v_add_f32 v113, 1.0, v113
    v_add_f32 v114, 1.0, v114
    v_add_f32 v115, 1.0, v115
    v_add_f32 v116, 1.0, v116
    v_add_f32 v117, 1.0, v117
    v_add_f32 v118, 1.0, v118
    v_add_f32 v119, 1.0, v119
    v_rcp_f32 v112, v112
    v_rcp_f32 v113, v113
    v_rcp_f32 v114, v114
    v_rcp_f32 v115, v115
    v_rcp_f32 v116, v116
    v_rcp_f32 v117, v117
    v_rcp_f32 v118, v118
    v_rcp_f32 v119, v119
    v_mul_f32 v32, v32, v112
    v_mul_f32 v33, v33, v113
    v_mul_f32 v34, v34, v114
    v_mul_f32 v35, v35, v115
    v_mul_f32 v36, v36, v116
    v_mul_f32 v37, v37, v117
    v_mul_f32 v38, v38, v118
    v_mul_f32 v39, v39, v119
    v_cvt_pk_bf16_f32 v120, v32, v33
    v_cvt_pk_bf16_f32 v121, v34, v35
    v_cvt_pk_bf16_f32 v122, v36, v37
    v_cvt_pk_bf16_f32 v123, v38, v39
    v_lshlrev_b32 v32, 16, v120
    v_and_b32 v33, 0xffff0000, v120
    v_lshlrev_b32 v34, 16, v121
    v_and_b32 v35, 0xffff0000, v121
    v_lshlrev_b32 v36, 16, v122
    v_and_b32 v37, 0xffff0000, v122
    v_lshlrev_b32 v38, 16, v123
    v_and_b32 v39, 0xffff0000, v123
    v_mul_f32 v32, v32, v48
    v_mul_f32 v33, v33, v49
    v_mul_f32 v34, v34, v50
    v_mul_f32 v35, v35, v51
    v_mul_f32 v36, v36, v52
    v_mul_f32 v37, v37, v53
    v_mul_f32 v38, v38, v54
    v_mul_f32 v39, v39, v55
    v_cvt_pk_bf16_f32 v96, v32, v33
    v_cvt_pk_bf16_f32 v97, v34, v35
    v_cvt_pk_bf16_f32 v98, v36, v37
    v_cvt_pk_bf16_f32 v99, v38, v39
    buffer_store_dwordx4 v[96:99], v0, s[8:11], s28 offen offset:0 sc1
    v_cvt_pk_bf16_f32 v120, v40, v41
    v_cvt_pk_bf16_f32 v121, v42, v43
    v_cvt_pk_bf16_f32 v122, v44, v45
    v_cvt_pk_bf16_f32 v123, v46, v47
    v_lshlrev_b32 v40, 16, v120
    v_and_b32 v41, 0xffff0000, v120
    v_lshlrev_b32 v42, 16, v121
    v_and_b32 v43, 0xffff0000, v121
    v_lshlrev_b32 v44, 16, v122
    v_and_b32 v45, 0xffff0000, v122
    v_lshlrev_b32 v46, 16, v123
    v_and_b32 v47, 0xffff0000, v123
    v_cvt_pk_bf16_f32 v120, v56, v57
    v_cvt_pk_bf16_f32 v121, v58, v59
    v_cvt_pk_bf16_f32 v122, v60, v61
    v_cvt_pk_bf16_f32 v123, v62, v63
    v_lshlrev_b32 v56, 16, v120
    v_and_b32 v57, 0xffff0000, v120
    v_lshlrev_b32 v58, 16, v121
    v_and_b32 v59, 0xffff0000, v121
    v_lshlrev_b32 v60, 16, v122
    v_and_b32 v61, 0xffff0000, v122
    v_lshlrev_b32 v62, 16, v123
    v_and_b32 v63, 0xffff0000, v123
    v_mul_f32 v112, v40, v40
    v_mul_f32 v113, v41, v41
    v_mul_f32 v114, v42, v42
    v_mul_f32 v115, v43, v43
    v_mul_f32 v116, v44, v44
    v_mul_f32 v117, v45, v45
    v_mul_f32 v118, v46, v46
    v_mul_f32 v119, v47, v47
    v_fma_f32 v112, v112, s67, v5
    v_fma_f32 v113, v113, s67, v5
    v_fma_f32 v114, v114, s67, v5
    v_fma_f32 v115, v115, s67, v5
    v_fma_f32 v116, v116, s67, v5
    v_fma_f32 v117, v117, s67, v5
    v_fma_f32 v118, v118, s67, v5
    v_fma_f32 v119, v119, s67, v5
    v_mul_f32 v112, v112, v40
    v_mul_f32 v113, v113, v41
    v_mul_f32 v114, v114, v42
    v_mul_f32 v115, v115, v43
    v_mul_f32 v116, v116, v44
    v_mul_f32 v117, v117, v45
    v_mul_f32 v118, v118, v46
    v_mul_f32 v119, v119, v47
    v_exp_f32 v112, v112
    v_exp_f32 v113, v113
    v_exp_f32 v114, v114
    v_exp_f32 v115, v115
    v_exp_f32 v116, v116
    v_exp_f32 v117, v117
    v_exp_f32 v118, v118
    v_exp_f32 v119, v119
    v_add_f32 v112, 1.0, v112
    v_add_f32 v113, 1.0, v113
    v_add_f32 v114, 1.0, v114
    v_add_f32 v115, 1.0, v115
    v_add_f32 v116, 1.0, v116
    v_add_f32 v117, 1.0, v117
    v_add_f32 v118, 1.0, v118
    v_add_f32 v119, 1.0, v119
    v_rcp_f32 v112, v112
    v_rcp_f32 v113, v113
    v_rcp_f32 v114, v114
    v_rcp_f32 v115, v115
    v_rcp_f32 v116, v116
    v_rcp_f32 v117, v117
    v_rcp_f32 v118, v118
    v_rcp_f32 v119, v119
    v_mul_f32 v40, v40, v112
    v_mul_f32 v41, v41, v113
    v_mul_f32 v42, v42, v114
    v_mul_f32 v43, v43, v115
    v_mul_f32 v44, v44, v116
    v_mul_f32 v45, v45, v117
    v_mul_f32 v46, v46, v118
    v_mul_f32 v47, v47, v119
    v_cvt_pk_bf16_f32 v120, v40, v41
    v_cvt_pk_bf16_f32 v121, v42, v43
    v_cvt_pk_bf16_f32 v122, v44, v45
    v_cvt_pk_bf16_f32 v123, v46, v47
    v_lshlrev_b32 v40, 16, v120
    v_and_b32 v41, 0xffff0000, v120
    v_lshlrev_b32 v42, 16, v121
    v_and_b32 v43, 0xffff0000, v121
    v_lshlrev_b32 v44, 16, v122
    v_and_b32 v45, 0xffff0000, v122
    v_lshlrev_b32 v46, 16, v123
    v_and_b32 v47, 0xffff0000, v123
    v_mul_f32 v40, v40, v56
    v_mul_f32 v41, v41, v57
    v_mul_f32 v42, v42, v58
    v_mul_f32 v43, v43, v59
    v_mul_f32 v44, v44, v60
    v_mul_f32 v45, v45, v61
    v_mul_f32 v46, v46, v62
    v_mul_f32 v47, v47, v63
    v_cvt_pk_bf16_f32 v100, v40, v41
    v_cvt_pk_bf16_f32 v101, v42, v43
    v_cvt_pk_bf16_f32 v102, v44, v45
    v_cvt_pk_bf16_f32 v103, v46, v47
    buffer_store_dwordx4 v[100:103], v0, s[8:11], s28 offen offset:1024 sc1
    s_add_u32 s28, s28, 110592
    v_mov_b32 v5, s66
    v_cvt_pk_bf16_f32 v120, v64, v65
    v_cvt_pk_bf16_f32 v121, v66, v67
    v_cvt_pk_bf16_f32 v122, v68, v69
    v_cvt_pk_bf16_f32 v123, v70, v71
    v_lshlrev_b32 v64, 16, v120
    v_and_b32 v65, 0xffff0000, v120
    v_lshlrev_b32 v66, 16, v121
    v_and_b32 v67, 0xffff0000, v121
    v_lshlrev_b32 v68, 16, v122
    v_and_b32 v69, 0xffff0000, v122
    v_lshlrev_b32 v70, 16, v123
    v_and_b32 v71, 0xffff0000, v123
    v_cvt_pk_bf16_f32 v120, v80, v81
    v_cvt_pk_bf16_f32 v121, v82, v83
    v_cvt_pk_bf16_f32 v122, v84, v85
    v_cvt_pk_bf16_f32 v123, v86, v87
    v_lshlrev_b32 v80, 16, v120
    v_and_b32 v81, 0xffff0000, v120
    v_lshlrev_b32 v82, 16, v121
    v_and_b32 v83, 0xffff0000, v121
    v_lshlrev_b32 v84, 16, v122
    v_and_b32 v85, 0xffff0000, v122
    v_lshlrev_b32 v86, 16, v123
    v_and_b32 v87, 0xffff0000, v123
    v_mul_f32 v112, v64, v64
    v_mul_f32 v113, v65, v65
    v_mul_f32 v114, v66, v66
    v_mul_f32 v115, v67, v67
    v_mul_f32 v116, v68, v68
    v_mul_f32 v117, v69, v69
    v_mul_f32 v118, v70, v70
    v_mul_f32 v119, v71, v71
    v_fma_f32 v112, v112, s67, v5
    v_fma_f32 v113, v113, s67, v5
    v_fma_f32 v114, v114, s67, v5
    v_fma_f32 v115, v115, s67, v5
    v_fma_f32 v116, v116, s67, v5
    v_fma_f32 v117, v117, s67, v5
    v_fma_f32 v118, v118, s67, v5
    v_fma_f32 v119, v119, s67, v5
    v_mul_f32 v112, v112, v64
    v_mul_f32 v113, v113, v65
    v_mul_f32 v114, v114, v66
    v_mul_f32 v115, v115, v67
    v_mul_f32 v116, v116, v68
    v_mul_f32 v117, v117, v69
    v_mul_f32 v118, v118, v70
    v_mul_f32 v119, v119, v71
    v_exp_f32 v112, v112
    v_exp_f32 v113, v113
    v_exp_f32 v114, v114
    v_exp_f32 v115, v115
    v_exp_f32 v116, v116
    v_exp_f32 v117, v117
    v_exp_f32 v118, v118
    v_exp_f32 v119, v119
    v_add_f32 v112, 1.0, v112
    v_add_f32 v113, 1.0, v113
    v_add_f32 v114, 1.0, v114
    v_add_f32 v115, 1.0, v115
    v_add_f32 v116, 1.0, v116
    v_add_f32 v117, 1.0, v117
    v_add_f32 v118, 1.0, v118
    v_add_f32 v119, 1.0, v119
    v_rcp_f32 v112, v112
    v_rcp_f32 v113, v113
    v_rcp_f32 v114, v114
    v_rcp_f32 v115, v115
    v_rcp_f32 v116, v116
    v_rcp_f32 v117, v117
    v_rcp_f32 v118, v118
    v_rcp_f32 v119, v119
    v_mul_f32 v64, v64, v112
    v_mul_f32 v65, v65, v113
    v_mul_f32 v66, v66, v114
    v_mul_f32 v67, v67, v115
    v_mul_f32 v68, v68, v116
    v_mul_f32 v69, v69, v117
    v_mul_f32 v70, v70, v118
    v_mul_f32 v71, v71, v119
    v_cvt_pk_bf16_f32 v120, v64, v65
    v_cvt_pk_bf16_f32 v121, v66, v67
    v_cvt_pk_bf16_f32 v122, v68, v69
    v_cvt_pk_bf16_f32 v123, v70, v71
    v_lshlrev_b32 v64, 16, v120
    v_and_b32 v65, 0xffff0000, v120
    v_lshlrev_b32 v66, 16, v121
    v_and_b32 v67, 0xffff0000, v121
    v_lshlrev_b32 v68, 16, v122
    v_and_b32 v69, 0xffff0000, v122
    v_lshlrev_b32 v70, 16, v123
    v_and_b32 v71, 0xffff0000, v123
    v_mul_f32 v64, v64, v80
    v_mul_f32 v65, v65, v81
    v_mul_f32 v66, v66, v82
    v_mul_f32 v67, v67, v83
    v_mul_f32 v68, v68, v84
    v_mul_f32 v69, v69, v85
    v_mul_f32 v70, v70, v86
    v_mul_f32 v71, v71, v87
    v_cvt_pk_bf16_f32 v104, v64, v65
    v_cvt_pk_bf16_f32 v105, v66, v67
    v_cvt_pk_bf16_f32 v106, v68, v69
    v_cvt_pk_bf16_f32 v107, v70, v71
    buffer_store_dwordx4 v[104:107], v0, s[8:11], s28 offen offset:0 sc1
    v_cvt_pk_bf16_f32 v120, v72, v73
    v_cvt_pk_bf16_f32 v121, v74, v75
    v_cvt_pk_bf16_f32 v122, v76, v77
    v_cvt_pk_bf16_f32 v123, v78, v79
    v_lshlrev_b32 v72, 16, v120
    v_and_b32 v73, 0xffff0000, v120
    v_lshlrev_b32 v74, 16, v121
    v_and_b32 v75, 0xffff0000, v121
    v_lshlrev_b32 v76, 16, v122
    v_and_b32 v77, 0xffff0000, v122
    v_lshlrev_b32 v78, 16, v123
    v_and_b32 v79, 0xffff0000, v123
    v_cvt_pk_bf16_f32 v120, v88, v89
    v_cvt_pk_bf16_f32 v121, v90, v91
    v_cvt_pk_bf16_f32 v122, v92, v93
    v_cvt_pk_bf16_f32 v123, v94, v95
    v_lshlrev_b32 v88, 16, v120
    v_and_b32 v89, 0xffff0000, v120
    v_lshlrev_b32 v90, 16, v121
    v_and_b32 v91, 0xffff0000, v121
    v_lshlrev_b32 v92, 16, v122
    v_and_b32 v93, 0xffff0000, v122
    v_lshlrev_b32 v94, 16, v123
    v_and_b32 v95, 0xffff0000, v123
    v_mul_f32 v112, v72, v72
    v_mul_f32 v113, v73, v73
    v_mul_f32 v114, v74, v74
    v_mul_f32 v115, v75, v75
    v_mul_f32 v116, v76, v76
    v_mul_f32 v117, v77, v77
    v_mul_f32 v118, v78, v78
    v_mul_f32 v119, v79, v79
    v_fma_f32 v112, v112, s67, v5
    v_fma_f32 v113, v113, s67, v5
    v_fma_f32 v114, v114, s67, v5
    v_fma_f32 v115, v115, s67, v5
    v_fma_f32 v116, v116, s67, v5
    v_fma_f32 v117, v117, s67, v5
    v_fma_f32 v118, v118, s67, v5
    v_fma_f32 v119, v119, s67, v5
    v_mul_f32 v112, v112, v72
    v_mul_f32 v113, v113, v73
    v_mul_f32 v114, v114, v74
    v_mul_f32 v115, v115, v75
    v_mul_f32 v116, v116, v76
    v_mul_f32 v117, v117, v77
    v_mul_f32 v118, v118, v78
    v_mul_f32 v119, v119, v79
    v_exp_f32 v112, v112
    v_exp_f32 v113, v113
    v_exp_f32 v114, v114
    v_exp_f32 v115, v115
    v_exp_f32 v116, v116
    v_exp_f32 v117, v117
    v_exp_f32 v118, v118
    v_exp_f32 v119, v119
    v_add_f32 v112, 1.0, v112
    v_add_f32 v113, 1.0, v113
    v_add_f32 v114, 1.0, v114
    v_add_f32 v115, 1.0, v115
    v_add_f32 v116, 1.0, v116
    v_add_f32 v117, 1.0, v117
    v_add_f32 v118, 1.0, v118
    v_add_f32 v119, 1.0, v119
    v_rcp_f32 v112, v112
    v_rcp_f32 v113, v113
    v_rcp_f32 v114, v114
    v_rcp_f32 v115, v115
    v_rcp_f32 v116, v116
    v_rcp_f32 v117, v117
    v_rcp_f32 v118, v118
    v_rcp_f32 v119, v119
    v_mul_f32 v72, v72, v112
    v_mul_f32 v73, v73, v113
    v_mul_f32 v74, v74, v114
    v_mul_f32 v75, v75, v115
    v_mul_f32 v76, v76, v116
    v_mul_f32 v77, v77, v117
    v_mul_f32 v78, v78, v118
    v_mul_f32 v79, v79, v119
    v_cvt_pk_bf16_f32 v120, v72, v73
    v_cvt_pk_bf16_f32 v121, v74, v75
    v_cvt_pk_bf16_f32 v122, v76, v77
    v_cvt_pk_bf16_f32 v123, v78, v79
    v_lshlrev_b32 v72, 16, v120
    v_and_b32 v73, 0xffff0000, v120
    v_lshlrev_b32 v74, 16, v121
    v_and_b32 v75, 0xffff0000, v121
    v_lshlrev_b32 v76, 16, v122
    v_and_b32 v77, 0xffff0000, v122
    v_lshlrev_b32 v78, 16, v123
    v_and_b32 v79, 0xffff0000, v123
    v_mul_f32 v72, v72, v88
    v_mul_f32 v73, v73, v89
    v_mul_f32 v74, v74, v90
    v_mul_f32 v75, v75, v91
    v_mul_f32 v76, v76, v92
    v_mul_f32 v77, v77, v93
    v_mul_f32 v78, v78, v94
    v_mul_f32 v79, v79, v95
    v_cvt_pk_bf16_f32 v108, v72, v73
    v_cvt_pk_bf16_f32 v109, v74, v75
    v_cvt_pk_bf16_f32 v110, v76, v77
    v_cvt_pk_bf16_f32 v111, v78, v79
    buffer_store_dwordx4 v[108:111], v0, s[8:11], s28 offen offset:1024 sc1
G_next:
    s_add_u32 s20, s20, 12
    s_cmp_lt_u32 s20, 246
    s_cbranch_scc1 G_loop
    s_waitcnt vmcnt(0) lgkmcnt(0)
    s_barrier
    s_mul_i32 s64, s25, 12
    s_add_u32 s64, s64, s26
    s_lshl_b32 s64, s64, 2
    s_add_u32 s64, s64, 109052928
    s_cmp_lg_u32 s4, 0
    s_cbranch_scc1 G_end
    v_mov_b32 v5, 1
    s_mov_b64 exec, 1
    buffer_store_dword v5, off, s[8:11], s64 sc1
    s_mov_b64 exec, -1
G_end:
    s_cmp_ge_u32 s5, 28
    s_cbranch_scc1 M_done
    s_cmp_ge_u32 s5, 20
    s_cbranch_scc1 M_attn
    v_lshrrev_b32 v8, 2, v7
    v_and_b32 v9, 3, v7
    v_mul_u32_u24 v1, 1280, v8
    v_lshl_add_u32 v1, v9, 4, v1
    v_lshrrev_b32 v8, 5, v7
    v_lshlrev_b32 v10, 8, v8
    v_bfe_u32 v11, v7, 2, 2
    v_lshl_add_u32 v10, v11, 6, v10
    v_bfe_u32 v11, v7, 4, 1
    v_lshl_add_u32 v10, v11, 5, v10
    v_lshl_add_u32 v10, v9, 3, v10
    s_lshl_b32 s33, s4, 15
    v_add_u32 v2, s33, v10
    s_mov_b32 s12, s78
    s_mov_b32 s13, s79
    s_mov_b32 s14, 5242880
    s_lshl_b32 s21, s5, 6
    s_mul_i32 s32, s4, 1310720
    s_add_u32 s32, s32, s21
    s_add_u32 m0, s33, 0
    s_add_u32 s64, s32, 0
    buffer_load_dwordx4 v1, s[12:15], s64 offen lds
    s_add_u32 m0, s33, 1024
    s_add_u32 s64, s32, 20480
    buffer_load_dwordx4 v1, s[12:15], s64 offen lds
    s_waitcnt vmcnt(1)
    s_add_u32 m0, s33, 2048
    s_add_u32 s64, s32, 40960
    buffer_load_dwordx4 v1, s[12:15], s64 offen lds
    s_add_u32 m0, s33, 3072
    s_add_u32 s64, s32, 61440
    buffer_load_dwordx4 v1, s[12:15], s64 offen lds
    s_waitcnt vmcnt(1)
    s_add_u32 m0, s33, 4096
    s_add_u32 s64, s32, 81920
    buffer_load_dwordx4 v1, s[12:15], s64 offen lds
    s_add_u32 m0, s33, 5120
    s_add_u32 s64, s32, 102400
    buffer_load_dwordx4 v1, s[12:15], s64 offen lds
    s_waitcnt vmcnt(1)
    s_add_u32 m0, s33, 6144
    s_add_u32 s64, s32, 122880
    buffer_load_dwordx4 v1, s[12:15], s64 offen lds
    s_add_u32 m0, s33, 7168
    s_add_u32 s64, s32, 143360
    buffer_load_dwordx4 v1, s[12:15], s64 offen lds
    s_waitcnt vmcnt(1)
    s_waitcnt vmcnt(0)
    ds_read_b64_tr_b16 a[0:1], v2 offset:0
    ds_read_b64_tr_b16 a[2:3], v2 offset:512
    ds_read_b64_tr_b16 a[4:5], v2 offset:1024
    ds_read_b64_tr_b16 a[6:7], v2 offset:1536
    ds_read_b64_tr_b16 a[8:9], v2 offset:2048
    ds_read_b64_tr_b16 a[10:11], v2 offset:2560
    ds_read_b64_tr_b16 a[12:13], v2 offset:3072
    ds_read_b64_tr_b16 a[14:15], v2 offset:3584
    s_waitcnt lgkmcnt(0)
    ds_read_b64_tr_b16 a[16:17], v2 offset:4096
    ds_read_b64_tr_b16 a[18:19], v2 offset:4608
    ds_read_b64_tr_b16 a[20:21], v2 offset:5120
    ds_read_b64_tr_b16 a[22:23], v2 offset:5632
    ds_read_b64_tr_b16 a[24:25], v2 offset:6144
    ds_read_b64_tr_b16 a[26:27], v2 offset:6656
    ds_read_b64_tr_b16 a[28:29], v2 offset:7168
    ds_read_b64_tr_b16 a[30:31], v2 offset:7680
    s_waitcnt lgkmcnt(0)
    s_add_u32 m0, s33, 8192
    s_add_u32 s64, s32, 163840
    buffer_load_dwordx4 v1, s[12:15], s64 offen lds
    s_add_u32 m0, s33, 9216
    s_add_u32 s64, s32, 184320
    buffer_load_dwordx4 v1, s[12:15], s64 offen lds
    s_waitcnt vmcnt(1)
    s_add_u32 m0, s33, 10240
    s_add_u32 s64, s32, 204800
    buffer_load_dwordx4 v1, s[12:15], s64 offen lds
    s_add_u32 m0, s33, 11264
    s_add_u32 s64, s32, 225280
    buffer_load_dwordx4 v1, s[12:15], s64 offen lds
    s_waitcnt vmcnt(1)
    s_add_u32 m0, s33, 12288
    s_add_u32 s64, s32, 245760
    buffer_load_dwordx4 v1, s[12:15], s64 offen lds
    s_add_u32 m0, s33, 13312
    s_add_u32 s64, s32, 266240
    buffer_load_dwordx4 v1, s[12:15], s64 offen lds
    s_waitcnt vmcnt(1)
    s_add_u32 m0, s33, 14336
    s_add_u32 s64, s32, 286720
    buffer_load_dwordx4 v1, s[12:15], s64 offen lds
    s_add_u32 m0, s33, 15360
    s_add_u32 s64, s32, 307200
    buffer_load_dwordx4 v1, s[12:15], s64 offen lds
    s_waitcnt vmcnt(1)
    s_waitcnt vmcnt(0)
    ds_read_b64_tr_b16 a[32:33], v2 offset:8192
    ds_read_b64_tr_b16 a[34:35], v2 offset:8704
    ds_read_b64_tr_b16 a[36:37], v2 offset:9216
    ds_read_b64_tr_b16 a[38:39], v2 offset:9728
    ds_read_b64_tr_b16 a[40:41], v2 offset:10240
    ds_read_b64_tr_b16 a[42:43], v2 offset:10752
    ds_read_b64_tr_b16 a[44:45], v2 offset:11264
    ds_read_b64_tr_b16 a[46:47], v2 offset:11776
    s_waitcnt lgkmcnt(0)
    ds_read_b64_tr_b16 a[48:49], v2 offset:12288
    ds_read_b64_tr_b16 a[50:51], v2 offset:12800
    ds_read_b64_tr_b16 a[52:53], v2 offset:13312
    ds_read_b64_tr_b16 a[54:55], v2 offset:13824
    ds_read_b64_tr_b16 a[56:57], v2 offset:14336
    ds_read_b64_tr_b16 a[58:59], v2 offset:14848
    ds_read_b64_tr_b16 a[60:61], v2 offset:15360
    ds_read_b64_tr_b16 a[62:63], v2 offset:15872
    s_waitcnt lgkmcnt(0)
    s_add_u32 m0, s33, 16384
    s_add_u32 s64, s32, 327680
    buffer_load_dwordx4 v1, s[12:15], s64 offen lds
    s_add_u32 m0, s33, 17408
    s_add_u32 s64, s32, 348160
    buffer_load_dwordx4 v1, s[12:15], s64 offen lds
    s_waitcnt vmcnt(1)
    s_add_u32 m0, s33, 18432
    s_add_u32 s64, s32, 368640
    buffer_load_dwordx4 v1, s[12:15], s64 offen lds
    s_add_u32 m0, s33, 19456
    s_add_u32 s64, s32, 389120
    buffer_load_dwordx4 v1, s[12:15], s64 offen lds
    s_waitcnt vmcnt(1)
    s_add_u32 m0, s33, 20480
    s_add_u32 s64, s32, 409600
    buffer_load_dwordx4 v1, s[12:15], s64 offen lds
    s_add_u32 m0, s33, 21504
    s_add_u32 s64, s32, 430080
    buffer_load_dwordx4 v1, s[12:15], s64 offen lds
    s_waitcnt vmcnt(1)
    s_add_u32 m0, s33, 22528
    s_add_u32 s64, s32, 450560
    buffer_load_dwordx4 v1, s[12:15], s64 offen lds
    s_add_u32 m0, s33, 23552
    s_add_u32 s64, s32, 471040
    buffer_load_dwordx4 v1, s[12:15], s64 offen lds
    s_waitcnt vmcnt(1)
    s_waitcnt vmcnt(0)
    ds_read_b64_tr_b16 a[64:65], v2 offset:16384
    ds_read_b64_tr_b16 a[66:67], v2 offset:16896
    ds_read_b64_tr_b16 a[68:69], v2 offset:17408
    ds_read_b64_tr_b16 a[70:71], v2 offset:17920
    ds_read_b64_tr_b16 a[72:73], v2 offset:18432
    ds_read_b64_tr_b16 a[74:75], v2 offset:18944
    ds_read_b64_tr_b16 a[76:77], v2 offset:19456
    ds_read_b64_tr_b16 a[78:79], v2 offset:19968
    s_waitcnt lgkmcnt(0)
    ds_read_b64_tr_b16 a[80:81], v2 offset:20480
    ds_read_b64_tr_b16 a[82:83], v2 offset:20992
    ds_read_b64_tr_b16 a[84:85], v2 offset:21504
    ds_read_b64_tr_b16 a[86:87], v2 offset:22016
    ds_read_b64_tr_b16 a[88:89], v2 offset:22528
    ds_read_b64_tr_b16 a[90:91], v2 offset:23040
    ds_read_b64_tr_b16 a[92:93], v2 offset:23552
    ds_read_b64_tr_b16 a[94:95], v2 offset:24064
    s_waitcnt lgkmcnt(0)
    s_add_u32 m0, s33, 24576
    s_add_u32 s64, s32, 491520
    buffer_load_dwordx4 v1, s[12:15], s64 offen lds
    s_add_u32 m0, s33, 25600
    s_add_u32 s64, s32, 512000
    buffer_load_dwordx4 v1, s[12:15], s64 offen lds
    s_waitcnt vmcnt(1)
    s_add_u32 m0, s33, 26624
    s_add_u32 s64, s32, 532480
    buffer_load_dwordx4 v1, s[12:15], s64 offen lds
    s_add_u32 m0, s33, 27648
    s_add_u32 s64, s32, 552960
    buffer_load_dwordx4 v1, s[12:15], s64 offen lds
    s_waitcnt vmcnt(1)
    s_add_u32 m0, s33, 28672
    s_add_u32 s64, s32, 573440
    buffer_load_dwordx4 v1, s[12:15], s64 offen lds
    s_add_u32 m0, s33, 29696
    s_add_u32 s64, s32, 593920
    buffer_load_dwordx4 v1, s[12:15], s64 offen lds
    s_waitcnt vmcnt(1)
    s_add_u32 m0, s33, 30720
    s_add_u32 s64, s32, 614400
    buffer_load_dwordx4 v1, s[12:15], s64 offen lds
    s_add_u32 m0, s33, 31744
    s_add_u32 s64, s32, 634880
    buffer_load_dwordx4 v1, s[12:15], s64 offen lds
    s_waitcnt vmcnt(1)
    s_waitcnt vmcnt(0)
    ds_read_b64_tr_b16 a[96:97], v2 offset:24576
    ds_read_b64_tr_b16 a[98:99], v2 offset:25088
    ds_read_b64_tr_b16 a[100:101], v2 offset:25600
    ds_read_b64_tr_b16 a[102:103], v2 offset:26112
    ds_read_b64_tr_b16 a[104:105], v2 offset:26624
    ds_read_b64_tr_b16 a[106:107], v2 offset:27136
    ds_read_b64_tr_b16 a[108:109], v2 offset:27648
    ds_read_b64_tr_b16 a[110:111], v2 offset:28160
    s_waitcnt lgkmcnt(0)
    ds_read_b64_tr_b16 a[112:113], v2 offset:28672
    ds_read_b64_tr_b16 a[114:115], v2 offset:29184
    ds_read_b64_tr_b16 a[116:117], v2 offset:29696
    ds_read_b64_tr_b16 a[118:119], v2 offset:30208
    ds_read_b64_tr_b16 a[120:121], v2 offset:30720
    ds_read_b64_tr_b16 a[122:123], v2 offset:31232
    ds_read_b64_tr_b16 a[124:125], v2 offset:31744
    ds_read_b64_tr_b16 a[126:127], v2 offset:32256
    s_waitcnt lgkmcnt(0)
    s_add_u32 m0, s33, 0
    s_add_u32 s64, s32, 655360
    buffer_load_dwordx4 v1, s[12:15], s64 offen lds
    s_add_u32 m0, s33, 1024
    s_add_u32 s64, s32, 675840
    buffer_load_dwordx4 v1, s[12:15], s64 offen lds
    s_waitcnt vmcnt(1)
    s_add_u32 m0, s33, 2048
    s_add_u32 s64, s32, 696320
    buffer_load_dwordx4 v1, s[12:15], s64 offen lds
    s_add_u32 m0, s33, 3072
    s_add_u32 s64, s32, 716800
    buffer_load_dwordx4 v1, s[12:15], s64 offen lds
    s_waitcnt vmcnt(1)
    s_add_u32 m0, s33, 4096
    s_add_u32 s64, s32, 737280
    buffer_load_dwordx4 v1, s[12:15], s64 offen lds
    s_add_u32 m0, s33, 5120
    s_add_u32 s64, s32, 757760
    buffer_load_dwordx4 v1, s[12:15], s64 offen lds
    s_waitcnt vmcnt(1)
    s_add_u32 m0, s33, 6144
    s_add_u32 s64, s32, 778240
    buffer_load_dwordx4 v1, s[12:15], s64 offen lds
    s_add_u32 m0, s33, 7168
    s_add_u32 s64, s32, 798720
    buffer_load_dwordx4 v1, s[12:15], s64 offen lds
    s_waitcnt vmcnt(1)
    s_waitcnt vmcnt(0)
    ds_read_b64_tr_b16 a[128:129], v2 offset:0
    ds_read_b64_tr_b16 a[130:131], v2 offset:512
    ds_read_b64_tr_b16 a[132:133], v2 offset:1024
    ds_read_b64_tr_b16 a[134:135], v2 offset:1536
    ds_read_b64_tr_b16 a[136:137], v2 offset:2048
    ds_read_b64_tr_b16 a[138:139], v2 offset:2560
    ds_read_b64_tr_b16 a[140:141], v2 offset:3072
    ds_read_b64_tr_b16 a[142:143], v2 offset:3584
    s_waitcnt lgkmcnt(0)
    ds_read_b64_tr_b16 a[144:145], v2 offset:4096
    ds_read_b64_tr_b16 a[146:147], v2 offset:4608
    ds_read_b64_tr_b16 a[148:149], v2 offset:5120
    ds_read_b64_tr_b16 a[150:151], v2 offset:5632
    ds_read_b64_tr_b16 a[152:153], v2 offset:6144
    ds_read_b64_tr_b16 a[154:155], v2 offset:6656
    ds_read_b64_tr_b16 a[156:157], v2 offset:7168
    ds_read_b64_tr_b16 a[158:159], v2 offset:7680
    s_waitcnt lgkmcnt(0)
    s_add_u32 m0, s33, 8192
    s_add_u32 s64, s32, 819200
    buffer_load_dwordx4 v1, s[12:15], s64 offen lds
    s_add_u32 m0, s33, 9216
    s_add_u32 s64, s32, 839680
    buffer_load_dwordx4 v1, s[12:15], s64 offen lds
    s_waitcnt vmcnt(1)
    s_add_u32 m0, s33, 10240
    s_add_u32 s64, s32, 860160
    buffer_load_dwordx4 v1, s[12:15], s64 offen lds
    s_add_u32 m0, s33, 11264
    s_add_u32 s64, s32, 880640
    buffer_load_dwordx4 v1, s[12:15], s64 offen lds
    s_waitcnt vmcnt(1)
    s_add_u32 m0, s33, 12288
    s_add_u32 s64, s32, 901120
    buffer_load_dwordx4 v1, s[12:15], s64 offen lds
    s_add_u32 m0, s33, 13312
    s_add_u32 s64, s32, 921600
    buffer_load_dwordx4 v1, s[12:15], s64 offen lds
    s_waitcnt vmcnt(1)
    s_add_u32 m0, s33, 14336
    s_add_u32 s64, s32, 942080
    buffer_load_dwordx4 v1, s[12:15], s64 offen lds
    s_add_u32 m0, s33, 15360
    s_add_u32 s64, s32, 962560
    buffer_load_dwordx4 v1, s[12:15], s64 offen lds
    s_waitcnt vmcnt(1)
    s_waitcnt vmcnt(0)
    ds_read_b64_tr_b16 a[160:161], v2 offset:8192
    ds_read_b64_tr_b16 a[162:163], v2 offset:8704
    ds_read_b64_tr_b16 a[164:165], v2 offset:9216
    ds_read_b64_tr_b16 a[166:167], v2 offset:9728
    ds_read_b64_tr_b16 a[168:169], v2 offset:10240
    ds_read_b64_tr_b16 a[170:171], v2 offset:10752
    ds_read_b64_tr_b16 a[172:173], v2 offset:11264
    ds_read_b64_tr_b16 a[174:175], v2 offset:11776
    s_waitcnt lgkmcnt(0)
    ds_read_b64_tr_b16 a[176:177], v2 offset:12288
    ds_read_b64_tr_b16 a[178:179], v2 offset:12800
    ds_read_b64_tr_b16 a[180:181], v2 offset:13312
    ds_read_b64_tr_b16 a[182:183], v2 offset:13824
    ds_read_b64_tr_b16 a[184:185], v2 offset:14336
    ds_read_b64_tr_b16 a[186:187], v2 offset:14848
    ds_read_b64_tr_b16 a[188:189], v2 offset:15360
    ds_read_b64_tr_b16 a[190:191], v2 offset:15872
    s_waitcnt lgkmcnt(0)
    s_add_u32 m0, s33, 16384
    s_add_u32 s64, s32, 983040
    buffer_load_dwordx4 v1, s[12:15], s64 offen lds
    s_add_u32 m0, s33, 17408
    s_add_u32 s64, s32, 1003520
    buffer_load_dwordx4 v1, s[12:15], s64 offen lds
    s_waitcnt vmcnt(1)
    s_add_u32 m0, s33, 18432
    s_add_u32 s64, s32, 1024000
    buffer_load_dwordx4 v1, s[12:15], s64 offen lds
    s_add_u32 m0, s33, 19456
    s_add_u32 s64, s32, 1044480
    buffer_load_dwordx4 v1, s[12:15], s64 offen lds
    s_waitcnt vmcnt(1)
    s_add_u32 m0, s33, 20480
    s_add_u32 s64, s32, 1064960
    buffer_load_dwordx4 v1, s[12:15], s64 offen lds
    s_add_u32 m0, s33, 21504
    s_add_u32 s64, s32, 1085440
    buffer_load_dwordx4 v1, s[12:15], s64 offen lds
    s_waitcnt vmcnt(1)
    s_add_u32 m0, s33, 22528
    s_add_u32 s64, s32, 1105920
    buffer_load_dwordx4 v1, s[12:15], s64 offen lds
    s_add_u32 m0, s33, 23552
    s_add_u32 s64, s32, 1126400
    buffer_load_dwordx4 v1, s[12:15], s64 offen lds
    s_waitcnt vmcnt(1)
    s_waitcnt vmcnt(0)
    ds_read_b64_tr_b16 a[192:193], v2 offset:16384
    ds_read_b64_tr_b16 a[194:195], v2 offset:16896
    ds_read_b64_tr_b16 a[196:197], v2 offset:17408
    ds_read_b64_tr_b16 a[198:199], v2 offset:17920
    ds_read_b64_tr_b16 a[200:201], v2 offset:18432
    ds_read_b64_tr_b16 a[202:203], v2 offset:18944
    ds_read_b64_tr_b16 a[204:205], v2 offset:19456
    ds_read_b64_tr_b16 a[206:207], v2 offset:19968
    s_waitcnt lgkmcnt(0)
    ds_read_b64_tr_b16 a[208:209], v2 offset:20480
    ds_read_b64_tr_b16 a[210:211], v2 offset:20992
    ds_read_b64_tr_b16 a[212:213], v2 offset:21504
    ds_read_b64_tr_b16 a[214:215], v2 offset:22016
    ds_read_b64_tr_b16 a[216:217], v2 offset:22528
    ds_read_b64_tr_b16 a[218:219], v2 offset:23040
    ds_read_b64_tr_b16 a[220:221], v2 offset:23552
    ds_read_b64_tr_b16 a[222:223], v2 offset:24064
    s_waitcnt lgkmcnt(0)
    s_add_u32 m0, s33, 24576
    s_add_u32 s64, s32, 1146880
    buffer_load_dwordx4 v1, s[12:15], s64 offen lds
    s_add_u32 m0, s33, 25600
    s_add_u32 s64, s32, 1167360
    buffer_load_dwordx4 v1, s[12:15], s64 offen lds
    s_waitcnt vmcnt(1)
    s_add_u32 m0, s33, 26624
    s_add_u32 s64, s32, 1187840
    buffer_load_dwordx4 v1, s[12:15], s64 offen lds
    s_add_u32 m0, s33, 27648
    s_add_u32 s64, s32, 1208320
    buffer_load_dwordx4 v1, s[12:15], s64 offen lds
    s_waitcnt vmcnt(1)
    s_add_u32 m0, s33, 28672
    s_add_u32 s64, s32, 1228800
    buffer_load_dwordx4 v1, s[12:15], s64 offen lds
    s_add_u32 m0, s33, 29696
    s_add_u32 s64, s32, 1249280
    buffer_load_dwordx4 v1, s[12:15], s64 offen lds
    s_waitcnt vmcnt(1)
    s_add_u32 m0, s33, 30720
    s_add_u32 s64, s32, 1269760
    buffer_load_dwordx4 v1, s[12:15], s64 offen lds
    s_add_u32 m0, s33, 31744
    s_add_u32 s64, s32, 1290240
    buffer_load_dwordx4 v1, s[12:15], s64 offen lds
    s_waitcnt vmcnt(1)
    s_waitcnt vmcnt(0)
    ds_read_b64_tr_b16 a[224:225], v2 offset:24576
    ds_read_b64_tr_b16 a[226:227], v2 offset:25088
    ds_read_b64_tr_b16 a[228:229], v2 offset:25600
    ds_read_b64_tr_b16 a[230:231], v2 offset:26112
    ds_read_b64_tr_b16 a[232:233], v2 offset:26624
    ds_read_b64_tr_b16 a[234:235], v2 offset:27136
    ds_read_b64_tr_b16 a[236:237], v2 offset:27648
    ds_read_b64_tr_b16 a[238:239], v2 offset:28160
    s_waitcnt lgkmcnt(0)
    ds_read_b64_tr_b16 a[240:241], v2 offset:28672
    ds_read_b64_tr_b16 a[242:243], v2 offset:29184
    ds_read_b64_tr_b16 a[244:245], v2 offset:29696
    ds_read_b64_tr_b16 a[246:247], v2 offset:30208
    ds_read_b64_tr_b16 a[248:249], v2 offset:30720
    ds_read_b64_tr_b16 a[250:251], v2 offset:31232
    ds_read_b64_tr_b16 a[252:253], v2 offset:31744
    ds_read_b64_tr_b16 a[254:255], v2 offset:32256
    s_waitcnt lgkmcnt(0)
    s_barrier
    s_mov_b32 s12, s84
    s_mov_b32 s13, s85
    s_mov_b32 s14, 2211840
    s_mul_i32 s33, s4, 27648
    s_mul_i32 s32, s4, 552960
    s_add_u32 s32, s32, s21
    s_add_u32 m0, s33, 0
    s_add_u32 s64, s32, 0
    buffer_load_dwordx4 v1, s[12:15], s64 offen lds
    s_add_u32 m0, s33, 1024
    s_add_u32 s64, s32, 20480
    buffer_load_dwordx4 v1, s[12:15], s64 offen lds
    s_waitcnt vmcnt(1)
    s_add_u32 m0, s33, 2048
    s_add_u32 s64, s32, 40960
    buffer_load_dwordx4 v1, s[12:15], s64 offen lds
    s_add_u32 m0, s33, 3072
    s_add_u32 s64, s32, 61440
    buffer_load_dwordx4 v1, s[12:15], s64 offen lds
    s_waitcnt vmcnt(1)
    s_add_u32 m0, s33, 4096
    s_add_u32 s64, s32, 81920
    buffer_load_dwordx4 v1, s[12:15], s64 offen lds
    s_add_u32 m0, s33, 5120
    s_add_u32 s64, s32, 102400
    buffer_load_dwordx4 v1, s[12:15], s64 offen lds
    s_waitcnt vmcnt(1)
    s_add_u32 m0, s33, 6144
    s_add_u32 s64, s32, 122880
    buffer_load_dwordx4 v1, s[12:15], s64 offen lds
    s_add_u32 m0, s33, 7168
    s_add_u32 s64, s32, 143360
    buffer_load_dwordx4 v1, s[12:15], s64 offen lds
    s_waitcnt vmcnt(4)
    s_waitcnt vmcnt(1)
    s_add_u32 m0, s33, 8192
    s_add_u32 s64, s32, 163840
    buffer_load_dwordx4 v1, s[12:15], s64 offen lds
    s_add_u32 m0, s33, 9216
    s_add_u32 s64, s32, 184320
    buffer_load_dwordx4 v1, s[12:15], s64 offen lds
    s_waitcnt vmcnt(1)
    s_add_u32 m0, s33, 10240
    s_add_u32 s64, s32, 204800
    buffer_load_dwordx4 v1, s[12:15], s64 offen lds
    s_add_u32 m0, s33, 11264
    s_add_u32 s64, s32, 225280
    buffer_load_dwordx4 v1, s[12:15], s64 offen lds
    s_waitcnt vmcnt(1)
    s_add_u32 m0, s33, 12288
    s_add_u32 s64, s32, 245760
    buffer_load_dwordx4 v1, s[12:15], s64 offen lds
    s_add_u32 m0, s33, 13312
    s_add_u32 s64, s32, 266240
    buffer_load_dwordx4 v1, s[12:15], s64 offen lds
    s_waitcnt vmcnt(1)
    s_add_u32 m0, s33, 14336
    s_add_u32 s64, s32, 286720
    buffer_load_dwordx4 v1, s[12:15], s64 offen lds
    s_add_u32 m0, s33, 15360
    s_add_u32 s64, s32, 307200
    buffer_load_dwordx4 v1, s[12:15], s64 offen lds
    s_waitcnt vmcnt(4)
    s_waitcnt vmcnt(1)
    s_add_u32 m0, s33, 16384
    s_add_u32 s64, s32, 327680
    buffer_load_dwordx4 v1, s[12:15], s64 offen lds
    s_add_u32 m0, s33, 17408
    s_add_u32 s64, s32, 348160
    buffer_load_dwordx4 v1, s[12:15], s64 offen lds
    s_waitcnt vmcnt(1)
    s_add_u32 m0, s33, 18432
    s_add_u32 s64, s32, 368640
    buffer_load_dwordx4 v1, s[12:15], s64 offen lds
    s_add_u32 m0, s33, 19456
    s_add_u32 s64, s32, 389120
    buffer_load_dwordx4 v1, s[12:15], s64 offen lds
    s_waitcnt vmcnt(1)
    s_add_u32 m0, s33, 20480
    s_add_u32 s64, s32, 409600
    buffer_load_dwordx4 v1, s[12:15], s64 offen lds
    s_add_u32 m0, s33, 21504
    s_add_u32 s64, s32, 430080
    buffer_load_dwordx4 v1, s[12:15], s64 offen lds
    s_waitcnt vmcnt(1)
    s_add_u32 m0, s33, 22528
    s_add_u32 s64, s32, 450560
    buffer_load_dwordx4 v1, s[12:15], s64 offen lds
    s_add_u32 m0, s33, 23552
    s_add_u32 s64, s32, 471040
    buffer_load_dwordx4 v1, s[12:15], s64 offen lds
    s_waitcnt vmcnt(4)
    s_waitcnt vmcnt(1)
    s_add_u32 m0, s33, 24576
    s_add_u32 s64, s32, 491520
    buffer_load_dwordx4 v1, s[12:15], s64 offen lds
    s_add_u32 m0, s33, 25600
    s_add_u32 s64, s32, 512000
    buffer_load_dwordx4 v1, s[12:15], s64 offen lds
    s_waitcnt vmcnt(1)
    s_add_u32 m0, s33, 26624
    s_add_u32 s64, s32, 532480
    buffer_load_dwordx4 v1, s[12:15], s64 offen lds
    v_add_u32 v2, s33, v10
    s_mov_b32 s16, s86
    s_mov_b32 s17, s87
    s_mov_b32 s18, 2621440
    s_mov_b32 s24, s88
    s_mov_b32 s25, s89
    s_mov_b32 s26, 2621440
    s_mov_b32 s27, 0x20000
    v_and_b32 v9, 31, v7
    v_mul_u32_u24 v9, 1280, v9
    v_lshl_add_u32 v9, v8, 3, v9
    s_lshl_b32 s64, s4, 4
    s_add_u32 s64, s64, s21
    v_add_u32 v3, s64, v9
    v_and_b32 v9, 7, v7
    v_lshlrev_b32 v4, 7, v9
    s_waitcnt vmcnt(0)
    v_min_u32 v6, 63, v7
    v_lshlrev_b32 v6, 2, v6
    s_mov_b32 s64, 109052928
W_g1:
    buffer_load_dword v8, v6, s[8:11], s64 offen offset:0 sc1
    buffer_load_dword v9, v6, s[8:11], s64 offen offset:128 sc1
    s_sub_u32 s40, s40, 1
    s_cbranch_scc1 M_fin
    s_waitcnt vmcnt(0)
    v_min_u32 v8, v8, v9
    v_cmp_eq_u32 vcc, 0, v8
    s_cbranch_vccz W_g1_ok
    s_sleep 2
    s_branch W_g1
W_g1_ok:
    v_lshlrev_b32 v6, 4, v7
    s_mov_b32 s64, 109064192
W_g1_kv:
    buffer_load_dwordx4 v[8:11], v6, s[8:11], s64 offen offset:0 sc1
    buffer_load_dwordx4 v[12:15], v6, s[8:11], s64 offen offset:1024 sc1
    buffer_load_dwordx4 v[16:19], v6, s[8:11], s64 offen offset:2048 sc1
    buffer_load_dwordx4 v[20:23], v6, s[8:11], s64 offen offset:3072 sc1
    s_sub_u32 s40, s40, 1
    s_cbranch_scc1 M_fin
    s_waitcnt vmcnt(3)
    v_min3_u32 v8, v8, v9, v10
    s_waitcnt vmcnt(2)
    v_min3_u32 v8, v8, v11, v12
    v_min3_u32 v8, v8, v13, v14
    s_waitcnt vmcnt(1)
    v_min3_u32 v8, v8, v15, v16
    v_min3_u32 v8, v8, v17, v18
    s_waitcnt vmcnt(0)
    v_min3_u32 v8, v8, v19, v20
    v_min3_u32 v8, v8, v21, v22
    v_min_u32 v8, v8, v23
    v_cmp_eq_u32 vcc, 0, v8
    s_cbranch_vccnz W_g1_kv
    s_lshl_b32 s64, s4, 12
    v_add_u32 v5, s64, v0
    s_lshl_b32 s64, s4, 10
    v_add_u32 v6, s64, v0
    v_add_u32 v5, 110592, v5
    v_add_u32 v6, 110592, v6
    s_mov_b32 s20, s3
    s_mov_b32 s22, 0xbfb8aa3b
    v_mov_b32 v26, v0
    v_mov_b32 v27, v3
W_loop:
    s_mul_i32 s64, s20, 110592
    s_add_u32 s64, s64, s33
    s_add_u32 s64, s64, 71303168
    s_mul_i32 s23, s20, 40960
    buffer_load_dwordx4 v[64:67], v0, s[8:11], s64 offen offset:0 sc1
    buffer_load_dwordx4 v[68:71], v0, s[8:11], s64 offen offset:1024 sc1
    buffer_load_dwordx4 v[72:75], v0, s[8:11], s64 offen offset:2048 sc1
    buffer_load_dwordx4 v[76:79], v0, s[8:11], s64 offen offset:3072 sc1
    s_add_u32 s64, s64, 4096
    buffer_load_dwordx4 v[80:83], v0, s[8:11], s64 offen offset:0 sc1
    buffer_load_dwordx4 v[84:87], v0, s[8:11], s64 offen offset:1024 sc1
    buffer_load_dwordx4 v[88:91], v0, s[8:11], s64 offen offset:2048 sc1
    buffer_load_dwordx4 v[92:95], v0, s[8:11], s64 offen offset:3072 sc1
    s_waitcnt vmcnt(4)
    s_add_u32 s64, s64, 4096
    buffer_load_dwordx4 v[96:99], v0, s[8:11], s64 offen offset:0 sc1
    buffer_load_dwordx4 v[100:103], v0, s[8:11], s64 offen offset:1024 sc1
    buffer_load_dwordx4 v[104:107], v0, s[8:11], s64 offen offset:2048 sc1
    buffer_load_dwordx4 v[108:111], v0, s[8:11], s64 offen offset:3072 sc1
    s_waitcnt vmcnt(4)
    s_add_u32 s64, s64, 4096
    buffer_load_dwordx4 v[112:115], v0, s[8:11], s64 offen offset:0 sc1
    buffer_load_dwordx4 v[116:119], v0, s[8:11], s64 offen offset:1024 sc1
    buffer_load_dwordx4 v[120:123], v0, s[8:11], s64 offen offset:2048 sc1
    buffer_load_dwordx4 v[124:127], v0, s[8:11], s64 offen offset:3072 sc1
    s_waitcnt vmcnt(4)
    s_add_u32 s64, s64, 4096
    buffer_load_dwordx4 v[128:131], v0, s[8:11], s64 offen offset:0 sc1
    buffer_load_dwordx4 v[132:135], v0, s[8:11], s64 offen offset:1024 sc1
    buffer_load_dwordx4 v[136:139], v0, s[8:11], s64 offen offset:2048 sc1
    buffer_load_dwordx4 v[140:143], v0, s[8:11], s64 offen offset:3072 sc1
    s_waitcnt vmcnt(4)
    s_add_u32 s64, s64, 4096
    buffer_load_dwordx4 v[144:147], v0, s[8:11], s64 offen offset:0 sc1
    buffer_load_dwordx4 v[148:151], v0, s[8:11], s64 offen offset:1024 sc1
    buffer_load_dwordx4 v[152:155], v0, s[8:11], s64 offen offset:2048 sc1
    buffer_load_dwordx4 v[156:159], v0, s[8:11], s64 offen offset:3072 sc1
    s_waitcnt vmcnt(4)
    s_add_u32 s64, s64, 4096
    buffer_load_dwordx4 v[160:163], v0, s[8:11], s64 offen offset:0 sc1
    buffer_load_dwordx4 v[164:167], v0, s[8:11], s64 offen offset:1024 sc1
    buffer_load_dwordx4 v[168:171], v0, s[8:11], s64 offen offset:2048 sc1
    buffer_load_dwordx2 v[20:21], v3, s[16:19], s23 offen
    ds_read_b64_tr_b16 v[8:9], v2 offset:0
    ds_read_b64_tr_b16 v[10:11], v2 offset:512
    ds_read_b64_tr_b16 v[12:13], v2 offset:1024
    ds_read_b64_tr_b16 v[14:15], v2 offset:1536
    ds_read_b64_tr_b16 v[16:17], v2 offset:2048
    ds_read_b64_tr_b16 v[18:19], v2 offset:2560
    s_waitcnt lgkmcnt(4)
    v_mfma_f32_32x32x16_bf16 v[32:47], v[8:11], v[64:67], 0
    ds_read_b64_tr_b16 v[8:9], v2 offset:3072
    ds_read_b64_tr_b16 v[10:11], v2 offset:3584
    s_waitcnt lgkmcnt(4)
    v_mfma_f32_32x32x16_bf16 v[32:47], v[12:15], v[68:71], v[32:47]
    ds_read_b64_tr_b16 v[12:13], v2 offset:4096
    ds_read_b64_tr_b16 v[14:15], v2 offset:4608
    s_waitcnt lgkmcnt(4)
    v_mfma_f32_32x32x16_bf16 v[32:47], v[16:19], v[72:75], v[32:47]
    ds_read_b64_tr_b16 v[16:17], v2 offset:5120
    ds_read_b64_tr_b16 v[18:19], v2 offset:5632
    s_waitcnt lgkmcnt(4)
    v_mfma_f32_32x32x16_bf16 v[32:47], v[8:11], v[76:79], v[32:47]
    ds_read_b64_tr_b16 v[8:9], v2 offset:6144
    ds_read_b64_tr_b16 v[10:11], v2 offset:6656
    s_waitcnt lgkmcnt(4)
    v_mfma_f32_32x32x16_bf16 v[32:47], v[12:15], v[80:83], v[32:47]
    ds_read_b64_tr_b16 v[12:13], v2 offset:7168
    ds_read_b64_tr_b16 v[14:15], v2 offset:7680
    s_waitcnt lgkmcnt(4)
    v_mfma_f32_32x32x16_bf16 v[32:47], v[16:19], v[84:87], v[32:47]
    ds_read_b64_tr_b16 v[16:17], v2 offset:8192
    ds_read_b64_tr_b16 v[18:19], v2 offset:8704
    s_waitcnt lgkmcnt(4)
    v_mfma_f32_32x32x16_bf16 v[32:47], v[8:11], v[88:91], v[32:47]
    ds_read_b64_tr_b16 v[8:9], v2 offset:9216
    ds_read_b64_tr_b16 v[10:11], v2 offset:9728
    s_waitcnt lgkmcnt(4)
    v_mfma_f32_32x32x16_bf16 v[32:47], v[12:15], v[92:95], v[32:47]
    ds_read_b64_tr_b16 v[12:13], v2 offset:10240
    ds_read_b64_tr_b16 v[14:15], v2 offset:10752
    s_waitcnt lgkmcnt(4)
    v_mfma_f32_32x32x16_bf16 v[32:47], v[16:19], v[96:99], v[32:47]
    ds_read_b64_tr_b16 v[16:17], v2 offset:11264
    ds_read_b64_tr_b16 v[18:19], v2 offset:11776
    s_waitcnt lgkmcnt(4)
    v_mfma_f32_32x32x16_bf16 v[32:47], v[8:11], v[100:103], v[32:47]
    ds_read_b64_tr_b16 v[8:9], v2 offset:12288
    ds_read_b64_tr_b16 v[10:11], v2 offset:12800
    s_waitcnt lgkmcnt(4)
    v_mfma_f32_32x32x16_bf16 v[32:47], v[12:15], v[104:107], v[32:47]
    ds_read_b64_tr_b16 v[12:13], v2 offset:13312
    ds_read_b64_tr_b16 v[14:15], v2 offset:13824
    s_waitcnt lgkmcnt(4)
    v_mfma_f32_32x32x16_bf16 v[32:47], v[16:19], v[108:111], v[32:47]
    ds_read_b64_tr_b16 v[16:17], v2 offset:14336
    ds_read_b64_tr_b16 v[18:19], v2 offset:14848
    s_waitcnt lgkmcnt(4)
    v_mfma_f32_32x32x16_bf16 v[32:47], v[8:11], v[112:115], v[32:47]
    ds_read_b64_tr_b16 v[8:9], v2 offset:15360
    ds_read_b64_tr_b16 v[10:11], v2 offset:15872
    s_waitcnt lgkmcnt(4)
    v_mfma_f32_32x32x16_bf16 v[32:47], v[12:15], v[116:119], v[32:47]
    ds_read_b64_tr_b16 v[12:13], v2 offset:16384
    ds_read_b64_tr_b16 v[14:15], v2 offset:16896
    s_waitcnt lgkmcnt(4)
    v_mfma_f32_32x32x16_bf16 v[32:47], v[16:19], v[120:123], v[32:47]
    ds_read_b64_tr_b16 v[16:17], v2 offset:17408
    ds_read_b64_tr_b16 v[18:19], v2 offset:17920
    s_waitcnt lgkmcnt(4)
    v_mfma_f32_32x32x16_bf16 v[32:47], v[8:11], v[124:127], v[32:47]
    ds_read_b64_tr_b16 v[8:9], v2 offset:18432
    ds_read_b64_tr_b16 v[10:11], v2 offset:18944
    s_waitcnt lgkmcnt(4)
    v_mfma_f32_32x32x16_bf16 v[32:47], v[12:15], v[128:131], v[32:47]
    ds_read_b64_tr_b16 v[12:13], v2 offset:19456
    ds_read_b64_tr_b16 v[14:15], v2 offset:19968
    s_waitcnt lgkmcnt(4)
    v_mfma_f32_32x32x16_bf16 v[32:47], v[16:19], v[132:135], v[32:47]
    ds_read_b64_tr_b16 v[16:17], v2 offset:20480
    ds_read_b64_tr_b16 v[18:19], v2 offset:20992
    s_waitcnt lgkmcnt(4)
    v_mfma_f32_32x32x16_bf16 v[32:47], v[8:11], v[136:139], v[32:47]
    ds_read_b64_tr_b16 v[8:9], v2 offset:21504
    ds_read_b64_tr_b16 v[10:11], v2 offset:22016
    s_waitcnt lgkmcnt(4)
    v_mfma_f32_32x32x16_bf16 v[32:47], v[12:15], v[140:143], v[32:47]
    ds_read_b64_tr_b16 v[12:13], v2 offset:22528
    ds_read_b64_tr_b16 v[14:15], v2 offset:23040
    s_waitcnt vmcnt(7) lgkmcnt(4)
    v_mfma_f32_32x32x16_bf16 v[32:47], v[16:19], v[144:147], v[32:47]
    ds_read_b64_tr_b16 v[16:17], v2 offset:23552
    ds_read_b64_tr_b16 v[18:19], v2 offset:24064
    s_waitcnt vmcnt(6) lgkmcnt(4)
    v_mfma_f32_32x32x16_bf16 v[32:47], v[8:11], v[148:151], v[32:47]
    ds_read_b64_tr_b16 v[8:9], v2 offset:24576
    ds_read_b64_tr_b16 v[10:11], v2 offset:25088
    s_waitcnt vmcnt(5) lgkmcnt(4)
    v_mfma_f32_32x32x16_bf16 v[32:47], v[12:15], v[152:155], v[32:47]
    ds_read_b64_tr_b16 v[12:13], v2 offset:25600
    ds_read_b64_tr_b16 v[14:15], v2 offset:26112
    s_waitcnt vmcnt(4) lgkmcnt(4)
    v_mfma_f32_32x32x16_bf16 v[32:47], v[16:19], v[156:159], v[32:47]
    ds_read_b64_tr_b16 v[16:17], v2 offset:26624
    ds_read_b64_tr_b16 v[18:19], v2 offset:27136
    s_waitcnt vmcnt(3) lgkmcnt(4)
    v_mfma_f32_32x32x16_bf16 v[32:47], v[8:11], v[160:163], v[32:47]
    s_waitcnt vmcnt(2) lgkmcnt(2)
    v_mfma_f32_32x32x16_bf16 v[32:47], v[12:15], v[164:167], v[32:47]
    s_waitcnt vmcnt(1) lgkmcnt(0)
    v_mfma_f32_32x32x16_bf16 v[32:47], v[16:19], v[168:171], v[32:47]
    s_nop 11
    ds_write_b128 v5, v[32:35] offset:0
    ds_write_b128 v5, v[36:39] offset:1024
    ds_write_b128 v5, v[40:43] offset:2048
    ds_write_b128 v5, v[44:47] offset:3072
    s_waitcnt lgkmcnt(0)
    s_barrier
    ds_read_b128 v[192:195], v6 offset:0
    ds_read_b128 v[196:199], v6 offset:4096
    ds_read_b128 v[200:203], v6 offset:8192
    ds_read_b128 v[204:207], v6 offset:12288
    s_waitcnt lgkmcnt(2)
    v_add_f32 v192, v192, v196
    v_add_f32 v193, v193, v197
    v_add_f32 v194, v194, v198
    v_add_f32 v195, v195, v199
    s_waitcnt lgkmcnt(0)
    v_add_f32 v200, v200, v204
    v_add_f32 v201, v201, v205
    v_add_f32 v202, v202, v206
    v_add_f32 v203, v203, v207
    v_add_f32 v22, v192, v200
    v_add_f32 v23, v193, v201
    v_add_f32 v24, v194, v202
    v_add_f32 v25, v195, v203
    v_cvt_pk_bf16_f32 v192, v22, v23
    v_cvt_pk_bf16_f32 v193, v24, v25
    v_lshlrev_b32 v22, 16, v192
    v_and_b32 v23, 0xffff0000, v192
    v_lshlrev_b32 v24, 16, v193
    v_and_b32 v25, 0xffff0000, v193
    v_mul_f32 v196, s22, v22
    v_mul_f32 v197, s22, v23
    v_mul_f32 v198, s22, v24
    v_mul_f32 v199, s22, v25
    v_exp_f32 v196, v196
    v_exp_f32 v197, v197
    v_exp_f32 v198, v198
    v_exp_f32 v199, v199
    v_add_f32 v196, 1.0, v196
    v_add_f32 v197, 1.0, v197
    v_add_f32 v198, 1.0, v198
    v_add_f32 v199, 1.0, v199
    v_rcp_f32 v196, v196
    v_rcp_f32 v197, v197
    v_rcp_f32 v198, v198
    v_rcp_f32 v199, v199
    v_mul_f32 v22, v22, v196
    v_mul_f32 v23, v23, v197
    v_mul_f32 v24, v24, v198
    v_mul_f32 v25, v25, v199
    v_cvt_pk_bf16_f32 v192, v22, v23
    v_cvt_pk_bf16_f32 v193, v24, v25
    v_lshlrev_b32 v22, 16, v192
    v_and_b32 v23, 0xffff0000, v192
    v_lshlrev_b32 v24, 16, v193
    v_and_b32 v25, 0xffff0000, v193
    s_lshl_b32 s64, s20, 10
    s_add_u32 s64, s64, 109068288
    s_waitcnt vmcnt(0)
W_o:
    buffer_load_dword v192, v4, s[8:11], s64 offen offset:0 sc1
    s_sub_u32 s40, s40, 1
    s_cbranch_scc1 M_fin
    s_waitcnt vmcnt(0)
    v_cmp_eq_u32 vcc, 0, v192
    s_cbranch_vccz W_o_ok
    s_sleep 2
    s_branch W_o
W_o_ok:
    s_lshl_b32 s64, s20, 18
    s_lshl_b32 s65, s4, 16
    s_add_u32 s64, s64, s65
    s_add_u32 s64, s64, 50331648
    s_cmp_ge_u32 s20, 62
    s_cbranch_scc1 W_h
    buffer_load_dwordx4 v[64:67], v26, s[8:11], s64 offen offset:0 sc1
    buffer_load_dwordx4 v[68:71], v26, s[8:11], s64 offen offset:1024 sc1
    buffer_load_dwordx4 v[72:75], v26, s[8:11], s64 offen offset:2048 sc1
    buffer_load_dwordx4 v[76:79], v26, s[8:11], s64 offen offset:3072 sc1
    s_add_u32 s64, s64, 4096
    buffer_load_dwordx4 v[80:83], v26, s[8:11], s64 offen offset:0 sc1
    buffer_load_dwordx4 v[84:87], v26, s[8:11], s64 offen offset:1024 sc1
    buffer_load_dwordx4 v[88:91], v26, s[8:11], s64 offen offset:2048 sc1
    buffer_load_dwordx4 v[92:95], v26, s[8:11], s64 offen offset:3072 sc1
    s_add_u32 s64, s64, 4096
    buffer_load_dwordx4 v[96:99], v26, s[8:11], s64 offen offset:0 sc1
    buffer_load_dwordx4 v[100:103], v26, s[8:11], s64 offen offset:1024 sc1
    buffer_load_dwordx4 v[104:107], v26, s[8:11], s64 offen offset:2048 sc1
    buffer_load_dwordx4 v[108:111], v26, s[8:11], s64 offen offset:3072 sc1
    s_add_u32 s64, s64, 4096
    buffer_load_dwordx4 v[112:115], v26, s[8:11], s64 offen offset:0 sc1
    buffer_load_dwordx4 v[116:119], v26, s[8:11], s64 offen offset:1024 sc1
    buffer_load_dwordx4 v[120:123], v26, s[8:11], s64 offen offset:2048 sc1
    buffer_load_dwordx4 v[124:127], v26, s[8:11], s64 offen offset:3072 sc1
    s_waitcnt vmcnt(15)
    v_mfma_f32_32x32x16_bf16 v[48:63], a[0:3], v[64:67], 0
    s_add_u32 s64, s64, 4096
    buffer_load_dwordx4 v[64:67], v26, s[8:11], s64 offen offset:0 sc1
    s_waitcnt vmcnt(15)
    v_mfma_f32_32x32x16_bf16 v[48:63], a[4:7], v[68:71], v[48:63]
    buffer_load_dwordx4 v[68:71], v26, s[8:11], s64 offen offset:1024 sc1
    s_waitcnt vmcnt(15)
    v_mfma_f32_32x32x16_bf16 v[48:63], a[8:11], v[72:75], v[48:63]
    buffer_load_dwordx4 v[72:75], v26, s[8:11], s64 offen offset:2048 sc1
    s_waitcnt vmcnt(15)
    v_mfma_f32_32x32x16_bf16 v[48:63], a[12:15], v[76:79], v[48:63]
    buffer_load_dwordx4 v[76:79], v26, s[8:11], s64 offen offset:3072 sc1
    s_waitcnt vmcnt(15)
    v_mfma_f32_32x32x16_bf16 v[48:63], a[16:19], v[80:83], v[48:63]
    s_add_u32 s64, s64, 4096
    buffer_load_dwordx4 v[80:83], v26, s[8:11], s64 offen offset:0 sc1
    s_waitcnt vmcnt(15)
    v_mfma_f32_32x32x16_bf16 v[48:63], a[20:23], v[84:87], v[48:63]
    buffer_load_dwordx4 v[84:87], v26, s[8:11], s64 offen offset:1024 sc1
    s_waitcnt vmcnt(15)
    v_mfma_f32_32x32x16_bf16 v[48:63], a[24:27], v[88:91], v[48:63]
    buffer_load_dwordx4 v[88:91], v26, s[8:11], s64 offen offset:2048 sc1
    s_waitcnt vmcnt(15)
    v_mfma_f32_32x32x16_bf16 v[48:63], a[28:31], v[92:95], v[48:63]
    buffer_load_dwordx4 v[92:95], v26, s[8:11], s64 offen offset:3072 sc1
    s_waitcnt vmcnt(15)
    v_mfma_f32_32x32x16_bf16 v[48:63], a[32:35], v[96:99], v[48:63]
    s_add_u32 s64, s64, 4096
    buffer_load_dwordx4 v[96:99], v26, s[8:11], s64 offen offset:0 sc1
    s_waitcnt vmcnt(15)
    v_mfma_f32_32x32x16_bf16 v[48:63], a[36:39], v[100:103], v[48:63]
    buffer_load_dwordx4 v[100:103], v26, s[8:11], s64 offen offset:1024 sc1
    s_waitcnt vmcnt(15)
    v_mfma_f32_32x32x16_bf16 v[48:63], a[40:43], v[104:107], v[48:63]
    buffer_load_dwordx4 v[104:107], v26, s[8:11], s64 offen offset:2048 sc1
    s_waitcnt vmcnt(15)
    v_mfma_f32_32x32x16_bf16 v[48:63], a[44:47], v[108:111], v[48:63]
    buffer_load_dwordx4 v[108:111], v26, s[8:11], s64 offen offset:3072 sc1
    s_waitcnt vmcnt(15)
    v_mfma_f32_32x32x16_bf16 v[48:63], a[48:51], v[112:115], v[48:63]
    s_add_u32 s64, s64, 4096
    buffer_load_dwordx4 v[112:115], v26, s[8:11], s64 offen offset:0 sc1
    s_waitcnt vmcnt(15)
    v_mfma_f32_32x32x16_bf16 v[48:63], a[52:55], v[116:119], v[48:63]
    buffer_load_dwordx4 v[116:119], v26, s[8:11], s64 offen offset:1024 sc1
    s_waitcnt vmcnt(15)
    v_mfma_f32_32x32x16_bf16 v[48:63], a[56:59], v[120:123], v[48:63]
    buffer_load_dwordx4 v[120:123], v26, s[8:11], s64 offen offset:2048 sc1
    s_waitcnt vmcnt(15)
    v_mfma_f32_32x32x16_bf16 v[48:63], a[60:63], v[124:127], v[48:63]
    buffer_load_dwordx4 v[124:127], v26, s[8:11], s64 offen offset:3072 sc1
    s_waitcnt vmcnt(15)
    v_mfma_f32_32x32x16_bf16 v[48:63], a[64:67], v[64:67], v[48:63]
    s_add_u32 s64, s64, 4096
    buffer_load_dwordx4 v[64:67], v26, s[8:11], s64 offen offset:0 sc1
    s_waitcnt vmcnt(15)
    v_mfma_f32_32x32x16_bf16 v[48:63], a[68:71], v[68:71], v[48:63]
    buffer_load_dwordx4 v[68:71], v26, s[8:11], s64 offen offset:1024 sc1
    s_waitcnt vmcnt(15)
    v_mfma_f32_32x32x16_bf16 v[48:63], a[72:75], v[72:75], v[48:63]
    buffer_load_dwordx4 v[72:75], v26, s[8:11], s64 offen offset:2048 sc1
    s_waitcnt vmcnt(15)
    v_mfma_f32_32x32x16_bf16 v[48:63], a[76:79], v[76:79], v[48:63]
    buffer_load_dwordx4 v[76:79], v26, s[8:11], s64 offen offset:3072 sc1
    s_waitcnt vmcnt(15)
    v_mfma_f32_32x32x16_bf16 v[48:63], a[80:83], v[80:83], v[48:63]
    s_add_u32 s64, s64, 4096
    buffer_load_dwordx4 v[80:83], v26, s[8:11], s64 offen offset:0 sc1
    s_waitcnt vmcnt(15)
    v_mfma_f32_32x32x16_bf16 v[48:63], a[84:87], v[84:87], v[48:63]
    buffer_load_dwordx4 v[84:87], v26, s[8:11], s64 offen offset:1024 sc1
    s_waitcnt vmcnt(15)
    v_mfma_f32_32x32x16_bf16 v[48:63], a[88:91], v[88:91], v[48:63]
    buffer_load_dwordx4 v[88:91], v26, s[8:11], s64 offen offset:2048 sc1
    s_waitcnt vmcnt(15)
    v_mfma_f32_32x32x16_bf16 v[48:63], a[92:95], v[92:95], v[48:63]
    buffer_load_dwordx4 v[92:95], v26, s[8:11], s64 offen offset:3072 sc1
    s_waitcnt vmcnt(15)
    v_mfma_f32_32x32x16_bf16 v[48:63], a[96:99], v[96:99], v[48:63]
    s_add_u32 s64, s64, 4096
    buffer_load_dwordx4 v[96:99], v26, s[8:11], s64 offen offset:0 sc1
    s_waitcnt vmcnt(15)
    v_mfma_f32_32x32x16_bf16 v[48:63], a[100:103], v[100:103], v[48:63]
    buffer_load_dwordx4 v[100:103], v26, s[8:11], s64 offen offset:1024 sc1
    s_waitcnt vmcnt(15)
    v_mfma_f32_32x32x16_bf16 v[48:63], a[104:107], v[104:107], v[48:63]
    buffer_load_dwordx4 v[104:107], v26, s[8:11], s64 offen offset:2048 sc1
    s_waitcnt vmcnt(15)
    v_mfma_f32_32x32x16_bf16 v[48:63], a[108:111], v[108:111], v[48:63]
    buffer_load_dwordx4 v[108:111], v26, s[8:11], s64 offen offset:3072 sc1
    s_waitcnt vmcnt(15)
    v_mfma_f32_32x32x16_bf16 v[48:63], a[112:115], v[112:115], v[48:63]
    s_add_u32 s64, s64, 4096
    buffer_load_dwordx4 v[112:115], v26, s[8:11], s64 offen offset:0 sc1
    s_waitcnt vmcnt(15)
    v_mfma_f32_32x32x16_bf16 v[48:63], a[116:119], v[116:119], v[48:63]
    buffer_load_dwordx4 v[116:119], v26, s[8:11], s64 offen offset:1024 sc1
    s_waitcnt vmcnt(15)
    v_mfma_f32_32x32x16_bf16 v[48:63], a[120:123], v[120:123], v[48:63]
    buffer_load_dwordx4 v[120:123], v26, s[8:11], s64 offen offset:2048 sc1
    s_waitcnt vmcnt(15)
    v_mfma_f32_32x32x16_bf16 v[48:63], a[124:127], v[124:127], v[48:63]
    buffer_load_dwordx4 v[124:127], v26, s[8:11], s64 offen offset:3072 sc1
    s_waitcnt vmcnt(15)
    v_mfma_f32_32x32x16_bf16 v[48:63], a[128:131], v[64:67], v[48:63]
    s_add_u32 s64, s64, 4096
    buffer_load_dwordx4 v[64:67], v26, s[8:11], s64 offen offset:0 sc1
    s_waitcnt vmcnt(15)
    v_mfma_f32_32x32x16_bf16 v[48:63], a[132:135], v[68:71], v[48:63]
    buffer_load_dwordx4 v[68:71], v26, s[8:11], s64 offen offset:1024 sc1
    s_waitcnt vmcnt(15)
    v_mfma_f32_32x32x16_bf16 v[48:63], a[136:139], v[72:75], v[48:63]
    buffer_load_dwordx4 v[72:75], v26, s[8:11], s64 offen offset:2048 sc1
    s_waitcnt vmcnt(15)
    v_mfma_f32_32x32x16_bf16 v[48:63], a[140:143], v[76:79], v[48:63]
    buffer_load_dwordx4 v[76:79], v26, s[8:11], s64 offen offset:3072 sc1
    s_waitcnt vmcnt(15)
    v_mfma_f32_32x32x16_bf16 v[48:63], a[144:147], v[80:83], v[48:63]
    s_add_u32 s64, s64, 4096
    buffer_load_dwordx4 v[80:83], v26, s[8:11], s64 offen offset:0 sc1
    s_waitcnt vmcnt(15)
    v_mfma_f32_32x32x16_bf16 v[48:63], a[148:151], v[84:87], v[48:63]
    buffer_load_dwordx4 v[84:87], v26, s[8:11], s64 offen offset:1024 sc1
    s_waitcnt vmcnt(15)
    v_mfma_f32_32x32x16_bf16 v[48:63], a[152:155], v[88:91], v[48:63]
    buffer_load_dwordx4 v[88:91], v26, s[8:11], s64 offen offset:2048 sc1
    s_waitcnt vmcnt(15)
    v_mfma_f32_32x32x16_bf16 v[48:63], a[156:159], v[92:95], v[48:63]
    buffer_load_dwordx4 v[92:95], v26, s[8:11], s64 offen offset:3072 sc1
    s_waitcnt vmcnt(15)
    v_mfma_f32_32x32x16_bf16 v[48:63], a[160:163], v[96:99], v[48:63]
    s_add_u32 s64, s64, 4096
    buffer_load_dwordx4 v[96:99], v26, s[8:11], s64 offen offset:0 sc1
    s_waitcnt vmcnt(15)
    v_mfma_f32_32x32x16_bf16 v[48:63], a[164:167], v[100:103], v[48:63]
    buffer_load_dwordx4 v[100:103], v26, s[8:11], s64 offen offset:1024 sc1
    s_waitcnt vmcnt(15)
    v_mfma_f32_32x32x16_bf16 v[48:63], a[168:171], v[104:107], v[48:63]
    buffer_load_dwordx4 v[104:107], v26, s[8:11], s64 offen offset:2048 sc1
    s_waitcnt vmcnt(15)
    v_mfma_f32_32x32x16_bf16 v[48:63], a[172:175], v[108:111], v[48:63]
    buffer_load_dwordx4 v[108:111], v26, s[8:11], s64 offen offset:3072 sc1
    s_waitcnt vmcnt(15)
    v_mfma_f32_32x32x16_bf16 v[48:63], a[176:179], v[112:115], v[48:63]
    s_add_u32 s64, s64, 4096
    buffer_load_dwordx4 v[112:115], v26, s[8:11], s64 offen offset:0 sc1
    s_waitcnt vmcnt(15)
    v_mfma_f32_32x32x16_bf16 v[48:63], a[180:183], v[116:119], v[48:63]
    buffer_load_dwordx4 v[116:119], v26, s[8:11], s64 offen offset:1024 sc1
    s_waitcnt vmcnt(15)
    v_mfma_f32_32x32x16_bf16 v[48:63], a[184:187], v[120:123], v[48:63]
    buffer_load_dwordx4 v[120:123], v26, s[8:11], s64 offen offset:2048 sc1
    s_waitcnt vmcnt(15)
    v_mfma_f32_32x32x16_bf16 v[48:63], a[188:191], v[124:127], v[48:63]
    buffer_load_dwordx4 v[124:127], v26, s[8:11], s64 offen offset:3072 sc1
    s_waitcnt vmcnt(15)
    v_mfma_f32_32x32x16_bf16 v[48:63], a[192:195], v[64:67], v[48:63]
    s_waitcnt vmcnt(14)
    v_mfma_f32_32x32x16_bf16 v[48:63], a[196:199], v[68:71], v[48:63]
    s_waitcnt vmcnt(13)
    v_mfma_f32_32x32x16_bf16 v[48:63], a[200:203], v[72:75], v[48:63]
    s_waitcnt vmcnt(12)
    v_mfma_f32_32x32x16_bf16 v[48:63], a[204:207], v[76:79], v[48:63]
    s_waitcnt vmcnt(11)
    v_mfma_f32_32x32x16_bf16 v[48:63], a[208:211], v[80:83], v[48:63]
    s_waitcnt vmcnt(10)
    v_mfma_f32_32x32x16_bf16 v[48:63], a[212:215], v[84:87], v[48:63]
    s_waitcnt vmcnt(9)
    v_mfma_f32_32x32x16_bf16 v[48:63], a[216:219], v[88:91], v[48:63]
    s_waitcnt vmcnt(8)
    v_mfma_f32_32x32x16_bf16 v[48:63], a[220:223], v[92:95], v[48:63]
    s_waitcnt vmcnt(7)
    v_mfma_f32_32x32x16_bf16 v[48:63], a[224:227], v[96:99], v[48:63]
    s_waitcnt vmcnt(6)
    v_mfma_f32_32x32x16_bf16 v[48:63], a[228:231], v[100:103], v[48:63]
    s_waitcnt vmcnt(5)
    v_mfma_f32_32x32x16_bf16 v[48:63], a[232:235], v[104:107], v[48:63]
    s_waitcnt vmcnt(4)
    v_mfma_f32_32x32x16_bf16 v[48:63], a[236:239], v[108:111], v[48:63]
    s_waitcnt vmcnt(3)
    v_mfma_f32_32x32x16_bf16 v[48:63], a[240:243], v[112:115], v[48:63]
    s_waitcnt vmcnt(2)
    v_mfma_f32_32x32x16_bf16 v[48:63], a[244:247], v[116:119], v[48:63]
    s_waitcnt vmcnt(1)
    v_mfma_f32_32x32x16_bf16 v[48:63], a[248:251], v[120:123], v[48:63]
    s_waitcnt vmcnt(0)
    v_mfma_f32_32x32x16_bf16 v[48:63], a[252:255], v[124:127], v[48:63]
    s_nop 11
    ds_write_b128 v5, v[48:51] offset:16384
    ds_write_b128 v5, v[52:55] offset:17408
    ds_write_b128 v5, v[56:59] offset:18432
    ds_write_b128 v5, v[60:63] offset:19456
    s_waitcnt lgkmcnt(0)
    s_barrier
    ds_read_b128 v[192:195], v6 offset:16384
    ds_read_b128 v[196:199], v6 offset:20480
    ds_read_b128 v[200:203], v6 offset:24576
    ds_read_b128 v[204:207], v6 offset:28672
    s_waitcnt lgkmcnt(2)
    v_add_f32 v192, v192, v196
    v_add_f32 v193, v193, v197
    v_add_f32 v194, v194, v198
    v_add_f32 v195, v195, v199
    s_waitcnt lgkmcnt(0)
    v_add_f32 v200, v200, v204
    v_add_f32 v201, v201, v205
    v_add_f32 v202, v202, v206
    v_add_f32 v203, v203, v207
    v_add_f32 v48, v192, v200
    v_add_f32 v49, v193, v201
    v_add_f32 v50, v194, v202
    v_add_f32 v51, v195, v203
    s_branch W_j
W_h:
    buffer_load_dwordx4 v[64:67], v26, s[8:11], s64 offen offset:0 sc1
    buffer_load_dwordx4 v[68:71], v26, s[8:11], s64 offen offset:2048 sc1
    s_add_u32 s64, s64, 4096
    buffer_load_dwordx4 v[72:75], v26, s[8:11], s64 offen offset:0 sc1
    buffer_load_dwordx4 v[76:79], v26, s[8:11], s64 offen offset:2048 sc1
    s_add_u32 s64, s64, 4096
    buffer_load_dwordx4 v[80:83], v26, s[8:11], s64 offen offset:0 sc1
    buffer_load_dwordx4 v[84:87], v26, s[8:11], s64 offen offset:2048 sc1
    s_add_u32 s64, s64, 4096
    buffer_load_dwordx4 v[88:91], v26, s[8:11], s64 offen offset:0 sc1
    buffer_load_dwordx4 v[92:95], v26, s[8:11], s64 offen offset:2048 sc1
    s_add_u32 s64, s64, 4096
    buffer_load_dwordx4 v[96:99], v26, s[8:11], s64 offen offset:0 sc1
    buffer_load_dwordx4 v[100:103], v26, s[8:11], s64 offen offset:2048 sc1
    s_add_u32 s64, s64, 4096
    buffer_load_dwordx4 v[104:107], v26, s[8:11], s64 offen offset:0 sc1
    buffer_load_dwordx4 v[108:111], v26, s[8:11], s64 offen offset:2048 sc1
    s_add_u32 s64, s64, 4096
    buffer_load_dwordx4 v[112:115], v26, s[8:11], s64 offen offset:0 sc1
    buffer_load_dwordx4 v[116:119], v26, s[8:11], s64 offen offset:2048 sc1
    s_add_u32 s64, s64, 4096
    buffer_load_dwordx4 v[120:123], v26, s[8:11], s64 offen offset:0 sc1
    buffer_load_dwordx4 v[124:127], v26, s[8:11], s64 offen offset:2048 sc1
    s_add_u32 s64, s64, 4096
    buffer_load_dwordx4 v[128:131], v26, s[8:11], s64 offen offset:0 sc1
    buffer_load_dwordx4 v[132:135], v26, s[8:11], s64 offen offset:2048 sc1
    s_add_u32 s64, s64, 4096
    buffer_load_dwordx4 v[136:139], v26, s[8:11], s64 offen offset:0 sc1
    buffer_load_dwordx4 v[140:143], v26, s[8:11], s64 offen offset:2048 sc1
    s_add_u32 s64, s64, 4096
    buffer_load_dwordx4 v[144:147], v26, s[8:11], s64 offen offset:0 sc1
    buffer_load_dwordx4 v[148:151], v26, s[8:11], s64 offen offset:2048 sc1
    s_add_u32 s64, s64, 4096
    buffer_load_dwordx4 v[152:155], v26, s[8:11], s64 offen offset:0 sc1
    buffer_load_dwordx4 v[156:159], v26, s[8:11], s64 offen offset:2048 sc1
    s_add_u32 s64, s64, 4096
    buffer_load_dwordx4 v[160:163], v26, s[8:11], s64 offen offset:0 sc1
    buffer_load_dwordx4 v[164:167], v26, s[8:11], s64 offen offset:2048 sc1
    s_add_u32 s64, s64, 4096
    buffer_load_dwordx4 v[168:171], v26, s[8:11], s64 offen offset:0 sc1
    buffer_load_dwordx4 v[172:175], v26, s[8:11], s64 offen offset:2048 sc1
    s_add_u32 s64, s64, 4096
    buffer_load_dwordx4 v[176:179], v26, s[8:11], s64 offen offset:0 sc1
    buffer_load_dwordx4 v[180:183], v26, s[8:11], s64 offen offset:2048 sc1
    s_add_u32 s64, s64, 4096
    buffer_load_dwordx4 v[184:187], v26, s[8:11], s64 offen offset:0 sc1
    buffer_load_dwordx4 v[188:191], v26, s[8:11], s64 offen offset:2048 sc1
    s_waitcnt vmcnt(31)
    v_mfma_f32_32x32x16_bf16 v[48:63], a[0:3], v[64:67], 0
    v_mfma_f32_32x32x16_bf16 v[208:223], a[4:7], v[64:67], 0
    s_waitcnt vmcnt(30)
    v_mfma_f32_32x32x16_bf16 v[48:63], a[8:11], v[68:71], v[48:63]
    v_mfma_f32_32x32x16_bf16 v[208:223], a[12:15], v[68:71], v[208:223]
    s_waitcnt vmcnt(29)
    v_mfma_f32_32x32x16_bf16 v[48:63], a[16:19], v[72:75], v[48:63]
    v_mfma_f32_32x32x16_bf16 v[208:223], a[20:23], v[72:75], v[208:223]
    s_waitcnt vmcnt(28)
    v_mfma_f32_32x32x16_bf16 v[48:63], a[24:27], v[76:79], v[48:63]
    v_mfma_f32_32x32x16_bf16 v[208:223], a[28:31], v[76:79], v[208:223]
    s_waitcnt vmcnt(27)
    v_mfma_f32_32x32x16_bf16 v[48:63], a[32:35], v[80:83], v[48:63]
    v_mfma_f32_32x32x16_bf16 v[208:223], a[36:39], v[80:83], v[208:223]
    s_waitcnt vmcnt(26)
    v_mfma_f32_32x32x16_bf16 v[48:63], a[40:43], v[84:87], v[48:63]
    v_mfma_f32_32x32x16_bf16 v[208:223], a[44:47], v[84:87], v[208:223]
    s_waitcnt vmcnt(25)
    v_mfma_f32_32x32x16_bf16 v[48:63], a[48:51], v[88:91], v[48:63]
    v_mfma_f32_32x32x16_bf16 v[208:223], a[52:55], v[88:91], v[208:223]
    s_waitcnt vmcnt(24)
    v_mfma_f32_32x32x16_bf16 v[48:63], a[56:59], v[92:95], v[48:63]
    v_mfma_f32_32x32x16_bf16 v[208:223], a[60:63], v[92:95], v[208:223]
    s_waitcnt vmcnt(23)
    v_mfma_f32_32x32x16_bf16 v[48:63], a[64:67], v[96:99], v[48:63]
    v_mfma_f32_32x32x16_bf16 v[208:223], a[68:71], v[96:99], v[208:223]
    s_waitcnt vmcnt(22)
    v_mfma_f32_32x32x16_bf16 v[48:63], a[72:75], v[100:103], v[48:63]
    v_mfma_f32_32x32x16_bf16 v[208:223], a[76:79], v[100:103], v[208:223]
    s_waitcnt vmcnt(21)
    v_mfma_f32_32x32x16_bf16 v[48:63], a[80:83], v[104:107], v[48:63]
    v_mfma_f32_32x32x16_bf16 v[208:223], a[84:87], v[104:107], v[208:223]
    s_waitcnt vmcnt(20)
    v_mfma_f32_32x32x16_bf16 v[48:63], a[88:91], v[108:111], v[48:63]
    v_mfma_f32_32x32x16_bf16 v[208:223], a[92:95], v[108:111], v[208:223]
    s_waitcnt vmcnt(19)
    v_mfma_f32_32x32x16_bf16 v[48:63], a[96:99], v[112:115], v[48:63]
    v_mfma_f32_32x32x16_bf16 v[208:223], a[100:103], v[112:115], v[208:223]
    s_waitcnt vmcnt(18)
    v_mfma_f32_32x32x16_bf16 v[48:63], a[104:107], v[116:119], v[48:63]
    v_mfma_f32_32x32x16_bf16 v[208:223], a[108:111], v[116:119], v[208:223]
    s_waitcnt vmcnt(17)
    v_mfma_f32_32x32x16_bf16 v[48:63], a[112:115], v[120:123], v[48:63]
    v_mfma_f32_32x32x16_bf16 v[208:223], a[116:119], v[120:123], v[208:223]
    s_waitcnt vmcnt(16)
    v_mfma_f32_32x32x16_bf16 v[48:63], a[120:123], v[124:127], v[48:63]
    v_mfma_f32_32x32x16_bf16 v[208:223], a[124:127], v[124:127], v[208:223]
    s_waitcnt vmcnt(15)
    v_mfma_f32_32x32x16_bf16 v[48:63], a[128:131], v[128:131], v[48:63]
    v_mfma_f32_32x32x16_bf16 v[208:223], a[132:135], v[128:131], v[208:223]
    s_waitcnt vmcnt(14)
    v_mfma_f32_32x32x16_bf16 v[48:63], a[136:139], v[132:135], v[48:63]
    v_mfma_f32_32x32x16_bf16 v[208:223], a[140:143], v[132:135], v[208:223]
    s_waitcnt vmcnt(13)
    v_mfma_f32_32x32x16_bf16 v[48:63], a[144:147], v[136:139], v[48:63]
    v_mfma_f32_32x32x16_bf16 v[208:223], a[148:151], v[136:139], v[208:223]
    s_waitcnt vmcnt(12)
    v_mfma_f32_32x32x16_bf16 v[48:63], a[152:155], v[140:143], v[48:63]
    v_mfma_f32_32x32x16_bf16 v[208:223], a[156:159], v[140:143], v[208:223]
    s_waitcnt vmcnt(11)
    v_mfma_f32_32x32x16_bf16 v[48:63], a[160:163], v[144:147], v[48:63]
    v_mfma_f32_32x32x16_bf16 v[208:223], a[164:167], v[144:147], v[208:223]
    s_waitcnt vmcnt(10)
    v_mfma_f32_32x32x16_bf16 v[48:63], a[168:171], v[148:151], v[48:63]
    v_mfma_f32_32x32x16_bf16 v[208:223], a[172:175], v[148:151], v[208:223]
    s_waitcnt vmcnt(9)
    v_mfma_f32_32x32x16_bf16 v[48:63], a[176:179], v[152:155], v[48:63]
    v_mfma_f32_32x32x16_bf16 v[208:223], a[180:183], v[152:155], v[208:223]
    s_waitcnt vmcnt(8)
    v_mfma_f32_32x32x16_bf16 v[48:63], a[184:187], v[156:159], v[48:63]
    v_mfma_f32_32x32x16_bf16 v[208:223], a[188:191], v[156:159], v[208:223]
    s_waitcnt vmcnt(7)
    v_mfma_f32_32x32x16_bf16 v[48:63], a[192:195], v[160:163], v[48:63]
    v_mfma_f32_32x32x16_bf16 v[208:223], a[196:199], v[160:163], v[208:223]
    s_waitcnt vmcnt(6)
    v_mfma_f32_32x32x16_bf16 v[48:63], a[200:203], v[164:167], v[48:63]
    v_mfma_f32_32x32x16_bf16 v[208:223], a[204:207], v[164:167], v[208:223]
    s_waitcnt vmcnt(5)
    v_mfma_f32_32x32x16_bf16 v[48:63], a[208:211], v[168:171], v[48:63]
    v_mfma_f32_32x32x16_bf16 v[208:223], a[212:215], v[168:171], v[208:223]
    s_waitcnt vmcnt(4)
    v_mfma_f32_32x32x16_bf16 v[48:63], a[216:219], v[172:175], v[48:63]
    v_mfma_f32_32x32x16_bf16 v[208:223], a[220:223], v[172:175], v[208:223]
    s_waitcnt vmcnt(3)
    v_mfma_f32_32x32x16_bf16 v[48:63], a[224:227], v[176:179], v[48:63]
    v_mfma_f32_32x32x16_bf16 v[208:223], a[228:231], v[176:179], v[208:223]
    s_waitcnt vmcnt(2)
    v_mfma_f32_32x32x16_bf16 v[48:63], a[232:235], v[180:183], v[48:63]
    v_mfma_f32_32x32x16_bf16 v[208:223], a[236:239], v[180:183], v[208:223]
    s_waitcnt vmcnt(1)
    v_mfma_f32_32x32x16_bf16 v[48:63], a[240:243], v[184:187], v[48:63]
    v_mfma_f32_32x32x16_bf16 v[208:223], a[244:247], v[184:187], v[208:223]
    s_waitcnt vmcnt(0)
    v_mfma_f32_32x32x16_bf16 v[48:63], a[248:251], v[188:191], v[48:63]
    v_mfma_f32_32x32x16_bf16 v[208:223], a[252:255], v[188:191], v[208:223]
    v_xor_b32 v8, 0x100, v6
    s_nop 9
    ds_write_b128 v5, v[48:51] offset:16384
    ds_write_b128 v5, v[52:55] offset:17408
    ds_write_b128 v5, v[56:59] offset:18432
    ds_write_b128 v5, v[60:63] offset:19456
    ds_write_b128 v5, v[208:211] offset:32768
    ds_write_b128 v5, v[212:215] offset:33792
    ds_write_b128 v5, v[216:219] offset:34816
    ds_write_b128 v5, v[220:223] offset:35840
    s_waitcnt lgkmcnt(0)
    s_barrier
    ds_read_b128 v[192:195], v6 offset:16384
    ds_read_b128 v[196:199], v6 offset:20480
    ds_read_b128 v[200:203], v6 offset:24576
    ds_read_b128 v[204:207], v6 offset:28672
    ds_read_b128 v[64:67], v8 offset:32768
    ds_read_b128 v[68:71], v8 offset:36864
    ds_read_b128 v[72:75], v8 offset:40960
    ds_read_b128 v[76:79], v8 offset:45056
    s_waitcnt lgkmcnt(3)
    v_add_f32 v192, v192, v64
    v_add_f32 v193, v193, v65
    v_add_f32 v194, v194, v66
    v_add_f32 v195, v195, v67
    s_waitcnt lgkmcnt(2)
    v_add_f32 v196, v196, v68
    v_add_f32 v197, v197, v69
    v_add_f32 v198, v198, v70
    v_add_f32 v199, v199, v71
    s_waitcnt lgkmcnt(1)
    v_add_f32 v200, v200, v72
    v_add_f32 v201, v201, v73
    v_add_f32 v202, v202, v74
    v_add_f32 v203, v203, v75
    s_waitcnt lgkmcnt(0)
    v_add_f32 v204, v204, v76
    v_add_f32 v205, v205, v77
    v_add_f32 v206, v206, v78
    v_add_f32 v207, v207, v79
    v_add_f32 v192, v192, v196
    v_add_f32 v193, v193, v197
    v_add_f32 v194, v194, v198
    v_add_f32 v195, v195, v199
    v_add_f32 v200, v200, v204
    v_add_f32 v201, v201, v205
    v_add_f32 v202, v202, v206
    v_add_f32 v203, v203, v207
    v_add_f32 v48, v192, v200
    v_add_f32 v49, v193, v201
    v_add_f32 v50, v194, v202
    v_add_f32 v51, v195, v203
W_j:
    v_cvt_pk_bf16_f32 v192, v48, v49
    v_cvt_pk_bf16_f32 v193, v50, v51
    v_lshlrev_b32 v48, 16, v192
    v_and_b32 v49, 0xffff0000, v192
    v_lshlrev_b32 v50, 16, v193
    v_and_b32 v51, 0xffff0000, v193
    v_mul_f32 v48, v48, v22
    v_mul_f32 v49, v49, v23
    v_mul_f32 v50, v50, v24
    v_mul_f32 v51, v51, v25
    v_cvt_pk_bf16_f32 v192, v48, v49
    v_cvt_pk_bf16_f32 v193, v50, v51
    v_lshlrev_b32 v48, 16, v192
    v_and_b32 v49, 0xffff0000, v192
    v_lshlrev_b32 v50, 16, v193
    v_and_b32 v51, 0xffff0000, v193
    v_lshlrev_b32 v196, 16, v20
    v_and_b32 v197, 0xffff0000, v20
    v_lshlrev_b32 v198, 16, v21
    v_and_b32 v199, 0xffff0000, v21
    v_add_f32 v48, v48, v196
    v_add_f32 v49, v49, v197
    v_add_f32 v50, v50, v198
    v_add_f32 v51, v51, v199
    v_cvt_pk_bf16_f32 v200, v48, v49
    v_cvt_pk_bf16_f32 v201, v50, v51
    buffer_store_dwordx2 v[200:201], v27, s[24:27], s23 offen
    s_cmp_ge_u32 s20, 62
    s_cbranch_scc1 W_done
    s_add_u32 s20, s20, 6
    s_cmp_lt_u32 s20, 62
    s_cbranch_scc1 W_loop
    s_cmp_ge_u32 s20, 66
    s_cbranch_scc1 W_done
    s_mov_b32 s64, 0
    s_cmp_lt_u32 s20, 64
    s_cbranch_scc1 W_half
    s_sub_u32 s20, s20, 2
    s_mov_b32 s64, 16
W_half:
    v_and_b32 v192, 16, v7
    v_cmp_eq_u32 vcc, s64, v192
    v_mov_b32 v192, 0x7ff00000
    v_xor_b32 v193, 0x100, v0
    v_add_u32 v193, 0x400, v193
    v_cndmask_b32 v26, v193, v0, vcc
    v_cndmask_b32 v27, v192, v3, vcc
    s_branch W_loop
W_done:
    s_branch M_fin
M_attn:
    v_min_u32 v6, 63, v7
    v_lshlrev_b32 v6, 2, v6
    s_mov_b32 s64, 109052928
A_g1:
    buffer_load_dword v8, v6, s[8:11], s64 offen offset:0 sc1
    buffer_load_dword v9, v6, s[8:11], s64 offen offset:128 sc1
    s_sub_u32 s40, s40, 1
    s_cbranch_scc1 M_fin
    s_waitcnt vmcnt(0)
    v_min_u32 v8, v8, v9
    v_cmp_eq_u32 vcc, 0, v8
    s_cbranch_vccz A_g1_ok
    s_sleep 2
    s_branch A_g1
A_g1_ok:
    v_lshlrev_b32 v6, 4, v7
    s_mov_b32 s64, 109064192
A_g1_kv:
    buffer_load_dwordx4 v[8:11], v6, s[8:11], s64 offen offset:0 sc1
    buffer_load_dwordx4 v[12:15], v6, s[8:11], s64 offen offset:1024 sc1
    buffer_load_dwordx4 v[16:19], v6, s[8:11], s64 offen offset:2048 sc1
    buffer_load_dwordx4 v[20:23], v6, s[8:11], s64 offen offset:3072 sc1
    s_sub_u32 s40, s40, 1
    s_cbranch_scc1 M_fin
    s_waitcnt vmcnt(3)
    v_min3_u32 v8, v8, v9, v10
    s_waitcnt vmcnt(2)
    v_min3_u32 v8, v8, v11, v12
    v_min3_u32 v8, v8, v13, v14
    s_waitcnt vmcnt(1)
    v_min3_u32 v8, v8, v15, v16
    v_min3_u32 v8, v8, v17, v18
    s_waitcnt vmcnt(0)
    v_min3_u32 v8, v8, v19, v20
    v_min3_u32 v8, v8, v21, v22
    v_min_u32 v8, v8, v23
    v_cmp_eq_u32 vcc, 0, v8
    s_cbranch_vccnz A_g1_kv
    s_sub_u32 s22, s5, 20
    s_lshl_b32 s21, s22, 2
    s_add_u32 s21, s21, s4
    s_mov_b32 s20, s3
    s_mov_b32 s23, 0x3fb8aa3b
    s_mov_b32 s27, 0x3db504f3
    v_lshrrev_b32 v8, 5, v7
    v_and_b32 v9, 7, v7
    v_lshlrev_b32 v9, 4, v9
    v_lshl_add_u32 v1, v8, 7, v9
    v_and_b32 v9, 31, v7
    v_lshlrev_b32 v10, 2, v9
    v_lshl_add_u32 v2, v8, 8, v10
    v_lshlrev_b32 v10, 2, v8
    v_sub_u32 v10, v9, v10
    v_cmp_le_i32 s[70:71], 0, v10
    v_cmp_le_i32 s[72:73], 1, v10
    v_cmp_le_i32 s[74:75], 2, v10
    v_cmp_le_i32 s[76:77], 3, v10
    v_cmp_le_i32 s[78:79], 8, v10
    v_cmp_le_i32 s[80:81], 9, v10
    v_cmp_le_i32 s[82:83], 10, v10
    v_cmp_le_i32 s[84:85], 11, v10
    v_cmp_le_i32 s[86:87], 16, v10
    v_cmp_le_i32 s[88:89], 17, v10
    v_cmp_le_i32 s[90:91], 18, v10
    v_cmp_le_i32 s[92:93], 19, v10
    v_cmp_le_i32 s[94:95], 24, v10
    v_cmp_le_i32 s[96:97], 25, v10
    v_cmp_le_i32 s[98:99], 26, v10
    v_cmp_le_i32 s[100:101], 27, v10
    v_and_b32 v9, 1, v7
    v_lshlrev_b32 v9, 12, v9
    s_lshl_b32 s64, s21, 7
    v_add_u32 v3, s64, v9
    v_mov_b64 v[106:107], 0
    v_mov_b64 v[110:111], 0
    v_mov_b64 v[114:115], 0
    v_mov_b64 v[118:119], 0
    v_mov_b64 v[162:163], 0
A_loop:
    s_lshl_b32 s64, s20, 5
    s_add_u32 s64, s64, s21
    s_lshl_b32 s25, s64, 14
    s_lshl_b32 s24, s64, 13
    s_lshl_b32 s26, s64, 12
    s_add_u32 s26, s26, 88080384
    s_add_u32 s65, s24, 33554432
    s_add_u32 s66, s65, 4096
    s_add_u32 s67, s25, 4096
    s_add_u32 s68, s25, 8192
    s_add_u32 s69, s25, 12288
    buffer_load_dwordx4 v[8:11], v0, s[8:11], s65 offen offset:0 sc1
    buffer_load_dwordx4 v[40:43], v0, s[8:11], s25 offen offset:0 sc1
    buffer_load_dwordx4 v[12:15], v0, s[8:11], s65 offen offset:1024 sc1
    buffer_load_dwordx4 v[44:47], v0, s[8:11], s25 offen offset:1024 sc1
    buffer_load_dwordx4 v[16:19], v0, s[8:11], s65 offen offset:2048 sc1
    buffer_load_dwordx4 v[48:51], v0, s[8:11], s25 offen offset:2048 sc1
    buffer_load_dwordx4 v[20:23], v0, s[8:11], s65 offen offset:3072 sc1
    buffer_load_dwordx4 v[52:55], v0, s[8:11], s25 offen offset:3072 sc1
    buffer_load_dwordx4 v[24:27], v0, s[8:11], s66 offen offset:0 sc1
    buffer_load_dwordx4 v[56:59], v0, s[8:11], s67 offen offset:0 sc1
    buffer_load_dwordx4 v[28:31], v0, s[8:11], s66 offen offset:1024 sc1
    buffer_load_dwordx4 v[60:63], v0, s[8:11], s67 offen offset:1024 sc1
    buffer_load_dwordx4 v[32:35], v0, s[8:11], s66 offen offset:2048 sc1
    buffer_load_dwordx4 v[64:67], v0, s[8:11], s67 offen offset:2048 sc1
    buffer_load_dwordx4 v[36:39], v0, s[8:11], s66 offen offset:3072 sc1
    buffer_load_dwordx4 v[68:71], v0, s[8:11], s67 offen offset:3072 sc1
    buffer_load_dwordx4 v[72:75], v0, s[8:11], s68 offen offset:0 sc1
    buffer_load_dwordx4 v[76:79], v0, s[8:11], s68 offen offset:1024 sc1
    buffer_load_dwordx4 v[80:83], v0, s[8:11], s68 offen offset:2048 sc1
    buffer_load_dwordx4 v[84:87], v0, s[8:11], s68 offen offset:3072 sc1
    buffer_load_dwordx4 v[88:91], v0, s[8:11], s69 offen offset:0 sc1
    buffer_load_dwordx4 v[92:95], v0, s[8:11], s69 offen offset:1024 sc1
    buffer_load_dwordx4 v[96:99], v0, s[8:11], s69 offen offset:2048 sc1
    buffer_load_dwordx4 v[100:103], v0, s[8:11], s69 offen offset:3072 sc1
    s_waitcnt vmcnt(22)
    v_mfma_f32_32x32x16_bf16 v[120:135], v[40:43], v[8:11], 0
    s_waitcnt vmcnt(20)
    v_mfma_f32_32x32x16_bf16 v[120:135], v[44:47], v[12:15], v[120:135]
    s_waitcnt vmcnt(18)
    v_mfma_f32_32x32x16_bf16 v[120:135], v[48:51], v[16:19], v[120:135]
    s_waitcnt vmcnt(16)
    v_mfma_f32_32x32x16_bf16 v[120:135], v[52:55], v[20:23], v[120:135]
    s_waitcnt vmcnt(14)
    v_mfma_f32_32x32x16_bf16 v[120:135], v[56:59], v[24:27], v[120:135]
    s_waitcnt vmcnt(12)
    v_mfma_f32_32x32x16_bf16 v[120:135], v[60:63], v[28:31], v[120:135]
    s_waitcnt vmcnt(10)
    v_mfma_f32_32x32x16_bf16 v[120:135], v[64:67], v[32:35], v[120:135]
    s_waitcnt vmcnt(8)
    v_mfma_f32_32x32x16_bf16 v[120:135], v[68:71], v[36:39], v[120:135]
    s_nop 11
    v_cvt_pk_bf16_f32 v152, v120, v121
    v_cvt_pk_bf16_f32 v153, v122, v123
    v_cvt_pk_bf16_f32 v154, v124, v125
    v_cvt_pk_bf16_f32 v155, v126, v127
    v_cvt_pk_bf16_f32 v156, v128, v129
    v_cvt_pk_bf16_f32 v157, v130, v131
    v_cvt_pk_bf16_f32 v158, v132, v133
    v_cvt_pk_bf16_f32 v159, v134, v135
    v_lshlrev_b32 v120, 16, v152
    v_and_b32 v121, 0xffff0000, v152
    v_lshlrev_b32 v122, 16, v153
    v_and_b32 v123, 0xffff0000, v153
    v_lshlrev_b32 v124, 16, v154
    v_and_b32 v125, 0xffff0000, v154
    v_lshlrev_b32 v126, 16, v155
    v_and_b32 v127, 0xffff0000, v155
    v_lshlrev_b32 v128, 16, v156
    v_and_b32 v129, 0xffff0000, v156
    v_lshlrev_b32 v130, 16, v157
    v_and_b32 v131, 0xffff0000, v157
    v_lshlrev_b32 v132, 16, v158
    v_and_b32 v133, 0xffff0000, v158
    v_lshlrev_b32 v134, 16, v159
    v_and_b32 v135, 0xffff0000, v159
    v_mul_f32 v120, s27, v120
    v_mul_f32 v121, s27, v121
    v_mul_f32 v122, s27, v122
    v_mul_f32 v123, s27, v123
    v_mul_f32 v124, s27, v124
    v_mul_f32 v125, s27, v125
    v_mul_f32 v126, s27, v126
    v_mul_f32 v127, s27, v127
    v_mul_f32 v128, s27, v128
    v_mul_f32 v129, s27, v129
    v_mul_f32 v130, s27, v130
    v_mul_f32 v131, s27, v131
    v_mul_f32 v132, s27, v132
    v_mul_f32 v133, s27, v133
    v_mul_f32 v134, s27, v134
    v_mul_f32 v135, s27, v135
    v_cvt_pk_bf16_f32 v152, v120, v121
    v_cvt_pk_bf16_f32 v153, v122, v123
    v_cvt_pk_bf16_f32 v154, v124, v125
    v_cvt_pk_bf16_f32 v155, v126, v127
    v_cvt_pk_bf16_f32 v156, v128, v129
    v_cvt_pk_bf16_f32 v157, v130, v131
    v_cvt_pk_bf16_f32 v158, v132, v133
    v_cvt_pk_bf16_f32 v159, v134, v135
    v_lshlrev_b32 v120, 16, v152
    v_and_b32 v121, 0xffff0000, v152
    v_lshlrev_b32 v122, 16, v153
    v_and_b32 v123, 0xffff0000, v153
    v_lshlrev_b32 v124, 16, v154
    v_and_b32 v125, 0xffff0000, v154
    v_lshlrev_b32 v126, 16, v155
    v_and_b32 v127, 0xffff0000, v155
    v_lshlrev_b32 v128, 16, v156
    v_and_b32 v129, 0xffff0000, v156
    v_lshlrev_b32 v130, 16, v157
    v_and_b32 v131, 0xffff0000, v157
    v_lshlrev_b32 v132, 16, v158
    v_and_b32 v133, 0xffff0000, v158
    v_lshlrev_b32 v134, 16, v159
    v_and_b32 v135, 0xffff0000, v159
    v_mov_b32 v6, 0xff800000
    v_cndmask_b32 v120, v6, v120, s[70:71]
    v_cndmask_b32 v121, v6, v121, s[72:73]
    v_cndmask_b32 v122, v6, v122, s[74:75]
    v_cndmask_b32 v123, v6, v123, s[76:77]
    v_cndmask_b32 v124, v6, v124, s[78:79]
    v_cndmask_b32 v125, v6, v125, s[80:81]
    v_cndmask_b32 v126, v6, v126, s[82:83]
    v_cndmask_b32 v127, v6, v127, s[84:85]
    v_cndmask_b32 v128, v6, v128, s[86:87]
    v_cndmask_b32 v129, v6, v129, s[88:89]
    v_cndmask_b32 v130, v6, v130, s[90:91]
    v_cndmask_b32 v131, v6, v131, s[92:93]
    v_cndmask_b32 v132, v6, v132, s[94:95]
    v_cndmask_b32 v133, v6, v133, s[96:97]
    v_cndmask_b32 v134, v6, v134, s[98:99]
    v_cndmask_b32 v135, v6, v135, s[100:101]
    v_max3_f32 v4, v120, v121, v122
    v_max3_f32 v4, v4, v123, v124
    v_max3_f32 v4, v4, v125, v126
    v_max3_f32 v4, v4, v127, v128
    v_max3_f32 v4, v4, v129, v130
    v_max3_f32 v4, v4, v131, v132
    v_max3_f32 v4, v4, v133, v134
    v_max_f32 v4, v4, v135
    v_mov_b32 v5, v4
    s_nop 1
    v_permlane32_swap_b32 v4, v5
    v_max_f32 v4, v4, v5
    v_mul_f32 v6, s23, v4
    v_fma_f32 v120, s23, v120, -v6
    v_fma_f32 v121, s23, v121, -v6
    v_fma_f32 v122, s23, v122, -v6
    v_fma_f32 v123, s23, v123, -v6
    v_fma_f32 v124, s23, v124, -v6
    v_fma_f32 v125, s23, v125, -v6
    v_fma_f32 v126, s23, v126, -v6
    v_fma_f32 v127, s23, v127, -v6
    v_fma_f32 v128, s23, v128, -v6
    v_fma_f32 v129, s23, v129, -v6
    v_fma_f32 v130, s23, v130, -v6
    v_fma_f32 v131, s23, v131, -v6
    v_fma_f32 v132, s23, v132, -v6
    v_fma_f32 v133, s23, v133, -v6
    v_fma_f32 v134, s23, v134, -v6
    v_fma_f32 v135, s23, v135, -v6
    v_exp_f32 v120, v120
    v_exp_f32 v121, v121
    v_exp_f32 v122, v122
    v_exp_f32 v123, v123
    v_exp_f32 v124, v124
    v_exp_f32 v125, v125
    v_exp_f32 v126, v126
    v_exp_f32 v127, v127
    v_exp_f32 v128, v128
    v_exp_f32 v129, v129
    v_exp_f32 v130, v130
    v_exp_f32 v131, v131
    v_exp_f32 v132, v132
    v_exp_f32 v133, v133
    v_exp_f32 v134, v134
    v_exp_f32 v135, v135
    v_add_f32 v164, v120, v121
    v_add_f32 v164, v164, v122
    v_add_f32 v164, v164, v123
    v_add_f32 v164, v164, v124
    v_add_f32 v164, v164, v125
    v_add_f32 v164, v164, v126
    v_add_f32 v164, v164, v127
    v_add_f32 v164, v164, v128
    v_add_f32 v164, v164, v129
    v_add_f32 v164, v164, v130
    v_add_f32 v164, v164, v131
    v_add_f32 v164, v164, v132
    v_add_f32 v164, v164, v133
    v_add_f32 v164, v164, v134
    v_add_f32 v164, v164, v135
    s_waitcnt vmcnt(0)
    s_mov_b32 s64, 109056000
    s_add_u32 s65, s24, 50331648
    s_add_u32 s66, s65, 4096
A_pr:
    buffer_load_dword v5, v3, s[8:11], s64 offen offset:0 sc1
    s_sub_u32 s40, s40, 1
    s_cbranch_scc1 M_fin
    s_waitcnt vmcnt(0)
    v_cmp_ge_u32 vcc, s20, v5
    s_cbranch_vccz A_pr_ok
    v_cmp_gt_u32 vcc, s20, v5
    s_cbranch_vccz A_pr_n
    s_sleep 24
A_pr_n:
    s_sleep 2
    s_branch A_pr
A_pr_ok:
    buffer_load_dwordx4 v[40:43], v1, s[8:11], s26 offen offset:0 sc1
    buffer_load_dwordx4 v[44:47], v1, s[8:11], s26 offen offset:256 sc1
    buffer_load_dwordx4 v[48:51], v1, s[8:11], s26 offen offset:512 sc1
    buffer_load_dwordx4 v[52:55], v1, s[8:11], s26 offen offset:768 sc1
    buffer_load_dwordx4 v[56:59], v1, s[8:11], s26 offen offset:1024 sc1
    buffer_load_dwordx4 v[60:63], v1, s[8:11], s26 offen offset:1280 sc1
    buffer_load_dwordx4 v[64:67], v1, s[8:11], s26 offen offset:1536 sc1
    buffer_load_dwordx4 v[68:71], v1, s[8:11], s26 offen offset:1792 sc1
    buffer_load_dword v104, v2, s[8:11], s26 offen offset:2048 sc1
    buffer_load_dword v105, v2, s[8:11], s26 offen offset:2176 sc1
    buffer_load_dword v108, v2, s[8:11], s26 offen offset:2560 sc1
    buffer_load_dword v109, v2, s[8:11], s26 offen offset:2688 sc1
    buffer_load_dword v112, v2, s[8:11], s26 offen offset:3072 sc1
    buffer_load_dword v113, v2, s[8:11], s26 offen offset:3200 sc1
    buffer_load_dword v116, v2, s[8:11], s26 offen offset:3584 sc1
    buffer_load_dword v117, v2, s[8:11], s26 offen offset:3712 sc1
    s_waitcnt vmcnt(15)
    v_mfma_f32_32x32x16_bf16 v[136:151], v[40:43], v[8:11], 0
    s_waitcnt vmcnt(14)
    v_mfma_f32_32x32x16_bf16 v[136:151], v[44:47], v[12:15], v[136:151]
    s_waitcnt vmcnt(13)
    v_mfma_f32_32x32x16_bf16 v[136:151], v[48:51], v[16:19], v[136:151]
    s_waitcnt vmcnt(12)
    v_mfma_f32_32x32x16_bf16 v[136:151], v[52:55], v[20:23], v[136:151]
    s_waitcnt vmcnt(11)
    v_mfma_f32_32x32x16_bf16 v[136:151], v[56:59], v[24:27], v[136:151]
    s_waitcnt vmcnt(10)
    v_mfma_f32_32x32x16_bf16 v[136:151], v[60:63], v[28:31], v[136:151]
    s_waitcnt vmcnt(9)
    v_mfma_f32_32x32x16_bf16 v[136:151], v[64:67], v[32:35], v[136:151]
    s_waitcnt vmcnt(8)
    v_mfma_f32_32x32x16_bf16 v[136:151], v[68:71], v[36:39], v[136:151]
    s_nop 11
    v_cvt_pk_bf16_f32 v152, v136, v137
    v_cvt_pk_bf16_f32 v153, v138, v139
    v_lshlrev_b32 v136, 16, v152
    v_and_b32 v137, 0xffff0000, v152
    v_lshlrev_b32 v138, 16, v153
    v_and_b32 v139, 0xffff0000, v153
    v_mul_f32 v136, s27, v136
    v_mul_f32 v137, s27, v137
    v_mul_f32 v138, s27, v138
    v_mul_f32 v139, s27, v139
    v_cvt_pk_bf16_f32 v152, v136, v137
    v_cvt_pk_bf16_f32 v153, v138, v139
    v_lshlrev_b32 v136, 16, v152
    v_and_b32 v137, 0xffff0000, v152
    v_lshlrev_b32 v138, 16, v153
    v_and_b32 v139, 0xffff0000, v153
    v_max3_f32 v4, v4, v136, v137
    v_max3_f32 v4, v4, v138, v139
    v_mov_b32 v5, v4
    s_nop 1
    v_permlane32_swap_b32 v4, v5
    v_max_f32 v4, v4, v5
    v_mul_f32 v4, s23, v4
    v_sub_f32 v6, v6, v4
    v_fma_f32 v136, s23, v136, -v4
    v_fma_f32 v137, s23, v137, -v4
    v_fma_f32 v138, s23, v138, -v4
    v_fma_f32 v139, s23, v139, -v4
    v_exp_f32 v6, v6
    v_exp_f32 v136, v136
    v_exp_f32 v137, v137
    v_exp_f32 v138, v138
    v_exp_f32 v139, v139
    v_add_f32 v4, v136, v137
    v_add_f32 v5, v138, v139
    v_fmac_f32 v4, v164, v6
    v_add_f32 v4, v4, v5
    v_mov_b32 v5, v4
    s_nop 1
    v_permlane32_swap_b32 v4, v5
    v_add_f32 v4, v4, v5
    v_rcp_f32 v4, v4
    s_nop 0
    v_mul_f32 v6, v6, v4
    v_mul_f32 v136, v136, v4
    v_mul_f32 v137, v137, v4
    v_mul_f32 v138, v138, v4
    v_mul_f32 v139, v139, v4
    v_cvt_pk_bf16_f32 v160, v136, v137
    v_cvt_pk_bf16_f32 v161, v138, v139
    v_mul_f32 v120, v120, v6
    v_mul_f32 v121, v121, v6
    v_mul_f32 v122, v122, v6
    v_mul_f32 v123, v123, v6
    v_mul_f32 v124, v124, v6
    v_mul_f32 v125, v125, v6
    v_mul_f32 v126, v126, v6
    v_mul_f32 v127, v127, v6
    v_mul_f32 v128, v128, v6
    v_mul_f32 v129, v129, v6
    v_mul_f32 v130, v130, v6
    v_mul_f32 v131, v131, v6
    v_mul_f32 v132, v132, v6
    v_mul_f32 v133, v133, v6
    v_mul_f32 v134, v134, v6
    v_mul_f32 v135, v135, v6
    v_cvt_pk_bf16_f32 v152, v120, v121
    v_cvt_pk_bf16_f32 v153, v122, v123
    v_cvt_pk_bf16_f32 v154, v124, v125
    v_cvt_pk_bf16_f32 v155, v126, v127
    v_cvt_pk_bf16_f32 v156, v128, v129
    v_cvt_pk_bf16_f32 v157, v130, v131
    v_cvt_pk_bf16_f32 v158, v132, v133
    v_cvt_pk_bf16_f32 v159, v134, v135
    s_waitcnt vmcnt(6)
    v_mfma_f32_32x32x16_bf16 v[192:207], v[104:107], v[160:163], 0
    v_mfma_f32_32x32x16_bf16 v[192:207], v[72:75], v[152:155], v[192:207]
    v_mfma_f32_32x32x16_bf16 v[192:207], v[76:79], v[156:159], v[192:207]
    s_waitcnt vmcnt(4)
    v_mfma_f32_32x32x16_bf16 v[208:223], v[108:111], v[160:163], 0
    v_mfma_f32_32x32x16_bf16 v[208:223], v[80:83], v[152:155], v[208:223]
    v_mfma_f32_32x32x16_bf16 v[208:223], v[84:87], v[156:159], v[208:223]
    s_nop 7
    v_cvt_pk_bf16_f32 v40, v192, v193
    v_cvt_pk_bf16_f32 v41, v194, v195
    v_cvt_pk_bf16_f32 v42, v196, v197
    v_cvt_pk_bf16_f32 v43, v198, v199
    v_cvt_pk_bf16_f32 v44, v200, v201
    v_cvt_pk_bf16_f32 v45, v202, v203
    v_cvt_pk_bf16_f32 v46, v204, v205
    v_cvt_pk_bf16_f32 v47, v206, v207
    buffer_store_dwordx4 v[40:43], v0, s[8:11], s65 offen offset:0 sc1
    buffer_store_dwordx4 v[44:47], v0, s[8:11], s65 offen offset:1024 sc1
    s_waitcnt vmcnt(4)
    v_mfma_f32_32x32x16_bf16 v[224:239], v[112:115], v[160:163], 0
    v_mfma_f32_32x32x16_bf16 v[224:239], v[88:91], v[152:155], v[224:239]
    v_mfma_f32_32x32x16_bf16 v[224:239], v[92:95], v[156:159], v[224:239]
    v_cvt_pk_bf16_f32 v48, v208, v209
    v_cvt_pk_bf16_f32 v49, v210, v211
    v_cvt_pk_bf16_f32 v50, v212, v213
    v_cvt_pk_bf16_f32 v51, v214, v215
    v_cvt_pk_bf16_f32 v52, v216, v217
    v_cvt_pk_bf16_f32 v53, v218, v219
    v_cvt_pk_bf16_f32 v54, v220, v221
    v_cvt_pk_bf16_f32 v55, v222, v223
    buffer_store_dwordx4 v[48:51], v0, s[8:11], s65 offen offset:2048 sc1
    buffer_store_dwordx4 v[52:55], v0, s[8:11], s65 offen offset:3072 sc1
    s_waitcnt vmcnt(4)
    v_mfma_f32_32x32x16_bf16 v[240:255], v[116:119], v[160:163], 0
    v_mfma_f32_32x32x16_bf16 v[240:255], v[96:99], v[152:155], v[240:255]
    v_mfma_f32_32x32x16_bf16 v[240:255], v[100:103], v[156:159], v[240:255]
    v_cvt_pk_bf16_f32 v56, v224, v225
    v_cvt_pk_bf16_f32 v57, v226, v227
    v_cvt_pk_bf16_f32 v58, v228, v229
    v_cvt_pk_bf16_f32 v59, v230, v231
    v_cvt_pk_bf16_f32 v60, v232, v233
    v_cvt_pk_bf16_f32 v61, v234, v235
    v_cvt_pk_bf16_f32 v62, v236, v237
    v_cvt_pk_bf16_f32 v63, v238, v239
    buffer_store_dwordx4 v[56:59], v0, s[8:11], s66 offen offset:0 sc1
    buffer_store_dwordx4 v[60:63], v0, s[8:11], s66 offen offset:1024 sc1
    s_nop 1
    v_cvt_pk_bf16_f32 v64, v240, v241
    v_cvt_pk_bf16_f32 v65, v242, v243
    v_cvt_pk_bf16_f32 v66, v244, v245
    v_cvt_pk_bf16_f32 v67, v246, v247
    v_cvt_pk_bf16_f32 v68, v248, v249
    v_cvt_pk_bf16_f32 v69, v250, v251
    v_cvt_pk_bf16_f32 v70, v252, v253
    v_cvt_pk_bf16_f32 v71, v254, v255
    buffer_store_dwordx4 v[64:67], v0, s[8:11], s66 offen offset:2048 sc1
    buffer_store_dwordx4 v[68:71], v0, s[8:11], s66 offen offset:3072 sc1
    s_lshl_b32 s64, s20, 3
    s_add_u32 s64, s64, s22
    s_lshl_b32 s64, s64, 7
    s_add_u32 s64, s64, 109068288
    v_mov_b32 v5, 1
    s_waitcnt vmcnt(0)
    s_barrier
    s_cmp_lg_u32 s4, 0
    s_cbranch_scc1 A_nf
    s_mov_b64 exec, 1
    buffer_store_dword v5, off, s[8:11], s64 sc1
    s_mov_b64 exec, -1
A_nf:
    s_add_u32 s20, s20, 6
    s_cmp_lt_u32 s20, 64
    s_cbranch_scc1 A_loop
M_fin:
    s_waitcnt vmcnt(0) lgkmcnt(0)
M_done:
    s_endpgm
M_rec:
    s_mov_b32 s5, s6
    s_lshr_b32 s3, s2, 3
    s_load_dwordx2 s[8:9], s[0:1], 104
    s_load_dwordx2 s[16:17], s[0:1], 96
    s_load_dwordx4 s[72:75], s[0:1], 16
    s_load_dwordx4 s[76:79], s[0:1], 32
    s_load_dwordx2 s[80:81], s[0:1], 8
    v_lshrrev_b32 v20, 6, v0
    v_and_b32 v21, 63, v0
    v_readfirstlane_b32 s4, v20
    s_mov_b32 s10, 0x10000000
    s_mov_b32 s11, 0x20000
    s_mov_b32 s18, 256
    s_mov_b32 s19, 0x20000
    s_mov_b32 s15, 0x20000
    v_and_b32 v22, 15, v21
    v_lshrrev_b32 v23, 4, v21
    v_and_b32 v24, 1, v22
    v_and_b32 v27, 1, v23
    v_lshrrev_b32 v28, 1, v23
    v_lshlrev_b32 v0, 4, v21
    v_lshl_add_u32 v25, v23, 1, v24
    v_lshrrev_b32 v26, 3, v22
    v_lshlrev_b32 v26, 2, v26
    v_xor_b32 v25, v25, v26
    v_lshrrev_b32 v26, 1, v22
    v_lshlrev_b32 v26, 7, v26
    v_lshl_add_u32 v1, v25, 4, v26
    s_mul_i32 s64, s4, 36864
    s_add_u32 s64, s64, 16384
    v_add_u32 v2, s64, v0
    s_add_u32 s64, s3, 32
    s_and_b32 s66, s3, 4
    s_cmp_eq_u32 s4, 0
    s_cselect_b32 s64, s3, s64
    s_cselect_b32 s66, s66, 0
    s_lshl_b32 s65, s64, 7
    s_mov_b32 s67, 5248
    v_lshrrev_b32 v25, 3, v21
    v_mul_lo_u32 v25, v25, s67
    v_and_b32 v26, 7, v21
    v_lshl_add_u32 v25, v26, 4, v25
    v_add_u32 v3, s65, v25
    s_cmp_ge_u32 s64, 40
    s_cselect_b32 s65, 0x20000000, s65
    v_xor_b32 v26, s66, v26
    v_lshlrev_b32 v26, 4, v26
    v_lshl_add_u32 v26, v27, 3, v26
    v_lshl_add_u32 v26, v28, 2, v26
    v_add_u32 v4, s65, v26
    s_and_b32 s66, s4, 1
    s_lshl_b32 s66, s66, 1
    v_add_u32 v25, s66, v28
    v_lshl_add_u32 v25, v25, 1, v24
    v_lshrrev_b32 v26, 3, v22
    v_lshlrev_b32 v26, 2, v26
    v_xor_b32 v25, v25, v26
    v_lshlrev_b32 v25, 4, v25
    v_lshl_add_u32 v25, v27, 3, v25
    v_lshrrev_b32 v26, 2, v22
    v_lshl_add_u32 v25, v26, 8, v25
    s_lshr_b32 s66, s4, 1
    s_lshl_b32 s66, s66, 10
    v_add_u32 v5, s66, v25
    v_lshrrev_b32 v25, 3, v22
    v_and_b32 v26, 7, v22
    v_lshl_add_u32 v25, v25, 4, v26
    v_lshlrev_b32 v25, 4, v25
    v_lshl_add_u32 v6, v23, 9, v25
    s_mov_b32 s42, 0x33333333
    s_mov_b32 s43, 0x33333333
    s_mov_b32 s54, 0xcccccccc
    s_mov_b32 s55, 0xcccccccc
    s_mov_b32 s44, 0x3030303
    s_mov_b32 s45, 0x3030303
    s_mov_b32 s46, 0xc0c0c0c
    s_mov_b32 s47, 0xc0c0c0c
    s_mov_b32 s48, 0x30303030
    s_mov_b32 s49, 0x30303030
    s_mov_b32 s50, 0xc0c0c0c0
    s_mov_b32 s51, 0xc0c0c0c0
    s_mov_b32 s52, 0x00f0000f
    s_mov_b32 s53, 0xf0000f00
    v_mov_b32 v25, 0x4444
    v_mov_b32 v26, 0xeeee
    v_cndmask_b32 v7, v25, v26, s[54:55]
    v_lshlrev_b32 v25, 4, v24
    v_mov_b32 v26, 0x3f80
    v_lshlrev_b32 v12, v25, v26
    v_mov_b32 v9, 0
    v_mov_b32 v10, 0
    v_mov_b32 v8, 0
    v_mov_b32 v11, 0
    s_lshl_b32 s56, s4, 10
    s_lshl_b32 s57, s4, 2
    s_lshl_b32 s59, s4, 9
    s_lshl_b32 s58, s4, 8
    s_add_u32 s58, s58, 4096
    s_lshl_b32 s71, s4, 5
    s_add_u32 s71, s71, 4096
    s_mov_b32 s98, 0x3f803f80
    s_mov_b32 s99, 0x3f803f80
    v_add_u32 v15, s56, v0
    s_mov_b32 s60, 0x3e0293ee
    s_mov_b32 s20, 0
    s_mov_b32 s21, 1
    s_mov_b32 s40, 2000000
    s_lshl_b32 s22, s3, 14
    s_lshl_b32 s64, s4, 11
    s_add_u32 s22, s22, s64
    s_add_u32 s23, s22, 8192
    s_mul_i32 s26, s5, 167936
    s_add_u32 s26, s26, 104857600
    s_mul_i32 s64, s3, 5248
    s_add_u32 s64, s64, s26
    s_add_u32 s24, s64, s56
    s_add_u32 s25, s64, s58
    s_add_u32 s27, s26, 41984
    s_add_u32 s28, s26, 83968
    s_add_u32 s29, s26, 125952
    s_lshl_b32 s64, s5, 16
    s_add_u32 s38, s64, 105906176
    s_add_u32 s39, s64, 106430464
    s_xor_b32 s6, s39, 0x10000
    s_mov_b32 s30, 0
    s_mov_b32 s31, 16384
    s_lshl_b32 s62, s5, 1
    s_and_b32 s64, s4, 1
    s_add_u32 s62, s62, s64
    s_lshl_b32 s62, s62, 10
    s_lshl_b32 s63, s3, 12
    s_add_u32 s63, s63, 88080384
    s_add_u32 s63, s63, s62
    s_mov_b32 s41, 0x20000000
    s_lshl_b32 s83, s5, 5
    s_add_u32 s83, s83, s3
    s_lshl_b32 s61, s83, 7
    s_add_u32 s61, s61, 109056000
    s_mul_i32 s34, s83, 5120
    s_add_u32 s34, s34, 106692608
    s_mov_b32 s97, s34
    s_add_u32 s35, s34, s58
    s_add_u32 s34, s34, s56
    s_waitcnt lgkmcnt(0)
    v_mov_b64 v[24:25], 0
    v_mov_b64 v[26:27], 0
    v_mov_b32 v29, -1
    buffer_store_dwordx4 v[24:27], v0, s[8:11], s24 offen sc1
    s_mov_b64 exec, 0xffff
    buffer_store_dwordx4 v[24:27], v0, s[8:11], s25 offen sc1
    s_mov_b64 exec, -1
    s_cmp_ge_u32 s4, 2
    s_cbranch_scc1 R_noinit
    buffer_store_dword v29, v4, s[8:11], s38 offen sc1
    buffer_store_dword v29, v4, s[8:11], s39 offen sc1
    s_add_u32 s64, s39, 8192
    buffer_store_dword v29, v4, s[8:11], s64 offen sc1
R_noinit:
    s_cmp_lg_u32 s4, 3
    s_cbranch_scc1 R_notw3
    v_mov_b32 v3, 0
R_notw3:
    s_waitcnt vmcnt(0)
    s_barrier
    s_getreg_b32 s82, hwreg(HW_REG_XCC_ID)
    s_and_b32 s82, s82, 0xf
    s_or_b32 s82, s82, 0x10
    v_mov_b32 v24, s82
    s_mov_b64 exec, 1
    buffer_store_byte v24, off, s[16:19], s83 offset:192 sc1
    s_mov_b64 exec, -1
    v_lshrrev_b32 v28, 2, v21
    v_and_b32 v29, 3, v21
    v_mul_u32_u24 v25, 1280, v28
    v_lshl_add_u32 v25, v29, 4, v25
    v_lshrrev_b32 v30, 1, v23
    v_lshlrev_b32 v30, 4, v30
    v_bfe_u32 v31, v21, 3, 1
    v_lshl_add_u32 v30, v31, 3, v30
    v_and_b32 v26, 1, v23
    v_lshl_add_u32 v30, v26, 2, v30
    v_bfe_u32 v27, v21, 2, 1
    v_add_u32 v30, v30, v27
    v_lshl_add_u32 v31, v31, 1, v26
    v_lshl_add_u32 v31, v31, 2, v27
    s_mul_i32 s84, s4, 36864
    s_add_u32 s84, s84, 16384
    v_lshlrev_b32 v27, 6, v30
    v_lshl_add_u32 v27, v29, 3, v27
    v_add_u32 v27, s84, v27
    v_lshrrev_b32 v26, 1, v29
    v_lshlrev_b32 v26, 1, v26
    v_add_u32 v26, s57, v26
    v_xor_b32 v26, v26, v31
    v_lshlrev_b32 v26, 4, v26
    v_lshl_add_u32 v26, v30, 8, v26
    v_and_b32 v28, 1, v29
    v_lshl_add_u32 v26, v28, 3, v26
    v_add_u32 v16, 36864, v26
    v_xor_b32 v17, 16, v16
    v_add_u32 v18, 73728, v16
    v_xor_b32 v19, 16, v18
    v_and_b32 v28, 1, v23
    v_xor_b32 v28, v28, v22
    v_lshlrev_b32 v28, 4, v28
    v_lshl_add_u32 v28, v23, 13, v28
    v_xor_b32 v29, 64, v28
    v_xor_b32 v30, 0x80, v28
    v_xor_b32 v31, 0xc0, v28
    s_lshl_b32 s85, s3, 8
    s_lshl_b32 s86, s4, 17
    s_add_u32 s85, s85, s86
    s_mul_i32 s64, s5, 2621440
    s_sub_u32 s86, s85, s64
    s_add_u32 s85, s85, s64
    s_mul_i32 s87, s3, 163840
    s_mul_i32 s64, s5, 640
    s_add_u32 s87, s87, s64
    s_lshl_b32 s88, s4, 7
    s_add_u32 s88, s88, s87
    s_lshl_b32 s64, s4, 5
    s_add_u32 s87, s87, s64
    s_add_u32 s87, s87, 512
    s_lshl_b32 s65, s4, 12
    s_add_u32 s65, s65, 36864
    s_mov_b32 s12, s80
    s_mov_b32 s13, s81
    s_mov_b32 s14, 10240
    v_lshrrev_b32 v48, 2, v22
    v_and_b32 v49, 1, v22
    v_lshl_add_u32 v48, v48, 1, v49
    v_mul_u32_u24 v48, 1280, v48
    v_lshl_add_u32 v48, v23, 5, v48
    v_bfe_u32 v49, v22, 1, 1
    v_lshl_add_u32 v48, v49, 4, v48
    v_add_u32 v49, s56, v1
    s_mul_i32 s68, s5, 640
    s_sub_u32 s69, 640, s68
    s_lshl_b32 s89, s4, 7
    s_add_u32 s100, s68, s89
    s_add_u32 s101, s69, s89
    v_and_b32 v50, 7, v21
    v_mul_u32_u24 v50, 1280, v50
    v_lshrrev_b32 v51, 3, v21
    v_lshl_add_u32 v50, v51, 4, v50
    s_mov_b32 s12, s80
    s_mov_b32 s13, s81
    s_mov_b32 s14, 10240
    buffer_load_dwordx4 v[32:35], v48, s[12:15], s100 offen
    buffer_load_dwordx4 v[36:39], v48, s[12:15], s68 offen offset:512
    buffer_load_dwordx4 v[40:43], v48, s[12:15], s101 offen
    buffer_load_dwordx4 v[44:47], v50, s[12:15], s69 offen offset:512
    s_mov_b32 s12, s78
    s_mov_b32 s13, s79
    s_mov_b32 s14, 5242880
    s_add_u32 s89, s87, 0
    s_add_u32 m0, s84, 0
    s_nop 0
    buffer_load_dwordx4 v25, s[12:15], s89 offen lds
    s_add_u32 s89, s87, 20480
    s_add_u32 m0, s84, 1024
    s_nop 0
    buffer_load_dwordx4 v25, s[12:15], s89 offen lds
    s_add_u32 s89, s87, 40960
    s_add_u32 m0, s84, 2048
    s_nop 0
    buffer_load_dwordx4 v25, s[12:15], s89 offen lds
    s_add_u32 s89, s87, 61440
    s_add_u32 m0, s84, 3072
    s_nop 0
    buffer_load_dwordx4 v25, s[12:15], s89 offen lds
    s_mov_b32 s12, s78
    s_mov_b32 s13, s79
    s_mov_b32 s14, 5242880
    s_add_u32 s89, s88, 0
    s_add_u32 m0, s84, 4096
    s_nop 0
    buffer_load_dwordx4 v25, s[12:15], s89 offen lds
    s_add_u32 s89, s88, 20480
    s_add_u32 m0, s84, 5120
    s_nop 0
    buffer_load_dwordx4 v25, s[12:15], s89 offen lds
    s_add_u32 s89, s88, 40960
    s_add_u32 m0, s84, 6144
    s_nop 0
    buffer_load_dwordx4 v25, s[12:15], s89 offen lds
    s_add_u32 s89, s88, 61440
    s_add_u32 m0, s84, 7168
    s_nop 0
    buffer_load_dwordx4 v25, s[12:15], s89 offen lds
    s_mov_b32 s12, s78
    s_mov_b32 s13, s79
    s_mov_b32 s14, 5242880
    s_add_u32 s89, s88, 64
    s_add_u32 m0, s84, 8192
    s_nop 0
    buffer_load_dwordx4 v25, s[12:15], s89 offen lds
    s_add_u32 s89, s88, 20544
    s_add_u32 m0, s84, 9216
    s_nop 0
    buffer_load_dwordx4 v25, s[12:15], s89 offen lds
    s_add_u32 s89, s88, 41024
    s_add_u32 m0, s84, 10240
    s_nop 0
    buffer_load_dwordx4 v25, s[12:15], s89 offen lds
    s_add_u32 s89, s88, 61504
    s_add_u32 m0, s84, 11264
    s_nop 0
    buffer_load_dwordx4 v25, s[12:15], s89 offen lds
    s_mov_b32 s12, s78
    s_mov_b32 s13, s79
    s_mov_b32 s14, 5242880
    s_add_u32 s89, s87, 81920
    s_add_u32 m0, s84, 12288
    s_nop 0
    buffer_load_dwordx4 v25, s[12:15], s89 offen lds
    s_add_u32 s89, s87, 102400
    s_add_u32 m0, s84, 13312
    s_nop 0
    buffer_load_dwordx4 v25, s[12:15], s89 offen lds
    s_add_u32 s89, s87, 122880
    s_add_u32 m0, s84, 14336
    s_nop 0
    buffer_load_dwordx4 v25, s[12:15], s89 offen lds
    s_add_u32 s89, s87, 143360
    s_add_u32 m0, s84, 15360
    s_nop 0
    buffer_load_dwordx4 v25, s[12:15], s89 offen lds
    s_mov_b32 s12, s72
    s_mov_b32 s13, s73
    s_mov_b32 s14, 5242880
    s_add_u32 s89, s85, 524288
    s_add_u32 m0, s65, 0
    s_nop 0
    buffer_load_dwordx4 v28, s[12:15], s89 offen lds
    s_add_u32 s89, s85, 557056
    s_add_u32 m0, s65, 1024
    s_nop 0
    buffer_load_dwordx4 v29, s[12:15], s89 offen lds
    s_add_u32 s89, s85, 589824
    s_add_u32 m0, s65, 2048
    s_nop 0
    buffer_load_dwordx4 v30, s[12:15], s89 offen lds
    s_add_u32 s89, s85, 622592
    s_add_u32 m0, s65, 3072
    s_nop 0
    buffer_load_dwordx4 v31, s[12:15], s89 offen lds
    s_mov_b32 s12, s72
    s_mov_b32 s13, s73
    s_mov_b32 s14, 5242880
    s_add_u32 s89, s85, 1048576
    s_add_u32 m0, s65, 36864
    s_nop 0
    buffer_load_dwordx4 v28, s[12:15], s89 offen lds
    s_add_u32 s89, s85, 1081344
    s_add_u32 m0, s65, 37888
    s_nop 0
    buffer_load_dwordx4 v29, s[12:15], s89 offen lds
    s_add_u32 s89, s85, 1114112
    s_add_u32 m0, s65, 38912
    s_nop 0
    buffer_load_dwordx4 v30, s[12:15], s89 offen lds
    s_add_u32 s89, s85, 1146880
    s_add_u32 m0, s65, 39936
    s_nop 0
    buffer_load_dwordx4 v31, s[12:15], s89 offen lds
    s_mov_b32 s12, s72
    s_mov_b32 s13, s73
    s_mov_b32 s14, 5242880
    s_add_u32 s89, s85, 1572864
    s_add_u32 m0, s65, 73728
    s_nop 0
    buffer_load_dwordx4 v28, s[12:15], s89 offen lds
    s_add_u32 s89, s85, 1605632
    s_add_u32 m0, s65, 74752
    s_nop 0
    buffer_load_dwordx4 v29, s[12:15], s89 offen lds
    s_add_u32 s89, s85, 1638400
    s_add_u32 m0, s65, 75776
    s_nop 0
    buffer_load_dwordx4 v30, s[12:15], s89 offen lds
    s_add_u32 s89, s85, 1671168
    s_add_u32 m0, s65, 76800
    s_nop 0
    buffer_load_dwordx4 v31, s[12:15], s89 offen lds
    s_waitcnt vmcnt(24)
    ds_read_b64_tr_b16 v[160:161], v27 offset:0
    ds_read_b64_tr_b16 v[162:163], v27 offset:128
    ds_read_b64_tr_b16 v[164:165], v27 offset:2048
    ds_read_b64_tr_b16 v[166:167], v27 offset:2176
    s_waitcnt lgkmcnt(0)
    s_mov_b32 s12, s78
    s_mov_b32 s13, s79
    s_mov_b32 s14, 5242880
    s_add_u32 s89, s88, 81920
    s_add_u32 m0, s84, 0
    s_nop 0
    buffer_load_dwordx4 v25, s[12:15], s89 offen lds
    s_add_u32 s89, s88, 102400
    s_add_u32 m0, s84, 1024
    s_nop 0
    buffer_load_dwordx4 v25, s[12:15], s89 offen lds
    s_add_u32 s89, s88, 122880
    s_add_u32 m0, s84, 2048
    s_nop 0
    buffer_load_dwordx4 v25, s[12:15], s89 offen lds
    s_add_u32 s89, s88, 143360
    s_add_u32 m0, s84, 3072
    s_nop 0
    buffer_load_dwordx4 v25, s[12:15], s89 offen lds
    s_waitcnt vmcnt(24)
    ds_read_b64_tr_b16 v[176:177], v27 offset:4096
    ds_read_b64_tr_b16 v[178:179], v27 offset:4224
    ds_read_b64_tr_b16 v[180:181], v27 offset:6144
    ds_read_b64_tr_b16 v[182:183], v27 offset:6272
    ds_read_b64_tr_b16 v[192:193], v27 offset:4128
    ds_read_b64_tr_b16 v[194:195], v27 offset:4256
    ds_read_b64_tr_b16 v[196:197], v27 offset:6176
    ds_read_b64_tr_b16 v[198:199], v27 offset:6304
    s_waitcnt lgkmcnt(0)
    s_mov_b32 s12, s78
    s_mov_b32 s13, s79
    s_mov_b32 s14, 5242880
    s_add_u32 s89, s88, 81984
    s_add_u32 m0, s84, 4096
    s_nop 0
    buffer_load_dwordx4 v25, s[12:15], s89 offen lds
    s_add_u32 s89, s88, 102464
    s_add_u32 m0, s84, 5120
    s_nop 0
    buffer_load_dwordx4 v25, s[12:15], s89 offen lds
    s_add_u32 s89, s88, 122944
    s_add_u32 m0, s84, 6144
    s_nop 0
    buffer_load_dwordx4 v25, s[12:15], s89 offen lds
    s_add_u32 s89, s88, 143424
    s_add_u32 m0, s84, 7168
    s_nop 0
    buffer_load_dwordx4 v25, s[12:15], s89 offen lds
    s_waitcnt vmcnt(24)
    ds_read_b64_tr_b16 v[208:209], v27 offset:8192
    ds_read_b64_tr_b16 v[210:211], v27 offset:8320
    ds_read_b64_tr_b16 v[212:213], v27 offset:10240
    ds_read_b64_tr_b16 v[214:215], v27 offset:10368
    ds_read_b64_tr_b16 v[224:225], v27 offset:8224
    ds_read_b64_tr_b16 v[226:227], v27 offset:8352
    ds_read_b64_tr_b16 v[228:229], v27 offset:10272
    ds_read_b64_tr_b16 v[230:231], v27 offset:10400
    s_waitcnt lgkmcnt(0)
    s_waitcnt vmcnt(20)
    ds_read_b64_tr_b16 v[168:169], v27 offset:12288
    ds_read_b64_tr_b16 v[170:171], v27 offset:12416
    ds_read_b64_tr_b16 v[172:173], v27 offset:14336
    ds_read_b64_tr_b16 v[174:175], v27 offset:14464
    s_waitcnt lgkmcnt(0)
    s_waitcnt vmcnt(4)
    ds_read_b64_tr_b16 v[184:185], v27 offset:0
    ds_read_b64_tr_b16 v[186:187], v27 offset:128
    ds_read_b64_tr_b16 v[188:189], v27 offset:2048
    ds_read_b64_tr_b16 v[190:191], v27 offset:2176
    ds_read_b64_tr_b16 v[200:201], v27 offset:32
    ds_read_b64_tr_b16 v[202:203], v27 offset:160
    ds_read_b64_tr_b16 v[204:205], v27 offset:2080
    ds_read_b64_tr_b16 v[206:207], v27 offset:2208
    s_waitcnt lgkmcnt(0)
    s_waitcnt vmcnt(0)
    ds_read_b64_tr_b16 v[216:217], v27 offset:4096
    ds_read_b64_tr_b16 v[218:219], v27 offset:4224
    ds_read_b64_tr_b16 v[220:221], v27 offset:6144
    ds_read_b64_tr_b16 v[222:223], v27 offset:6272
    ds_read_b64_tr_b16 v[232:233], v27 offset:4128
    ds_read_b64_tr_b16 v[234:235], v27 offset:4256
    ds_read_b64_tr_b16 v[236:237], v27 offset:6176
    ds_read_b64_tr_b16 v[238:239], v27 offset:6304
    s_waitcnt lgkmcnt(0)
    ds_write_b128 v49, v[32:35]
    ds_write_b128 v1, v[36:39] offset:4096
    v_min_u32 v40, -2, v40
    v_min_u32 v41, -2, v41
    v_min_u32 v42, -2, v42
    v_min_u32 v43, -2, v43
    v_min_u32 v44, -2, v44
    v_min_u32 v45, -2, v45
    v_min_u32 v46, -2, v46
    v_min_u32 v47, -2, v47
    s_add_u32 s89, s97, 4096
    buffer_store_dwordx4 v[40:43], v49, s[8:11], s97 offen
    buffer_store_dwordx4 v[44:47], v0, s[8:11], s89 offen
    s_barrier
    s_mov_b32 s12, s72
    s_mov_b32 s13, s73
    s_mov_b32 s14, 5242880
    s_add_u32 s89, s85, 2097152
    s_add_u32 m0, s65, 110592
    s_nop 0
    buffer_load_dwordx4 v28, s[12:15], s89 offen lds
    s_add_u32 s89, s85, 2129920
    s_add_u32 m0, s65, 111616
    s_nop 0
    buffer_load_dwordx4 v29, s[12:15], s89 offen lds
    s_add_u32 s89, s85, 2162688
    s_add_u32 m0, s65, 112640
    s_nop 0
    buffer_load_dwordx4 v30, s[12:15], s89 offen lds
    s_add_u32 s89, s85, 2195456
    s_add_u32 m0, s65, 113664
    s_nop 0
    buffer_load_dwordx4 v31, s[12:15], s89 offen lds
    ds_read_b64_tr_b16 a[24:25], v16 offset:0
    ds_read_b64_tr_b16 a[26:27], v16 offset:512
    ds_read_b64_tr_b16 a[28:29], v16 offset:8192
    ds_read_b64_tr_b16 a[30:31], v16 offset:8704
    ds_read_b64_tr_b16 a[32:33], v17 offset:0
    ds_read_b64_tr_b16 a[34:35], v17 offset:512
    ds_read_b64_tr_b16 a[36:37], v17 offset:8192
    ds_read_b64_tr_b16 a[38:39], v17 offset:8704
    s_waitcnt lgkmcnt(0)
    s_barrier
    s_mov_b32 s12, s72
    s_mov_b32 s13, s73
    s_mov_b32 s14, 5242880
    s_add_u32 s89, s86, 2621440
    s_add_u32 m0, s65, 0
    s_nop 0
    buffer_load_dwordx4 v28, s[12:15], s89 offen lds
    s_add_u32 s89, s86, 2654208
    s_add_u32 m0, s65, 1024
    s_nop 0
    buffer_load_dwordx4 v29, s[12:15], s89 offen lds
    s_add_u32 s89, s86, 2686976
    s_add_u32 m0, s65, 2048
    s_nop 0
    buffer_load_dwordx4 v30, s[12:15], s89 offen lds
    s_add_u32 s89, s86, 2719744
    s_add_u32 m0, s65, 3072
    s_nop 0
    buffer_load_dwordx4 v31, s[12:15], s89 offen lds
    ds_read_b64_tr_b16 a[64:65], v16 offset:36864
    ds_read_b64_tr_b16 a[66:67], v16 offset:37376
    ds_read_b64_tr_b16 a[68:69], v16 offset:45056
    ds_read_b64_tr_b16 a[70:71], v16 offset:45568
    ds_read_b64_tr_b16 a[72:73], v17 offset:36864
    ds_read_b64_tr_b16 a[74:75], v17 offset:37376
    ds_read_b64_tr_b16 a[76:77], v17 offset:45056
    ds_read_b64_tr_b16 a[78:79], v17 offset:45568
    s_waitcnt lgkmcnt(0)
    s_barrier
    s_mov_b32 s12, s72
    s_mov_b32 s13, s73
    s_mov_b32 s14, 5242880
    s_add_u32 s89, s86, 3145728
    s_add_u32 m0, s65, 36864
    s_nop 0
    buffer_load_dwordx4 v28, s[12:15], s89 offen lds
    s_add_u32 s89, s86, 3178496
    s_add_u32 m0, s65, 37888
    s_nop 0
    buffer_load_dwordx4 v29, s[12:15], s89 offen lds
    s_add_u32 s89, s86, 3211264
    s_add_u32 m0, s65, 38912
    s_nop 0
    buffer_load_dwordx4 v30, s[12:15], s89 offen lds
    s_add_u32 s89, s86, 3244032
    s_add_u32 m0, s65, 39936
    s_nop 0
    buffer_load_dwordx4 v31, s[12:15], s89 offen lds
    ds_read_b64_tr_b16 a[104:105], v18 offset:0
    ds_read_b64_tr_b16 a[106:107], v18 offset:512
    ds_read_b64_tr_b16 a[108:109], v18 offset:8192
    ds_read_b64_tr_b16 a[110:111], v18 offset:8704
    ds_read_b64_tr_b16 a[112:113], v19 offset:0
    ds_read_b64_tr_b16 a[114:115], v19 offset:512
    ds_read_b64_tr_b16 a[116:117], v19 offset:8192
    ds_read_b64_tr_b16 a[118:119], v19 offset:8704
    s_waitcnt lgkmcnt(0)
    s_waitcnt vmcnt(8)
    s_barrier
    s_mov_b32 s12, s72
    s_mov_b32 s13, s73
    s_mov_b32 s14, 5242880
    s_add_u32 s89, s86, 3670016
    s_add_u32 m0, s65, 73728
    s_nop 0
    buffer_load_dwordx4 v28, s[12:15], s89 offen lds
    s_add_u32 s89, s86, 3702784
    s_add_u32 m0, s65, 74752
    s_nop 0
    buffer_load_dwordx4 v29, s[12:15], s89 offen lds
    s_add_u32 s89, s86, 3735552
    s_add_u32 m0, s65, 75776
    s_nop 0
    buffer_load_dwordx4 v30, s[12:15], s89 offen lds
    s_add_u32 s89, s86, 3768320
    s_add_u32 m0, s65, 76800
    s_nop 0
    buffer_load_dwordx4 v31, s[12:15], s89 offen lds
    ds_read_b64_tr_b16 a[144:145], v18 offset:36864
    ds_read_b64_tr_b16 a[146:147], v18 offset:37376
    ds_read_b64_tr_b16 a[148:149], v18 offset:45056
    ds_read_b64_tr_b16 a[150:151], v18 offset:45568
    ds_read_b64_tr_b16 v[248:249], v19 offset:36864
    ds_read_b64_tr_b16 v[250:251], v19 offset:37376
    ds_read_b64_tr_b16 v[252:253], v19 offset:45056
    ds_read_b64_tr_b16 v[254:255], v19 offset:45568
    s_waitcnt lgkmcnt(0)
    ds_write_b128 v2, v[248:251] offset:8192
    ds_write_b128 v2, v[252:255] offset:9216
    s_waitcnt vmcnt(8)
    s_barrier
    s_mov_b32 s12, s72
    s_mov_b32 s13, s73
    s_mov_b32 s14, 5242880
    s_add_u32 s89, s86, 4194304
    s_add_u32 m0, s65, 110592
    s_nop 0
    buffer_load_dwordx4 v28, s[12:15], s89 offen lds
    s_add_u32 s89, s86, 4227072
    s_add_u32 m0, s65, 111616
    s_nop 0
    buffer_load_dwordx4 v29, s[12:15], s89 offen lds
    s_add_u32 s89, s86, 4259840
    s_add_u32 m0, s65, 112640
    s_nop 0
    buffer_load_dwordx4 v30, s[12:15], s89 offen lds
    s_add_u32 s89, s86, 4292608
    s_add_u32 m0, s65, 113664
    s_nop 0
    buffer_load_dwordx4 v31, s[12:15], s89 offen lds
    ds_read_b64_tr_b16 v[240:241], v16 offset:0
    ds_read_b64_tr_b16 v[242:243], v16 offset:512
    ds_read_b64_tr_b16 v[244:245], v16 offset:8192
    ds_read_b64_tr_b16 v[246:247], v16 offset:8704
    ds_read_b64_tr_b16 a[176:177], v17 offset:0
    ds_read_b64_tr_b16 a[178:179], v17 offset:512
    ds_read_b64_tr_b16 a[180:181], v17 offset:8192
    ds_read_b64_tr_b16 a[182:183], v17 offset:8704
    s_waitcnt lgkmcnt(0)
    ds_write_b128 v2, v[240:243] offset:12288
    ds_write_b128 v2, v[244:247] offset:13312
    s_waitcnt vmcnt(8)
    s_barrier
    s_mov_b32 s12, s72
    s_mov_b32 s13, s73
    s_mov_b32 s14, 5242880
    s_add_u32 s89, s86, 4718592
    s_add_u32 m0, s65, 0
    s_nop 0
    buffer_load_dwordx4 v28, s[12:15], s89 offen lds
    s_add_u32 s89, s86, 4751360
    s_add_u32 m0, s65, 1024
    s_nop 0
    buffer_load_dwordx4 v29, s[12:15], s89 offen lds
    s_add_u32 s89, s86, 4784128
    s_add_u32 m0, s65, 2048
    s_nop 0
    buffer_load_dwordx4 v30, s[12:15], s89 offen lds
    s_add_u32 s89, s86, 4816896
    s_add_u32 m0, s65, 3072
    s_nop 0
    buffer_load_dwordx4 v31, s[12:15], s89 offen lds
    ds_read_b64_tr_b16 a[192:193], v16 offset:36864
    ds_read_b64_tr_b16 a[194:195], v16 offset:37376
    ds_read_b64_tr_b16 a[196:197], v16 offset:45056
    ds_read_b64_tr_b16 a[198:199], v16 offset:45568
    ds_read_b64_tr_b16 v[248:249], v17 offset:36864
    ds_read_b64_tr_b16 v[250:251], v17 offset:37376
    ds_read_b64_tr_b16 v[252:253], v17 offset:45056
    ds_read_b64_tr_b16 v[254:255], v17 offset:45568
    s_waitcnt lgkmcnt(0)
    ds_write_b128 v2, v[248:251] offset:16384
    ds_write_b128 v2, v[252:255] offset:17408
    s_waitcnt vmcnt(8)
    s_barrier
    s_mov_b32 s12, s74
    s_mov_b32 s13, s75
    s_mov_b32 s14, 5242880
    s_add_u32 s89, s85, 0
    s_add_u32 m0, s65, 36864
    s_nop 0
    buffer_load_dwordx4 v28, s[12:15], s89 offen lds
    s_add_u32 s89, s85, 32768
    s_add_u32 m0, s65, 37888
    s_nop 0
    buffer_load_dwordx4 v29, s[12:15], s89 offen lds
    s_add_u32 s89, s85, 65536
    s_add_u32 m0, s65, 38912
    s_nop 0
    buffer_load_dwordx4 v30, s[12:15], s89 offen lds
    s_add_u32 s89, s85, 98304
    s_add_u32 m0, s65, 39936
    s_nop 0
    buffer_load_dwordx4 v31, s[12:15], s89 offen lds
    ds_read_b64_tr_b16 v[240:241], v18 offset:0
    ds_read_b64_tr_b16 v[242:243], v18 offset:512
    ds_read_b64_tr_b16 v[244:245], v18 offset:8192
    ds_read_b64_tr_b16 v[246:247], v18 offset:8704
    ds_read_b64_tr_b16 a[216:217], v19 offset:0
    ds_read_b64_tr_b16 a[218:219], v19 offset:512
    ds_read_b64_tr_b16 a[220:221], v19 offset:8192
    ds_read_b64_tr_b16 a[222:223], v19 offset:8704
    s_waitcnt lgkmcnt(0)
    ds_write_b128 v2, v[240:243] offset:18432
    ds_write_b128 v2, v[244:247] offset:19456
    s_waitcnt vmcnt(8)
    s_barrier
    s_mov_b32 s12, s74
    s_mov_b32 s13, s75
    s_mov_b32 s14, 5242880
    s_add_u32 s89, s85, 524288
    s_add_u32 m0, s65, 73728
    s_nop 0
    buffer_load_dwordx4 v28, s[12:15], s89 offen lds
    s_add_u32 s89, s85, 557056
    s_add_u32 m0, s65, 74752
    s_nop 0
    buffer_load_dwordx4 v29, s[12:15], s89 offen lds
    s_add_u32 s89, s85, 589824
    s_add_u32 m0, s65, 75776
    s_nop 0
    buffer_load_dwordx4 v30, s[12:15], s89 offen lds
    s_add_u32 s89, s85, 622592
    s_add_u32 m0, s65, 76800
    s_nop 0
    buffer_load_dwordx4 v31, s[12:15], s89 offen lds
    ds_read_b64_tr_b16 a[224:225], v18 offset:36864
    ds_read_b64_tr_b16 a[226:227], v18 offset:37376
    ds_read_b64_tr_b16 a[228:229], v18 offset:45056
    ds_read_b64_tr_b16 a[230:231], v18 offset:45568
    ds_read_b64_tr_b16 v[32:33], v19 offset:36864
    ds_read_b64_tr_b16 v[34:35], v19 offset:37376
    ds_read_b64_tr_b16 v[36:37], v19 offset:45056
    ds_read_b64_tr_b16 v[38:39], v19 offset:45568
    s_waitcnt lgkmcnt(0)
    s_waitcnt vmcnt(8)
    s_barrier
    s_mov_b32 s12, s74
    s_mov_b32 s13, s75
    s_mov_b32 s14, 5242880
    s_add_u32 s89, s85, 1048576
    s_add_u32 m0, s65, 110592
    s_nop 0
    buffer_load_dwordx4 v28, s[12:15], s89 offen lds
    s_add_u32 s89, s85, 1081344
    s_add_u32 m0, s65, 111616
    s_nop 0
    buffer_load_dwordx4 v29, s[12:15], s89 offen lds
    s_add_u32 s89, s85, 1114112
    s_add_u32 m0, s65, 112640
    s_nop 0
    buffer_load_dwordx4 v30, s[12:15], s89 offen lds
    s_add_u32 s89, s85, 1146880
    s_add_u32 m0, s65, 113664
    s_nop 0
    buffer_load_dwordx4 v31, s[12:15], s89 offen lds
    ds_read_b64_tr_b16 a[232:233], v16 offset:0
    ds_read_b64_tr_b16 a[234:235], v16 offset:512
    ds_read_b64_tr_b16 a[236:237], v16 offset:8192
    ds_read_b64_tr_b16 a[238:239], v16 offset:8704
    ds_read_b64_tr_b16 v[40:41], v17 offset:0
    ds_read_b64_tr_b16 v[42:43], v17 offset:512
    ds_read_b64_tr_b16 v[44:45], v17 offset:8192
    ds_read_b64_tr_b16 v[46:47], v17 offset:8704
    s_waitcnt lgkmcnt(0)
    s_waitcnt vmcnt(8)
    s_barrier
    s_mov_b32 s12, s74
    s_mov_b32 s13, s75
    s_mov_b32 s14, 5242880
    s_add_u32 s89, s85, 1572864
    s_add_u32 m0, s65, 0
    s_nop 0
    buffer_load_dwordx4 v28, s[12:15], s89 offen lds
    s_add_u32 s89, s85, 1605632
    s_add_u32 m0, s65, 1024
    s_nop 0
    buffer_load_dwordx4 v29, s[12:15], s89 offen lds
    s_add_u32 s89, s85, 1638400
    s_add_u32 m0, s65, 2048
    s_nop 0
    buffer_load_dwordx4 v30, s[12:15], s89 offen lds
    s_add_u32 s89, s85, 1671168
    s_add_u32 m0, s65, 3072
    s_nop 0
    buffer_load_dwordx4 v31, s[12:15], s89 offen lds
    ds_read_b64_tr_b16 a[0:1], v16 offset:36864
    ds_read_b64_tr_b16 a[2:3], v16 offset:37376
    ds_read_b64_tr_b16 a[4:5], v16 offset:45056
    ds_read_b64_tr_b16 a[6:7], v16 offset:45568
    ds_read_b64_tr_b16 v[248:249], v17 offset:36864
    ds_read_b64_tr_b16 v[250:251], v17 offset:37376
    ds_read_b64_tr_b16 v[252:253], v17 offset:45056
    ds_read_b64_tr_b16 v[254:255], v17 offset:45568
    s_waitcnt lgkmcnt(0)
    ds_write_b128 v2, v[248:251] offset:0
    ds_write_b128 v2, v[252:255] offset:1024
    s_waitcnt vmcnt(8)
    s_barrier
    s_mov_b32 s12, s74
    s_mov_b32 s13, s75
    s_mov_b32 s14, 5242880
    s_add_u32 s89, s85, 2097152
    s_add_u32 m0, s65, 36864
    s_nop 0
    buffer_load_dwordx4 v28, s[12:15], s89 offen lds
    s_add_u32 s89, s85, 2129920
    s_add_u32 m0, s65, 37888
    s_nop 0
    buffer_load_dwordx4 v29, s[12:15], s89 offen lds
    s_add_u32 s89, s85, 2162688
    s_add_u32 m0, s65, 38912
    s_nop 0
    buffer_load_dwordx4 v30, s[12:15], s89 offen lds
    s_add_u32 s89, s85, 2195456
    s_add_u32 m0, s65, 39936
    s_nop 0
    buffer_load_dwordx4 v31, s[12:15], s89 offen lds
    ds_read_b64_tr_b16 a[40:41], v18 offset:0
    ds_read_b64_tr_b16 a[42:43], v18 offset:512
    ds_read_b64_tr_b16 a[44:45], v18 offset:8192
    ds_read_b64_tr_b16 a[46:47], v18 offset:8704
    ds_read_b64_tr_b16 v[248:249], v19 offset:0
    ds_read_b64_tr_b16 v[250:251], v19 offset:512
    ds_read_b64_tr_b16 v[252:253], v19 offset:8192
    ds_read_b64_tr_b16 v[254:255], v19 offset:8704
    s_waitcnt lgkmcnt(0)
    ds_write_b128 v2, v[248:251] offset:2048
    ds_write_b128 v2, v[252:255] offset:3072
    s_waitcnt vmcnt(8)
    s_barrier
    s_mov_b32 s12, s74
    s_mov_b32 s13, s75
    s_mov_b32 s14, 5242880
    s_add_u32 s89, s86, 2621440
    s_add_u32 m0, s65, 73728
    s_nop 0
    buffer_load_dwordx4 v28, s[12:15], s89 offen lds
    s_add_u32 s89, s86, 2654208
    s_add_u32 m0, s65, 74752
    s_nop 0
    buffer_load_dwordx4 v29, s[12:15], s89 offen lds
    s_add_u32 s89, s86, 2686976
    s_add_u32 m0, s65, 75776
    s_nop 0
    buffer_load_dwordx4 v30, s[12:15], s89 offen lds
    s_add_u32 s89, s86, 2719744
    s_add_u32 m0, s65, 76800
    s_nop 0
    buffer_load_dwordx4 v31, s[12:15], s89 offen lds
    ds_read_b64_tr_b16 a[80:81], v18 offset:36864
    ds_read_b64_tr_b16 a[82:83], v18 offset:37376
    ds_read_b64_tr_b16 a[84:85], v18 offset:45056
    ds_read_b64_tr_b16 a[86:87], v18 offset:45568
    ds_read_b64_tr_b16 v[248:249], v19 offset:36864
    ds_read_b64_tr_b16 v[250:251], v19 offset:37376
    ds_read_b64_tr_b16 v[252:253], v19 offset:45056
    ds_read_b64_tr_b16 v[254:255], v19 offset:45568
    s_waitcnt lgkmcnt(0)
    ds_write_b128 v2, v[248:251] offset:4096
    ds_write_b128 v2, v[252:255] offset:5120
    s_waitcnt vmcnt(8)
    s_barrier
    s_mov_b32 s12, s74
    s_mov_b32 s13, s75
    s_mov_b32 s14, 5242880
    s_add_u32 s89, s86, 3145728
    s_add_u32 m0, s65, 110592
    s_nop 0
    buffer_load_dwordx4 v28, s[12:15], s89 offen lds
    s_add_u32 s89, s86, 3178496
    s_add_u32 m0, s65, 111616
    s_nop 0
    buffer_load_dwordx4 v29, s[12:15], s89 offen lds
    s_add_u32 s89, s86, 3211264
    s_add_u32 m0, s65, 112640
    s_nop 0
    buffer_load_dwordx4 v30, s[12:15], s89 offen lds
    s_add_u32 s89, s86, 3244032
    s_add_u32 m0, s65, 113664
    s_nop 0
    buffer_load_dwordx4 v31, s[12:15], s89 offen lds
    ds_read_b64_tr_b16 a[120:121], v16 offset:0
    ds_read_b64_tr_b16 a[122:123], v16 offset:512
    ds_read_b64_tr_b16 a[124:125], v16 offset:8192
    ds_read_b64_tr_b16 a[126:127], v16 offset:8704
    ds_read_b64_tr_b16 v[248:249], v17 offset:0
    ds_read_b64_tr_b16 v[250:251], v17 offset:512
    ds_read_b64_tr_b16 v[252:253], v17 offset:8192
    ds_read_b64_tr_b16 v[254:255], v17 offset:8704
    s_waitcnt lgkmcnt(0)
    ds_write_b128 v2, v[248:251] offset:6144
    ds_write_b128 v2, v[252:255] offset:7168
    s_waitcnt vmcnt(8)
    s_barrier
    s_mov_b32 s12, s74
    s_mov_b32 s13, s75
    s_mov_b32 s14, 5242880
    s_add_u32 s89, s86, 3670016
    s_add_u32 m0, s65, 0
    s_nop 0
    buffer_load_dwordx4 v28, s[12:15], s89 offen lds
    s_add_u32 s89, s86, 3702784
    s_add_u32 m0, s65, 1024
    s_nop 0
    buffer_load_dwordx4 v29, s[12:15], s89 offen lds
    s_add_u32 s89, s86, 3735552
    s_add_u32 m0, s65, 2048
    s_nop 0
    buffer_load_dwordx4 v30, s[12:15], s89 offen lds
    s_add_u32 s89, s86, 3768320
    s_add_u32 m0, s65, 3072
    s_nop 0
    buffer_load_dwordx4 v31, s[12:15], s89 offen lds
    ds_read_b64_tr_b16 a[152:153], v16 offset:36864
    ds_read_b64_tr_b16 a[154:155], v16 offset:37376
    ds_read_b64_tr_b16 a[156:157], v16 offset:45056
    ds_read_b64_tr_b16 a[158:159], v16 offset:45568
    ds_read_b64_tr_b16 a[160:161], v17 offset:36864
    ds_read_b64_tr_b16 a[162:163], v17 offset:37376
    ds_read_b64_tr_b16 a[164:165], v17 offset:45056
    ds_read_b64_tr_b16 a[166:167], v17 offset:45568
    s_waitcnt lgkmcnt(0)
    s_waitcnt vmcnt(8)
    s_barrier
    s_mov_b32 s12, s74
    s_mov_b32 s13, s75
    s_mov_b32 s14, 5242880
    s_add_u32 s89, s86, 4194304
    s_add_u32 m0, s65, 36864
    s_nop 0
    buffer_load_dwordx4 v28, s[12:15], s89 offen lds
    s_add_u32 s89, s86, 4227072
    s_add_u32 m0, s65, 37888
    s_nop 0
    buffer_load_dwordx4 v29, s[12:15], s89 offen lds
    s_add_u32 s89, s86, 4259840
    s_add_u32 m0, s65, 38912
    s_nop 0
    buffer_load_dwordx4 v30, s[12:15], s89 offen lds
    s_add_u32 s89, s86, 4292608
    s_add_u32 m0, s65, 39936
    s_nop 0
    buffer_load_dwordx4 v31, s[12:15], s89 offen lds
    ds_read_b64_tr_b16 a[184:185], v18 offset:0
    ds_read_b64_tr_b16 a[186:187], v18 offset:512
    ds_read_b64_tr_b16 a[188:189], v18 offset:8192
    ds_read_b64_tr_b16 a[190:191], v18 offset:8704
    ds_read_b64_tr_b16 v[248:249], v19 offset:0
    ds_read_b64_tr_b16 v[250:251], v19 offset:512
    ds_read_b64_tr_b16 v[252:253], v19 offset:8192
    ds_read_b64_tr_b16 v[254:255], v19 offset:8704
    s_waitcnt lgkmcnt(0)
    ds_write_b128 v2, v[248:251] offset:14336
    ds_write_b128 v2, v[252:255] offset:15360
    s_waitcnt vmcnt(8)
    s_barrier
    s_mov_b32 s12, s74
    s_mov_b32 s13, s75
    s_mov_b32 s14, 5242880
    s_add_u32 s89, s86, 4718592
    s_add_u32 m0, s65, 73728
    s_nop 0
    buffer_load_dwordx4 v28, s[12:15], s89 offen lds
    s_add_u32 s89, s86, 4751360
    s_add_u32 m0, s65, 74752
    s_nop 0
    buffer_load_dwordx4 v29, s[12:15], s89 offen lds
    s_add_u32 s89, s86, 4784128
    s_add_u32 m0, s65, 75776
    s_nop 0
    buffer_load_dwordx4 v30, s[12:15], s89 offen lds
    s_add_u32 s89, s86, 4816896
    s_add_u32 m0, s65, 76800
    s_nop 0
    buffer_load_dwordx4 v31, s[12:15], s89 offen lds
    ds_read_b64_tr_b16 a[200:201], v18 offset:36864
    ds_read_b64_tr_b16 a[202:203], v18 offset:37376
    ds_read_b64_tr_b16 a[204:205], v18 offset:45056
    ds_read_b64_tr_b16 a[206:207], v18 offset:45568
    ds_read_b64_tr_b16 a[208:209], v19 offset:36864
    ds_read_b64_tr_b16 a[210:211], v19 offset:37376
    ds_read_b64_tr_b16 a[212:213], v19 offset:45056
    ds_read_b64_tr_b16 a[214:215], v19 offset:45568
    s_waitcnt lgkmcnt(0)
    buffer_load_ubyte v25, v21, s[16:19], 0 offen offset:192 sc1
    buffer_load_dword v24, off, s[16:19], 0 offset:0 sc1
    s_lshr_b32 s96, s3, 1
    s_lshl_b32 s96, s96, 7
    s_add_u32 s96, s96, 109064192
    s_add_u32 s7, s96, 4
    v_and_b32 v26, 1, v21
    v_lshlrev_b32 v27, 11, v26
    v_lshlrev_b32 v26, 6, v26
    buffer_load_dword v26, v26, s[16:19], 0 offen offset:64 sc1
    s_waitcnt vmcnt(11)
    s_barrier
    s_mov_b32 s12, s76
    s_mov_b32 s13, s77
    s_mov_b32 s14, 5242880
    s_add_u32 s89, s85, 0
    s_add_u32 m0, s65, 110592
    s_nop 0
    buffer_load_dwordx4 v28, s[12:15], s89 offen lds
    s_add_u32 s89, s85, 32768
    s_add_u32 m0, s65, 111616
    s_nop 0
    buffer_load_dwordx4 v29, s[12:15], s89 offen lds
    s_add_u32 s89, s85, 65536
    s_add_u32 m0, s65, 112640
    s_nop 0
    buffer_load_dwordx4 v30, s[12:15], s89 offen lds
    s_add_u32 s89, s85, 98304
    s_add_u32 m0, s65, 113664
    s_nop 0
    buffer_load_dwordx4 v31, s[12:15], s89 offen lds
    ds_read_b64_tr_b16 a[240:241], v16 offset:0
    ds_read_b64_tr_b16 a[242:243], v16 offset:512
    ds_read_b64_tr_b16 a[244:245], v16 offset:8192
    ds_read_b64_tr_b16 a[246:247], v16 offset:8704
    ds_read_b64_tr_b16 a[248:249], v17 offset:0
    ds_read_b64_tr_b16 a[250:251], v17 offset:512
    ds_read_b64_tr_b16 a[252:253], v17 offset:8192
    ds_read_b64_tr_b16 a[254:255], v17 offset:8704
    s_waitcnt lgkmcnt(0)
    s_waitcnt vmcnt(11)
    s_barrier
    s_mov_b32 s12, s76
    s_mov_b32 s13, s77
    s_mov_b32 s14, 5242880
    s_add_u32 s89, s85, 524288
    s_add_u32 m0, s65, 0
    s_nop 0
    buffer_load_dwordx4 v28, s[12:15], s89 offen lds
    s_add_u32 s89, s85, 557056
    s_add_u32 m0, s65, 1024
    s_nop 0
    buffer_load_dwordx4 v29, s[12:15], s89 offen lds
    s_add_u32 s89, s85, 589824
    s_add_u32 m0, s65, 2048
    s_nop 0
    buffer_load_dwordx4 v30, s[12:15], s89 offen lds
    s_add_u32 s89, s85, 622592
    s_add_u32 m0, s65, 3072
    s_nop 0
    buffer_load_dwordx4 v31, s[12:15], s89 offen lds
    ds_read_b64_tr_b16 v[48:49], v16 offset:36864
    ds_read_b64_tr_b16 v[50:51], v16 offset:37376
    ds_read_b64_tr_b16 v[52:53], v16 offset:45056
    ds_read_b64_tr_b16 v[54:55], v16 offset:45568
    ds_read_b64_tr_b16 v[96:97], v17 offset:36864
    ds_read_b64_tr_b16 v[98:99], v17 offset:37376
    ds_read_b64_tr_b16 v[100:101], v17 offset:45056
    ds_read_b64_tr_b16 v[102:103], v17 offset:45568
    s_waitcnt lgkmcnt(0)
    s_waitcnt vmcnt(11)
    s_barrier
    s_mov_b32 s12, s76
    s_mov_b32 s13, s77
    s_mov_b32 s14, 5242880
    s_add_u32 s89, s85, 1048576
    s_add_u32 m0, s65, 36864
    s_nop 0
    buffer_load_dwordx4 v28, s[12:15], s89 offen lds
    s_add_u32 s89, s85, 1081344
    s_add_u32 m0, s65, 37888
    s_nop 0
    buffer_load_dwordx4 v29, s[12:15], s89 offen lds
    s_add_u32 s89, s85, 1114112
    s_add_u32 m0, s65, 38912
    s_nop 0
    buffer_load_dwordx4 v30, s[12:15], s89 offen lds
    s_add_u32 s89, s85, 1146880
    s_add_u32 m0, s65, 39936
    s_nop 0
    buffer_load_dwordx4 v31, s[12:15], s89 offen lds
    ds_read_b64_tr_b16 v[104:105], v18 offset:0
    ds_read_b64_tr_b16 v[106:107], v18 offset:512
    ds_read_b64_tr_b16 v[108:109], v18 offset:8192
    ds_read_b64_tr_b16 v[110:111], v18 offset:8704
    ds_read_b64_tr_b16 v[112:113], v19 offset:0
    ds_read_b64_tr_b16 v[114:115], v19 offset:512
    ds_read_b64_tr_b16 v[116:117], v19 offset:8192
    ds_read_b64_tr_b16 v[118:119], v19 offset:8704
    s_waitcnt lgkmcnt(0)
    s_waitcnt vmcnt(8)
    s_barrier
    s_mov_b32 s12, s76
    s_mov_b32 s13, s77
    s_mov_b32 s14, 5242880
    s_add_u32 s89, s85, 1572864
    s_add_u32 m0, s65, 73728
    s_nop 0
    buffer_load_dwordx4 v28, s[12:15], s89 offen lds
    s_add_u32 s89, s85, 1605632
    s_add_u32 m0, s65, 74752
    s_nop 0
    buffer_load_dwordx4 v29, s[12:15], s89 offen lds
    s_add_u32 s89, s85, 1638400
    s_add_u32 m0, s65, 75776
    s_nop 0
    buffer_load_dwordx4 v30, s[12:15], s89 offen lds
    s_add_u32 s89, s85, 1671168
    s_add_u32 m0, s65, 76800
    s_nop 0
    buffer_load_dwordx4 v31, s[12:15], s89 offen lds
    ds_read_b64_tr_b16 a[8:9], v18 offset:36864
    ds_read_b64_tr_b16 a[10:11], v18 offset:37376
    ds_read_b64_tr_b16 a[12:13], v18 offset:45056
    ds_read_b64_tr_b16 a[14:15], v18 offset:45568
    ds_read_b64_tr_b16 a[16:17], v19 offset:36864
    ds_read_b64_tr_b16 a[18:19], v19 offset:37376
    ds_read_b64_tr_b16 a[20:21], v19 offset:45056
    ds_read_b64_tr_b16 a[22:23], v19 offset:45568
    s_waitcnt lgkmcnt(0)
    s_waitcnt vmcnt(8)
    s_barrier
    s_mov_b32 s12, s76
    s_mov_b32 s13, s77
    s_mov_b32 s14, 5242880
    s_add_u32 s89, s85, 2097152
    s_add_u32 m0, s65, 110592
    s_nop 0
    buffer_load_dwordx4 v28, s[12:15], s89 offen lds
    s_add_u32 s89, s85, 2129920
    s_add_u32 m0, s65, 111616
    s_nop 0
    buffer_load_dwordx4 v29, s[12:15], s89 offen lds
    s_add_u32 s89, s85, 2162688
    s_add_u32 m0, s65, 112640
    s_nop 0
    buffer_load_dwordx4 v30, s[12:15], s89 offen lds
    s_add_u32 s89, s85, 2195456
    s_add_u32 m0, s65, 113664
    s_nop 0
    buffer_load_dwordx4 v31, s[12:15], s89 offen lds
    ds_read_b64_tr_b16 a[48:49], v16 offset:0
    ds_read_b64_tr_b16 a[50:51], v16 offset:512
    ds_read_b64_tr_b16 a[52:53], v16 offset:8192
    ds_read_b64_tr_b16 a[54:55], v16 offset:8704
    ds_read_b64_tr_b16 a[56:57], v17 offset:0
    ds_read_b64_tr_b16 a[58:59], v17 offset:512
    ds_read_b64_tr_b16 a[60:61], v17 offset:8192
    ds_read_b64_tr_b16 a[62:63], v17 offset:8704
    s_waitcnt lgkmcnt(0)
    s_waitcnt vmcnt(8)
    s_barrier
    s_mov_b32 s12, s76
    s_mov_b32 s13, s77
    s_mov_b32 s14, 5242880
    s_add_u32 s89, s86, 2621440
    s_add_u32 m0, s65, 0
    s_nop 0
    buffer_load_dwordx4 v28, s[12:15], s89 offen lds
    s_add_u32 s89, s86, 2654208
    s_add_u32 m0, s65, 1024
    s_nop 0
    buffer_load_dwordx4 v29, s[12:15], s89 offen lds
    s_add_u32 s89, s86, 2686976
    s_add_u32 m0, s65, 2048
    s_nop 0
    buffer_load_dwordx4 v30, s[12:15], s89 offen lds
    s_add_u32 s89, s86, 2719744
    s_add_u32 m0, s65, 3072
    s_nop 0
    buffer_load_dwordx4 v31, s[12:15], s89 offen lds
    ds_read_b64_tr_b16 a[88:89], v16 offset:36864
    ds_read_b64_tr_b16 a[90:91], v16 offset:37376
    ds_read_b64_tr_b16 a[92:93], v16 offset:45056
    ds_read_b64_tr_b16 a[94:95], v16 offset:45568
    ds_read_b64_tr_b16 a[96:97], v17 offset:36864
    ds_read_b64_tr_b16 a[98:99], v17 offset:37376
    ds_read_b64_tr_b16 a[100:101], v17 offset:45056
    ds_read_b64_tr_b16 a[102:103], v17 offset:45568
    s_waitcnt lgkmcnt(0)
    s_waitcnt vmcnt(8)
    s_barrier
    s_mov_b32 s12, s76
    s_mov_b32 s13, s77
    s_mov_b32 s14, 5242880
    s_add_u32 s89, s86, 3145728
    s_add_u32 m0, s65, 36864
    s_nop 0
    buffer_load_dwordx4 v28, s[12:15], s89 offen lds
    s_add_u32 s89, s86, 3178496
    s_add_u32 m0, s65, 37888
    s_nop 0
    buffer_load_dwordx4 v29, s[12:15], s89 offen lds
    s_add_u32 s89, s86, 3211264
    s_add_u32 m0, s65, 38912
    s_nop 0
    buffer_load_dwordx4 v30, s[12:15], s89 offen lds
    s_add_u32 s89, s86, 3244032
    s_add_u32 m0, s65, 39936
    s_nop 0
    buffer_load_dwordx4 v31, s[12:15], s89 offen lds
    ds_read_b64_tr_b16 a[128:129], v18 offset:0
    ds_read_b64_tr_b16 a[130:131], v18 offset:512
    ds_read_b64_tr_b16 a[132:133], v18 offset:8192
    ds_read_b64_tr_b16 a[134:135], v18 offset:8704
    ds_read_b64_tr_b16 a[136:137], v19 offset:0
    ds_read_b64_tr_b16 a[138:139], v19 offset:512
    ds_read_b64_tr_b16 a[140:141], v19 offset:8192
    ds_read_b64_tr_b16 a[142:143], v19 offset:8704
    s_waitcnt lgkmcnt(0)
    s_waitcnt vmcnt(8)
    s_barrier
    s_mov_b32 s12, s76
    s_mov_b32 s13, s77
    s_mov_b32 s14, 5242880
    s_add_u32 s89, s86, 3670016
    s_add_u32 m0, s65, 73728
    s_nop 0
    buffer_load_dwordx4 v28, s[12:15], s89 offen lds
    s_add_u32 s89, s86, 3702784
    s_add_u32 m0, s65, 74752
    s_nop 0
    buffer_load_dwordx4 v29, s[12:15], s89 offen lds
    s_add_u32 s89, s86, 3735552
    s_add_u32 m0, s65, 75776
    s_nop 0
    buffer_load_dwordx4 v30, s[12:15], s89 offen lds
    s_add_u32 s89, s86, 3768320
    s_add_u32 m0, s65, 76800
    s_nop 0
    buffer_load_dwordx4 v31, s[12:15], s89 offen lds
    ds_read_b64_tr_b16 v[240:241], v18 offset:36864
    ds_read_b64_tr_b16 v[242:243], v18 offset:37376
    ds_read_b64_tr_b16 v[244:245], v18 offset:45056
    ds_read_b64_tr_b16 v[246:247], v18 offset:45568
    ds_read_b64_tr_b16 a[168:169], v19 offset:36864
    ds_read_b64_tr_b16 a[170:171], v19 offset:37376
    ds_read_b64_tr_b16 a[172:173], v19 offset:45056
    ds_read_b64_tr_b16 a[174:175], v19 offset:45568
    s_waitcnt lgkmcnt(0)
    ds_write_b128 v2, v[240:243] offset:10240
    ds_write_b128 v2, v[244:247] offset:11264
    buffer_load_dword v27, v27, s[8:11], s96 offen sc1
    s_waitcnt vmcnt(9)
    s_barrier
    s_mov_b32 s12, s76
    s_mov_b32 s13, s77
    s_mov_b32 s14, 5242880
    s_add_u32 s89, s86, 4194304
    s_add_u32 m0, s65, 110592
    s_nop 0
    buffer_load_dwordx4 v28, s[12:15], s89 offen lds
    s_add_u32 s89, s86, 4227072
    s_add_u32 m0, s65, 111616
    s_nop 0
    buffer_load_dwordx4 v29, s[12:15], s89 offen lds
    s_add_u32 s89, s86, 4259840
    s_add_u32 m0, s65, 112640
    s_nop 0
    buffer_load_dwordx4 v30, s[12:15], s89 offen lds
    s_add_u32 s89, s86, 4292608
    s_add_u32 m0, s65, 113664
    s_nop 0
    buffer_load_dwordx4 v31, s[12:15], s89 offen lds
    ds_read_b64_tr_b16 v[56:57], v16 offset:0
    ds_read_b64_tr_b16 v[58:59], v16 offset:512
    ds_read_b64_tr_b16 v[60:61], v16 offset:8192
    ds_read_b64_tr_b16 v[62:63], v16 offset:8704
    ds_read_b64_tr_b16 v[144:145], v17 offset:0
    ds_read_b64_tr_b16 v[146:147], v17 offset:512
    ds_read_b64_tr_b16 v[148:149], v17 offset:8192
    ds_read_b64_tr_b16 v[150:151], v17 offset:8704
    s_waitcnt lgkmcnt(0)
    s_waitcnt vmcnt(9)
    s_barrier
    s_mov_b32 s12, s76
    s_mov_b32 s13, s77
    s_mov_b32 s14, 5242880
    s_add_u32 s89, s86, 4718592
    s_add_u32 m0, s65, 0
    s_nop 0
    buffer_load_dwordx4 v28, s[12:15], s89 offen lds
    s_add_u32 s89, s86, 4751360
    s_add_u32 m0, s65, 1024
    s_nop 0
    buffer_load_dwordx4 v29, s[12:15], s89 offen lds
    s_add_u32 s89, s86, 4784128
    s_add_u32 m0, s65, 2048
    s_nop 0
    buffer_load_dwordx4 v30, s[12:15], s89 offen lds
    s_add_u32 s89, s86, 4816896
    s_add_u32 m0, s65, 3072
    s_nop 0
    buffer_load_dwordx4 v31, s[12:15], s89 offen lds
    ds_read_b64_tr_b16 v[64:65], v16 offset:36864
    ds_read_b64_tr_b16 v[66:67], v16 offset:37376
    ds_read_b64_tr_b16 v[68:69], v16 offset:45056
    ds_read_b64_tr_b16 v[70:71], v16 offset:45568
    ds_read_b64_tr_b16 v[152:153], v17 offset:36864
    ds_read_b64_tr_b16 v[154:155], v17 offset:37376
    ds_read_b64_tr_b16 v[156:157], v17 offset:45056
    ds_read_b64_tr_b16 v[158:159], v17 offset:45568
    s_waitcnt lgkmcnt(0)
    s_waitcnt vmcnt(9)
    s_barrier
    s_mov_b32 s12, s72
    s_mov_b32 s13, s73
    s_mov_b32 s14, 5242880
    s_add_u32 s89, s85, 0
    s_add_u32 m0, s65, 36864
    s_nop 0
    buffer_load_dwordx4 v28, s[12:15], s89 offen lds
    s_add_u32 s89, s85, 32768
    s_add_u32 m0, s65, 37888
    s_nop 0
    buffer_load_dwordx4 v29, s[12:15], s89 offen lds
    s_add_u32 s89, s85, 65536
    s_add_u32 m0, s65, 38912
    s_nop 0
    buffer_load_dwordx4 v30, s[12:15], s89 offen lds
    s_add_u32 s89, s85, 98304
    s_add_u32 m0, s65, 39936
    s_nop 0
    buffer_load_dwordx4 v31, s[12:15], s89 offen lds
    ds_read_b64_tr_b16 v[72:73], v18 offset:0
    ds_read_b64_tr_b16 v[74:75], v18 offset:512
    ds_read_b64_tr_b16 v[76:77], v18 offset:8192
    ds_read_b64_tr_b16 v[78:79], v18 offset:8704
    ds_read_b64_tr_b16 v[120:121], v19 offset:0
    ds_read_b64_tr_b16 v[122:123], v19 offset:512
    ds_read_b64_tr_b16 v[124:125], v19 offset:8192
    ds_read_b64_tr_b16 v[126:127], v19 offset:8704
    s_waitcnt lgkmcnt(0)
    s_waitcnt vmcnt(8)
    s_barrier
    ds_read_b64_tr_b16 v[80:81], v18 offset:36864
    ds_read_b64_tr_b16 v[82:83], v18 offset:37376
    ds_read_b64_tr_b16 v[84:85], v18 offset:45056
    ds_read_b64_tr_b16 v[86:87], v18 offset:45568
    ds_read_b64_tr_b16 v[128:129], v19 offset:36864
    ds_read_b64_tr_b16 v[130:131], v19 offset:37376
    ds_read_b64_tr_b16 v[132:133], v19 offset:45056
    ds_read_b64_tr_b16 v[134:135], v19 offset:45568
    s_waitcnt lgkmcnt(0)
    s_waitcnt vmcnt(4)
    s_barrier
    ds_read_b64_tr_b16 v[88:89], v16 offset:0
    ds_read_b64_tr_b16 v[90:91], v16 offset:512
    ds_read_b64_tr_b16 v[92:93], v16 offset:8192
    ds_read_b64_tr_b16 v[94:95], v16 offset:8704
    ds_read_b64_tr_b16 v[136:137], v17 offset:0
    ds_read_b64_tr_b16 v[138:139], v17 offset:512
    ds_read_b64_tr_b16 v[140:141], v17 offset:8192
    ds_read_b64_tr_b16 v[142:143], v17 offset:8704
    s_waitcnt lgkmcnt(0)
    s_waitcnt vmcnt(0)
    s_barrier
    ds_read_b64_tr_b16 v[240:241], v16 offset:36864
    ds_read_b64_tr_b16 v[242:243], v16 offset:37376
    ds_read_b64_tr_b16 v[244:245], v16 offset:45056
    ds_read_b64_tr_b16 v[246:247], v16 offset:45568
    ds_read_b64_tr_b16 v[248:249], v17 offset:36864
    ds_read_b64_tr_b16 v[250:251], v17 offset:37376
    ds_read_b64_tr_b16 v[252:253], v17 offset:45056
    ds_read_b64_tr_b16 v[254:255], v17 offset:45568
    s_waitcnt lgkmcnt(0)
    s_barrier
    ds_write_b128 v2, v[32:35] offset:20480
    ds_write_b128 v2, v[36:39] offset:21504
    ds_write_b128 v2, v[40:43] offset:22528
    ds_write_b128 v2, v[44:47] offset:23552
    ds_write_b128 v2, v[48:51] offset:24576
    ds_write_b128 v2, v[52:55] offset:25600
    ds_write_b128 v2, v[56:59] offset:32768
    ds_write_b128 v2, v[60:63] offset:33792
    ds_write_b128 v2, v[64:67] offset:34816
    ds_write_b128 v2, v[68:71] offset:35840
    ds_write_b128 v2, v[72:75] offset:26624
    ds_write_b128 v2, v[76:79] offset:27648
    ds_write_b128 v2, v[80:83] offset:28672
    ds_write_b128 v2, v[84:87] offset:29696
    ds_write_b128 v2, v[88:91] offset:30720
    ds_write_b128 v2, v[92:95] offset:31744
    s_waitcnt lgkmcnt(0)
    v_cmp_eq_u32 vcc, 0, v25
    s_cbranch_vccz R_hs_ok
R_hs:
    buffer_load_ubyte v25, v21, s[16:19], 0 offen offset:192 sc1
    s_sub_u32 s40, s40, 1
    s_cbranch_scc1 R_exit
    s_waitcnt vmcnt(0)
    v_cmp_eq_u32 vcc, 0, v25
    s_cbranch_vccnz R_hs
R_hs_ok:
    v_cmp_ne_u32 vcc, s82, v25
    s_cmp_eq_u32 s5, 0
    s_cselect_b32 s83, vcc_lo, vcc_hi
    v_and_b32 v30, 1, v21
    v_lshlrev_b32 v28, 11, v30
    v_lshlrev_b32 v30, 6, v30
    v_cmp_gt_u32 vcc, 0x60, v26
    s_cbranch_vccz R_cnt_ok
    v_mov_b32 v27, 0
    v_cmp_gt_u32 vcc, 0x60, v26
    s_cbranch_vccz R_cnt_ok
R_cnt:
    buffer_load_dword v26, v30, s[16:19], 0 offen offset:64 sc1
    s_sub_u32 s40, s40, 1
    s_cbranch_scc1 R_exit
    s_waitcnt vmcnt(0)
    v_cmp_gt_u32 vcc, 0x60, v26
    s_cbranch_vccnz R_cnt
R_cnt_ok:
    v_cmp_eq_u32 vcc, 0, v27
    s_cbranch_vccz R_kv0_ok
R_kv0:
    buffer_load_dword v27, v28, s[8:11], s96 offen sc1
    s_sub_u32 s40, s40, 1
    s_cbranch_scc1 R_exit
    s_waitcnt vmcnt(0)
    v_cmp_eq_u32 vcc, 0, v27
    s_cbranch_vccnz R_kv0
R_kv0_ok:
    buffer_load_dwordx4 v[72:75], v6, s[8:11], s22 offen sc1
    buffer_load_dwordx4 v[76:79], v6, s[8:11], s22 offen offset:128 sc1
    s_add_u32 s22, s22, 524288
    v_cmp_gt_u32 vcc, 1572864, v24
    s_cbranch_vccz R_nr_ok
R_nr:
    buffer_load_dword v24, off, s[16:19], 0 offset:0 sc1
    s_sub_u32 s40, s40, 1
    s_cbranch_scc1 R_exit
    s_waitcnt vmcnt(0)
    v_cmp_gt_u32 vcc, 1572864, v24
    s_cbranch_vccnz R_nr
R_nr_ok:
    v_readlane_b32 s64, v25, 0
    v_readlane_b32 s65, v25, 32
    v_readfirstlane_b32 s66, v24
    s_nop 0
    s_and_b32 s66, s66, 0xffff
    s_cmp_gt_u32 s66, 192
    s_cselect_b32 s66, 1, 0
    s_lshr_b32 s64, s64, 2
    s_xor_b32 s64, s64, s66
    s_and_b32 s64, s64, 1
    s_lshl_b32 s64, s64, 13
    s_lshr_b32 s65, s65, 2
    s_xor_b32 s65, s65, s66
    s_and_b32 s65, s65, 1
    s_lshl_b32 s65, s65, 13
    s_cmp_eq_u32 s5, 0
    s_cselect_b32 s66, s64, s65
    s_cselect_b32 s65, s65, s64
    s_add_u32 s39, s39, s66
    s_add_u32 s6, s6, s65
    buffer_load_dword v52, v0, s[8:11], s24 offen sc1
    buffer_load_dword v53, v0, s[8:11], s25 offen sc1
    s_add_u32 s64, s38, 0
    buffer_load_dword v54, v4, s[8:11], s64 offen sc1
    s_add_u32 s64, s38, 16384
    buffer_load_dword v55, v4, s[8:11], s64 offen sc1
    s_add_u32 s64, s38, 32768
    buffer_load_dword v56, v4, s[8:11], s64 offen sc1
    buffer_load_dword v57, v0, s[8:11], s63 offen sc1
    buffer_load_dword v58, off, s[8:11], s61 sc1
    v_mov_b64 v[28:29], 0
    v_mov_b64 v[30:31], 0
    v_mov_b64 v[32:33], 0
    v_mov_b64 v[34:35], 0
    v_mov_b64 v[36:37], 0
    v_mov_b64 v[38:39], 0
    v_mov_b64 v[40:41], 0
    v_mov_b64 v[42:43], 0
    v_mov_b64 v[44:45], 0
    v_mov_b64 v[46:47], 0
    v_mov_b64 v[48:49], 0
    v_mov_b64 v[50:51], 0
    s_mov_b32 s88, 0x00ff00ff
    s_mov_b32 s89, 0x00ff00ff
    v_lshrrev_b32 v68, 2, v0
    v_bfe_u32 v14, v68, 5, 2
    v_lshlrev_b32 v13, 8, v14
    v_and_b32 v69, 0x9c, v68
    v_add_u32 v13, v13, v69
    v_and_b32 v69, 64, v68
    v_xor_b32 v69, s71, v69
    v_add_u32 v13, v13, v69
    buffer_load_dwordx4 v[88:91], v0, s[8:11], s34 offen sc1
    buffer_load_dword v92, v68, s[8:11], s35 offen sc1
    s_cmp_eq_u32 s4, 0
    s_cbranch_scc1 R_w0
    s_cmp_eq_u32 s4, 1
    s_cbranch_scc1 R_w1
    s_cmp_eq_u32 s4, 2
    s_cbranch_scc1 R_w2
    ds_read_b128 v[16:19], v1 offset:3072
    ds_read_b128 v[60:63], v2 offset:6144
    ds_read_b128 v[64:67], v2 offset:7168
    ds_read_b128 v[80:83], v2 offset:0
    ds_read_b128 v[84:87], v2 offset:1024
    s_waitcnt lgkmcnt(0)
    s_cmp_eq_u32 s83, 0
    s_cbranch_scc1 R_top_30
    s_branch R_top_31
R_w2:
    ds_read_b128 v[16:19], v1 offset:2048
    ds_read_b128 v[60:63], v2 offset:4096
    ds_read_b128 v[64:67], v2 offset:5120
    ds_read_b128 v[80:83], v2 offset:6144
    ds_read_b128 v[84:87], v2 offset:7168
    s_waitcnt lgkmcnt(0)
    s_cmp_eq_u32 s83, 0
    s_cbranch_scc1 R_top_20
    s_branch R_top_21
R_w1:
    ds_read_b128 v[16:19], v1 offset:1024
    ds_read_b128 v[60:63], v2 offset:2048
    ds_read_b128 v[64:67], v2 offset:3072
    ds_read_b128 v[80:83], v2 offset:4096
    ds_read_b128 v[84:87], v2 offset:5120
    s_waitcnt lgkmcnt(0)
    s_cmp_eq_u32 s83, 0
    s_cbranch_scc1 R_top_10
    s_branch R_top_11
R_w0:
    ds_read_b128 v[16:19], v1 offset:0
    ds_read_b128 v[60:63], v2 offset:0
    ds_read_b128 v[64:67], v2 offset:1024
    ds_read_b128 v[80:83], v2 offset:2048
    ds_read_b128 v[84:87], v2 offset:3072
    s_waitcnt lgkmcnt(0)
    s_cmp_eq_u32 s83, 0
    s_cbranch_scc1 R_top_00
    s_branch R_top_01
.p2align 6
R_comm_00:
    v_mov_b64 v[28:29], 0
    v_mov_b64 v[30:31], 0
    v_cndmask_b32 v16, v9, v12, s[44:45]
    v_cndmask_b32 v17, v9, v12, s[46:47]
    v_cndmask_b32 v18, v9, v12, s[48:49]
    v_cndmask_b32 v19, v9, v12, s[50:51]
    s_add_u32 s20, s20, 1
    s_add_u32 s22, s22, 0x80000
    s_add_u32 s23, s23, 0x80000
    s_add_u32 s36, s30, s38
    s_add_u32 s37, s30, s39
    s_add_u32 s32, s36, s56
    s_add_u32 s33, s36, s58
    s_add_u32 s34, s30, s6
    s_add_u32 s35, s34, s58
    s_add_u32 s34, s34, s56
    s_mov_b32 s41, s63
    s_add_u32 s63, s63, 0x20000
    s_add_u32 s30, s30, 16384
    s_cmp_eq_u32 s30, 49152
    s_cselect_b32 s30, 0, s30
    s_add_u32 s31, s31, 16384
    s_cmp_eq_u32 s31, 49152
    s_cselect_b32 s31, 0, s31
    ds_read_b128 v[60:63], v2 offset:0
    ds_read_b128 v[64:67], v2 offset:1024
    v_lshrrev_b32 v68, 2, v0
    v_bfe_u32 v14, v68, 5, 2
    v_lshlrev_b32 v13, 8, v14
    v_and_b32 v69, 0x9c, v68
    v_add_u32 v13, v13, v69
    v_and_b32 v69, 64, v68
    v_xor_b32 v69, s71, v69
    v_add_u32 v13, v13, v69
    buffer_load_dwordx4 v[80:83], v3, s[8:11], s26 offen sc1
    buffer_load_dwordx4 v[84:87], v3, s[8:11], s27 offen sc1
    buffer_load_dwordx4 v[88:91], v3, s[8:11], s28 offen sc1
    buffer_load_dwordx4 v[92:95], v3, s[8:11], s29 offen sc1
    s_sleep 3
    buffer_load_dwordx4 v[44:47], v3, s[8:11], s26 offen sc1
    buffer_load_dwordx4 v[48:51], v3, s[8:11], s27 offen sc1
    buffer_load_dwordx4 v[52:55], v3, s[8:11], s28 offen sc1
    buffer_load_dwordx4 v[56:59], v3, s[8:11], s29 offen sc1
    s_cmp_eq_u32 s21, 0
    s_cbranch_scc1 R_rs0_00
R_rs1_00:
    s_waitcnt vmcnt(7)
    v_mfma_f32_16x16x32_bf16 v[20:23], v[80:83], v[16:19], 0
    s_waitcnt vmcnt(6)
    v_mfma_f32_16x16x32_bf16 v[20:23], v[84:87], v[16:19], v[20:23]
    v_bitop3_b32 v14, v80, v82, v84 bitop3:0x80
    s_waitcnt vmcnt(5)
    v_mfma_f32_16x16x32_bf16 v[20:23], v[88:91], v[16:19], v[20:23]
    v_bitop3_b32 v14, v14, v86, v88 bitop3:0x80
    s_waitcnt vmcnt(4)
    v_mfma_f32_16x16x32_bf16 v[20:23], v[92:95], v[16:19], v[20:23]
    v_bitop3_b32 v14, v14, v90, v92 bitop3:0x80
    v_bitop3_b32 v14, v14, v14, v94 bitop3:0x80
    v_and_b32 v14, 1, v14
    v_cmp_ne_u32 vcc, 1, v14
    s_nop 3
    v_permlane32_swap_b32 v20, v22
    v_permlane32_swap_b32 v21, v23
    v_add_f32 v20, v20, v22
    v_add_f32 v21, v21, v23
    v_cvt_pk_bf16_f32 v20, v20, v21
    v_min_u32 v20, -2, v20
    s_cbranch_vccnz R_rf10_00
    buffer_store_dword v20, v4, s[8:11], s36 offen
    buffer_store_dword v20, v4, s[8:11], s37 offen sc1
    s_branch R_rsok_00
R_rf10_00:
    buffer_load_dwordx4 v[80:83], v3, s[8:11], s26 offen sc1
    buffer_load_dwordx4 v[84:87], v3, s[8:11], s27 offen sc1
    buffer_load_dwordx4 v[88:91], v3, s[8:11], s28 offen sc1
    buffer_load_dwordx4 v[92:95], v3, s[8:11], s29 offen sc1
    s_waitcnt vmcnt(7)
    v_mfma_f32_16x16x32_bf16 v[20:23], v[44:47], v[16:19], 0
    s_waitcnt vmcnt(6)
    v_mfma_f32_16x16x32_bf16 v[20:23], v[48:51], v[16:19], v[20:23]
    v_bitop3_b32 v14, v44, v46, v48 bitop3:0x80
    s_waitcnt vmcnt(5)
    v_mfma_f32_16x16x32_bf16 v[20:23], v[52:55], v[16:19], v[20:23]
    v_bitop3_b32 v14, v14, v50, v52 bitop3:0x80
    s_waitcnt vmcnt(4)
    v_mfma_f32_16x16x32_bf16 v[20:23], v[56:59], v[16:19], v[20:23]
    v_bitop3_b32 v14, v14, v54, v56 bitop3:0x80
    v_bitop3_b32 v14, v14, v14, v58 bitop3:0x80
    v_and_b32 v14, 1, v14
    v_cmp_ne_u32 vcc, 1, v14
    s_nop 3
    v_permlane32_swap_b32 v20, v22
    v_permlane32_swap_b32 v21, v23
    v_add_f32 v20, v20, v22
    v_add_f32 v21, v21, v23
    v_cvt_pk_bf16_f32 v20, v20, v21
    v_min_u32 v20, -2, v20
    s_cbranch_vccnz R_rf11_00
    buffer_store_dword v20, v4, s[8:11], s36 offen
    buffer_store_dword v20, v4, s[8:11], s37 offen sc1
    s_branch R_rsok_00
R_rf11_00:
    buffer_load_dwordx4 v[44:47], v3, s[8:11], s26 offen sc1
    buffer_load_dwordx4 v[48:51], v3, s[8:11], s27 offen sc1
    buffer_load_dwordx4 v[52:55], v3, s[8:11], s28 offen sc1
    buffer_load_dwordx4 v[56:59], v3, s[8:11], s29 offen sc1
    s_sub_u32 s40, s40, 1
    s_cbranch_scc1 R_abort_00
    s_branch R_rs1_00
R_rs0_00:
    s_waitcnt vmcnt(7)
    v_mfma_f32_16x16x32_bf16 v[20:23], v[80:83], v[16:19], 0
    s_waitcnt vmcnt(6)
    v_mfma_f32_16x16x32_bf16 v[20:23], v[84:87], v[16:19], v[20:23]
    v_or3_b32 v14, v80, v82, v84
    s_waitcnt vmcnt(5)
    v_mfma_f32_16x16x32_bf16 v[20:23], v[88:91], v[16:19], v[20:23]
    v_or3_b32 v14, v14, v86, v88
    s_waitcnt vmcnt(4)
    v_mfma_f32_16x16x32_bf16 v[20:23], v[92:95], v[16:19], v[20:23]
    v_or3_b32 v14, v14, v90, v92
    v_or3_b32 v14, v14, v14, v94
    v_and_b32 v14, 1, v14
    v_cmp_ne_u32 vcc, 0, v14
    s_nop 3
    v_permlane32_swap_b32 v20, v22
    v_permlane32_swap_b32 v21, v23
    v_add_f32 v20, v20, v22
    v_add_f32 v21, v21, v23
    v_cvt_pk_bf16_f32 v20, v20, v21
    v_min_u32 v20, -2, v20
    s_cbranch_vccnz R_rf00_00
    buffer_store_dword v20, v4, s[8:11], s36 offen
    buffer_store_dword v20, v4, s[8:11], s37 offen sc1
    s_branch R_rsok_00
R_rf00_00:
    buffer_load_dwordx4 v[80:83], v3, s[8:11], s26 offen sc1
    buffer_load_dwordx4 v[84:87], v3, s[8:11], s27 offen sc1
    buffer_load_dwordx4 v[88:91], v3, s[8:11], s28 offen sc1
    buffer_load_dwordx4 v[92:95], v3, s[8:11], s29 offen sc1
    s_waitcnt vmcnt(7)
    v_mfma_f32_16x16x32_bf16 v[20:23], v[44:47], v[16:19], 0
    s_waitcnt vmcnt(6)
    v_mfma_f32_16x16x32_bf16 v[20:23], v[48:51], v[16:19], v[20:23]
    v_or3_b32 v14, v44, v46, v48
    s_waitcnt vmcnt(5)
    v_mfma_f32_16x16x32_bf16 v[20:23], v[52:55], v[16:19], v[20:23]
    v_or3_b32 v14, v14, v50, v52
    s_waitcnt vmcnt(4)
    v_mfma_f32_16x16x32_bf16 v[20:23], v[56:59], v[16:19], v[20:23]
    v_or3_b32 v14, v14, v54, v56
    v_or3_b32 v14, v14, v14, v58
    v_and_b32 v14, 1, v14
    v_cmp_ne_u32 vcc, 0, v14
    s_nop 3
    v_permlane32_swap_b32 v20, v22
    v_permlane32_swap_b32 v21, v23
    v_add_f32 v20, v20, v22
    v_add_f32 v21, v21, v23
    v_cvt_pk_bf16_f32 v20, v20, v21
    v_min_u32 v20, -2, v20
    s_cbranch_vccnz R_rf01_00
    buffer_store_dword v20, v4, s[8:11], s36 offen
    buffer_store_dword v20, v4, s[8:11], s37 offen sc1
    s_branch R_rsok_00
R_rf01_00:
    buffer_load_dwordx4 v[44:47], v3, s[8:11], s26 offen sc1
    buffer_load_dwordx4 v[48:51], v3, s[8:11], s27 offen sc1
    buffer_load_dwordx4 v[52:55], v3, s[8:11], s28 offen sc1
    buffer_load_dwordx4 v[56:59], v3, s[8:11], s29 offen sc1
    s_sub_u32 s40, s40, 1
    s_cbranch_scc1 R_abort_00
    s_branch R_rs0_00
R_rsok_00:
    s_waitcnt lgkmcnt(2)
    s_barrier
    s_xor_b32 s21, s21, 1
    s_sleep 4
    buffer_load_dwordx4 v[80:83], v0, s[8:11], s32 offen sc1
    buffer_load_dword v84, v68, s[8:11], s33 offen sc1
    s_sleep 3
    buffer_load_dwordx4 v[52:55], v0, s[8:11], s32 offen sc1
    buffer_load_dword v56, v68, s[8:11], s33 offen sc1
    s_waitcnt vmcnt(3)
    ds_write_b128 v15, v[80:83] offset:0
    ds_read_b128 v[16:19], v1 offset:0
    s_waitcnt vmcnt(2)
    ds_write_b32 v13, v84 offset:0
    v_max3_u32 v14, v80, v81, v82
    v_max3_u32 v14, v14, v83, v84
    v_cmp_eq_u32 vcc, -1, v14
    s_cbranch_vccnz R_e_00
R_eput_00:
    buffer_load_dwordx4 v[88:91], v0, s[8:11], s34 offen sc1
    buffer_load_dword v92, v68, s[8:11], s35 offen sc1
R_top_00:
    s_waitcnt lgkmcnt(1)
    v_smfmac_f32_16x16x64_bf16 v[28:31], v[16:19], v[240:247], v7
    s_waitcnt lgkmcnt(0)
    s_barrier
    ds_read_b128 v[20:23], v1 offset:1024
    ds_read_b128 v[24:27], v1 offset:2048
    v_mov_b64 v[44:45], 0
    v_smfmac_f32_16x16x64_bf16 v[32:35], v[16:19], v[248:255], v7
    buffer_load_dwordx4 v[52:55], v6, s[8:11], s23 offen sc1
    v_mov_b64 v[46:47], 0
    v_smfmac_f32_16x16x64_bf16 v[36:39], v[16:19], a[0:7], v7
    buffer_load_dwordx4 v[56:59], v6, s[8:11], s23 offen offset:128 sc1
    v_mov_b64 v[48:49], 0
    v_smfmac_f32_16x16x64_bf16 v[40:43], v[16:19], v[60:67], v7
    s_waitcnt vmcnt(4)
    ds_read_b128 v[80:83], v2 offset:2048
    v_mov_b64 v[50:51], 0
    v_smfmac_f32_16x16x64_bf16 v[44:47], v[16:19], a[8:15], v7
    ds_read_b128 v[84:87], v2 offset:3072
    v_smfmac_f32_16x16x64_bf16 v[48:51], v[16:19], a[16:23], v7
    ds_read_b128 v[16:19], v1 offset:3072
    s_waitcnt lgkmcnt(4)
    v_smfmac_f32_16x16x64_bf16 v[28:31], v[20:23], a[24:31], v7
    ds_read_b128 v[60:63], v2 offset:4096
    v_smfmac_f32_16x16x64_bf16 v[32:35], v[20:23], a[32:39], v7
    ds_read_b128 v[64:67], v2 offset:5120
    v_smfmac_f32_16x16x64_bf16 v[36:39], v[20:23], a[40:47], v7
    s_waitcnt lgkmcnt(3)
    v_smfmac_f32_16x16x64_bf16 v[40:43], v[20:23], v[80:87], v7
    ds_read_b128 v[80:83], v2 offset:6144
    v_smfmac_f32_16x16x64_bf16 v[44:47], v[20:23], a[48:55], v7
    ds_read_b128 v[84:87], v2 offset:7168
    v_smfmac_f32_16x16x64_bf16 v[48:51], v[20:23], a[56:63], v7
    ds_read_b128 v[20:23], v1 offset:4096
    v_smfmac_f32_16x16x64_bf16 v[28:31], v[24:27], a[64:71], v7
    v_smfmac_f32_16x16x64_bf16 v[32:35], v[24:27], a[72:79], v7
    v_smfmac_f32_16x16x64_bf16 v[36:39], v[24:27], a[80:87], v7
    s_waitcnt lgkmcnt(3)
    v_smfmac_f32_16x16x64_bf16 v[40:43], v[24:27], v[60:67], v7
    ds_read_b128 v[60:63], v2 offset:8192
    v_smfmac_f32_16x16x64_bf16 v[44:47], v[24:27], a[88:95], v7
    ds_read_b128 v[64:67], v2 offset:9216
    v_smfmac_f32_16x16x64_bf16 v[48:51], v[24:27], a[96:103], v7
    v_smfmac_f32_16x16x64_bf16 v[28:31], v[16:19], a[104:111], v7
    s_waitcnt vmcnt(3)
    ds_write_b128 v15, v[88:91] offset:5120
    v_smfmac_f32_16x16x64_bf16 v[32:35], v[16:19], a[112:119], v7
    s_waitcnt vmcnt(2)
    ds_write_b32 v13, v92 offset:5120
    v_max3_u32 v14, v88, v89, v90
    v_smfmac_f32_16x16x64_bf16 v[36:39], v[16:19], a[120:127], v7
    v_max3_u32 v14, v14, v91, v92
    s_waitcnt lgkmcnt(5)
    v_smfmac_f32_16x16x64_bf16 v[40:43], v[16:19], v[80:87], v7
    ds_read_b128 v[80:83], v2 offset:10240
    v_cmp_eq_u32 vcc, -1, v14
    v_smfmac_f32_16x16x64_bf16 v[44:47], v[16:19], a[128:135], v7
    ds_read_b128 v[84:87], v2 offset:11264
    s_cbranch_vccnz R_slowl_00
R_contl_00:
    v_smfmac_f32_16x16x64_bf16 v[48:51], v[16:19], a[136:143], v7
    s_waitcnt lgkmcnt(2)
    s_barrier
    ds_read_b128 v[24:27], v1 offset:5120
    v_smfmac_f32_16x16x64_bf16 v[28:31], v[20:23], a[144:151], v7
    ds_read_b128 v[16:19], v1 offset:6144
    v_smfmac_f32_16x16x64_bf16 v[32:35], v[20:23], v[60:67], v7
    ds_read_b128 v[88:91], v2 offset:12288
    v_mov_b32 v14, -1
    v_smfmac_f32_16x16x64_bf16 v[36:39], v[20:23], a[152:159], v7
    ds_read_b128 v[92:95], v2 offset:13312
    s_add_u32 s64, s31, s38
    s_add_u32 s65, s31, s39
    buffer_store_dword v14, v4, s[8:11], s64 offen
    buffer_store_dword v14, v4, s[8:11], s65 offen sc1
    v_smfmac_f32_16x16x64_bf16 v[40:43], v[20:23], a[160:167], v7
    ds_read_b128 v[60:63], v2 offset:14336
    s_waitcnt lgkmcnt(5)
    v_smfmac_f32_16x16x64_bf16 v[44:47], v[20:23], v[80:87], v7
    ds_read_b128 v[64:67], v2 offset:15360
    v_smfmac_f32_16x16x64_bf16 v[48:51], v[20:23], a[168:175], v7
    ds_read_b128 v[20:23], v1 offset:7168
    s_waitcnt lgkmcnt(3)
    v_smfmac_f32_16x16x64_bf16 v[28:31], v[24:27], v[88:95], v7
    ds_read_b128 v[80:83], v2 offset:16384
    v_smfmac_f32_16x16x64_bf16 v[32:35], v[24:27], a[176:183], v7
    ds_read_b128 v[84:87], v2 offset:17408
    v_smfmac_f32_16x16x64_bf16 v[36:39], v[24:27], a[184:191], v7
    ds_read_b128 v[88:91], v2 offset:18432
    s_waitcnt lgkmcnt(4)
    v_smfmac_f32_16x16x64_bf16 v[40:43], v[24:27], v[60:67], v7
    ds_read_b128 v[24:27], v1 offset:8192
    v_smfmac_f32_16x16x64_bf16 v[28:31], v[16:19], a[192:199], v7
    ds_read_b128 v[92:95], v2 offset:19456
    s_waitcnt lgkmcnt(3)
    v_smfmac_f32_16x16x64_bf16 v[32:35], v[16:19], v[80:87], v7
    ds_read_b128 v[60:63], v2 offset:20480
    v_smfmac_f32_16x16x64_bf16 v[36:39], v[16:19], a[200:207], v7
    ds_read_b128 v[64:67], v2 offset:21504
    v_smfmac_f32_16x16x64_bf16 v[40:43], v[16:19], a[208:215], v7
    ds_read_b128 v[16:19], v1 offset:9216
    s_waitcnt lgkmcnt(3)
    v_smfmac_f32_16x16x64_bf16 v[28:31], v[20:23], v[88:95], v7
    ds_read_b128 v[80:83], v2 offset:22528
    v_smfmac_f32_16x16x64_bf16 v[32:35], v[20:23], a[216:223], v7
    ds_read_b128 v[84:87], v2 offset:23552
    v_smfmac_f32_16x16x64_bf16 v[28:31], v[24:27], a[224:231], v7
    ds_read_b128 v[88:91], v2 offset:24576
    s_waitcnt lgkmcnt(4)
    v_smfmac_f32_16x16x64_bf16 v[32:35], v[24:27], v[60:67], v7
    ds_read_b128 v[92:95], v2 offset:25600
    v_cndmask_b32 v8, v9, v12, s[52:53]
    s_waitcnt lgkmcnt(4)
    v_smfmac_f32_16x16x64_bf16 v[28:31], v[16:19], a[232:239], v7
    v_cndmask_b32 v11, v9, v12, s[52:53]
    s_waitcnt lgkmcnt(2)
    v_smfmac_f32_16x16x64_bf16 v[32:35], v[16:19], v[80:87], v7
    ds_read_b128 v[80:83], v2 offset:26624
    v_add_u32 v14, s57, v0
    v_smfmac_f32_16x16x64_bf16 v[36:39], v[20:23], a[240:247], v7
    ds_read_b128 v[84:87], v2 offset:27648
    v_smfmac_f32_16x16x64_bf16 v[40:43], v[20:23], a[248:255], v7
    s_waitcnt lgkmcnt(2)
    v_smfmac_f32_16x16x64_bf16 v[36:39], v[24:27], v[88:95], v7
    ds_read_b128 v[88:91], v2 offset:28672
    v_smfmac_f32_16x16x64_bf16 v[40:43], v[24:27], v[96:103], v7
    ds_read_b128 v[92:95], v2 offset:29696
    v_add_f32 v28, v28, v30
    v_add_f32 v29, v29, v31
    v_smfmac_f32_16x16x64_bf16 v[36:39], v[16:19], v[104:111], v7
    v_cvt_pk_bf16_f32 v68, v28, v29
    v_add_f32 v32, v32, v34
    v_smfmac_f32_16x16x64_bf16 v[40:43], v[16:19], v[112:119], v7
    v_add_f32 v33, v33, v35
    v_cvt_pk_bf16_f32 v69, v32, v33
    s_waitcnt lgkmcnt(2)
    v_smfmac_f32_16x16x64_bf16 v[44:47], v[20:23], v[80:87], v7
    ds_read_b128 v[80:83], v2 offset:30720
    v_mfma_f32_16x16x16_bf16 v[28:31], v[68:69], v[8:9], 0
    ds_read_b128 v[84:87], v2 offset:31744
    v_mfma_f32_16x16x16_bf16 v[32:35], v[68:69], v[10:11], 0
    v_smfmac_f32_16x16x64_bf16 v[48:51], v[20:23], v[120:127], v7
    ds_read_b128 v[20:23], v1 offset:5120
    v_add_f32 v36, v36, v38
    v_add_f32 v37, v37, v39
    v_cvt_pk_bf16_f32 v70, v36, v37
    v_add_f32 v40, v40, v42
    v_add_f32 v41, v41, v43
    v_cvt_pk_bf16_f32 v71, v40, v41
    v_cvt_pk_bf16_f32 v60, v28, v29
    v_cvt_pk_bf16_f32 v61, v30, v31
    v_mfma_f32_16x16x16_bf16 v[36:39], v[70:71], v[8:9], 0
    v_cvt_pk_bf16_f32 v62, v32, v33
    v_cvt_pk_bf16_f32 v63, v34, v35
    v_mfma_f32_16x16x16_bf16 v[40:43], v[70:71], v[10:11], 0
    s_nop 0
    v_mfma_f32_16x16x32_bf16 v[28:31], v[72:75], v[60:63], 0
    v_mfma_f32_16x16x32_bf16 v[32:35], v[76:79], v[60:63], 0
    s_waitcnt lgkmcnt(3)
    v_smfmac_f32_16x16x64_bf16 v[44:47], v[24:27], v[88:95], v7
    ds_read_b128 v[88:91], v2 offset:32768
    v_cvt_pk_bf16_f32 v64, v36, v37
    v_cvt_pk_bf16_f32 v65, v38, v39
    v_cvt_pk_bf16_f32 v66, v40, v41
    v_cvt_pk_bf16_f32 v67, v42, v43
    s_nop 0
    v_cndmask_b32 v28, v28, v32, s[54:55]
    v_cndmask_b32 v29, v29, v33, s[54:55]
    v_mfma_f32_16x16x32_bf16 v[36:39], v[64:67], v[60:63], 0
    v_cndmask_b32 v30, v30, v34, s[54:55]
    v_cndmask_b32 v31, v31, v35, s[54:55]
    ds_write_b128 v15, v[28:31] offset:10240
    v_smfmac_f32_16x16x64_bf16 v[48:51], v[24:27], v[128:135], v7
    ds_read_b128 v[24:27], v1 offset:6144
    s_nop 2
    v_cndmask_b32 v36, v36, v37, s[54:55]
    ds_write_b32 v14, v36 offset:14336
    buffer_load_dwordx4 v[72:75], v6, s[8:11], s22 offen sc1
    buffer_load_dwordx4 v[76:79], v6, s[8:11], s22 offen offset:128 sc1
    s_waitcnt lgkmcnt(5)
    v_smfmac_f32_16x16x64_bf16 v[44:47], v[16:19], v[80:87], v7
    ds_read_b128 v[92:95], v2 offset:33792
    ds_read_b128 v[80:83], v2 offset:34816
    v_smfmac_f32_16x16x64_bf16 v[48:51], v[16:19], v[136:143], v7
    ds_read_b128 v[84:87], v2 offset:35840
    s_waitcnt lgkmcnt(3)
    s_barrier
    ds_read_b128 v[68:71], v0 offset:14336
    ds_read_b128 v[32:35], v0 offset:11264
    ds_read_b128 v[36:39], v0 offset:12288
    ds_read_b128 v[40:43], v0 offset:13312
    s_cmp_eq_u32 s20, 63
    s_waitcnt lgkmcnt(6)
    v_smfmac_f32_16x16x64_bf16 v[44:47], v[20:23], v[88:95], v7
    v_smfmac_f32_16x16x64_bf16 v[48:51], v[20:23], v[144:151], v7
    s_waitcnt lgkmcnt(4)
    v_smfmac_f32_16x16x64_bf16 v[44:47], v[24:27], v[80:87], v7
    v_mov_b64 v[88:89], s[98:99]
    v_smfmac_f32_16x16x64_bf16 v[48:51], v[24:27], v[152:159], v7
    v_mov_b64 v[90:91], s[98:99]
    s_cbranch_scc1 R_end_00
    s_waitcnt lgkmcnt(3)
    v_pk_add_f32 v[68:69], v[68:69], v[70:71]
    s_waitcnt lgkmcnt(2)
    v_pk_add_f32 v[28:29], v[28:29], v[32:33]
    v_pk_add_f32 v[30:31], v[30:31], v[34:35]
    v_add_f32 v68, v68, v69
    s_waitcnt lgkmcnt(0)
    v_pk_add_f32 v[36:37], v[36:37], v[40:41]
    v_pk_add_f32 v[38:39], v[38:39], v[42:43]
    v_pk_add_f32 v[28:29], v[28:29], v[36:37]
    v_pk_add_f32 v[30:31], v[30:31], v[38:39]
    v_max3_f32 v13, v28, v29, v68
    v_max3_f32 v13, v30, v31, v13
    v_add_f32 v44, v44, v46
    v_add_f32 v45, v45, v47
    v_max_f32_dpp v13, v13, v13 quad_perm:[2,3,0,1] row_mask:0xf bank_mask:0xf
    v_mov_b32 v14, v13
    v_add_f32 v48, v48, v50
    v_add_f32 v49, v49, v51
    v_permlane16_swap_b32 v13, v14
    v_max_f32 v13, v13, v14
    v_mov_b32 v14, v13
    v_cvt_pk_bf16_f32 v70, v44, v45
    v_cvt_pk_bf16_f32 v71, v48, v49
    v_permlane32_swap_b32 v13, v14
    v_max_f32 v13, v13, v14
    v_mul_f32 v13, s60, v13
    v_fma_f32 v68, s60, v68, -v13
    v_pk_fma_f32 v[28:29], v[28:29], s[60:61], v[12:13] op_sel:[0,0,1] op_sel_hi:[1,0,1] neg_lo:[0,0,1] neg_hi:[0,0,1]
    v_pk_fma_f32 v[30:31], v[30:31], s[60:61], v[12:13] op_sel:[0,0,1] op_sel_hi:[1,0,1] neg_lo:[0,0,1] neg_hi:[0,0,1]
    v_exp_f32 v68, v68
    v_exp_f32 v28, v28
    v_exp_f32 v29, v29
    v_exp_f32 v30, v30
    v_exp_f32 v31, v31
    v_mov_b32_dpp v14, v68 quad_perm:[2,3,0,1] row_mask:0xf bank_mask:0xf
    v_cvt_pk_bf16_f32 v60, v28, v29
    v_cvt_pk_bf16_f32 v61, v30, v31
    v_cvt_pk_bf16_f32 v8, v68, v14
    v_cvt_pk_bf16_f32 v11, v68, v14
    v_mov_b32_dpp v62, v60 quad_perm:[2,3,0,1] row_mask:0xf bank_mask:0xf
    v_mfma_f32_16x16x16_bf16 v[28:31], v[88:89], v[8:9], 0
    v_mov_b32_dpp v63, v61 quad_perm:[2,3,0,1] row_mask:0xf bank_mask:0xf
    v_mfma_f32_16x16x16_bf16 v[36:39], v[70:71], v[8:9], 0
    v_lshrrev_b32 v14, 2, v6
    v_add_u32 v14, s59, v14
    v_mfma_f32_16x16x16_bf16 v[40:43], v[70:71], v[10:11], 0
    v_lshrrev_b32 v68, 1, v0
    v_mfma_f32_16x16x32_bf16 v[28:31], v[88:91], v[60:63], v[28:31]
    v_bfi_b32 v68, 24, v0, v68
    s_waitcnt vmcnt(5)
    v_mfma_f32_16x16x32_bf16 v[36:39], v[52:55], v[60:63], v[36:39]
    v_add_u32 v68, s59, v68
    s_waitcnt vmcnt(4)
    v_mfma_f32_16x16x32_bf16 v[40:43], v[56:59], v[60:63], v[40:43]
    s_nop 1
    v_rcp_f32 v13, v28
    s_mov_b64 exec, s[42:43]
    s_nop 0
    v_pk_mul_f32 v[36:37], v[36:37], v[12:13] op_sel:[0,1] op_sel_hi:[1,1]
    v_pk_mul_f32 v[38:39], v[38:39], v[12:13] op_sel:[0,1] op_sel_hi:[1,1]
    v_cvt_pk_bf16_f32 v36, v36, v37
    v_cvt_pk_bf16_f32 v37, v38, v39
    ds_write_b64 v5, v[36:37] offset:0
    v_pk_mul_f32 v[40:41], v[40:41], v[12:13] op_sel:[0,1] op_sel_hi:[1,1]
    v_pk_mul_f32 v[42:43], v[42:43], v[12:13] op_sel:[0,1] op_sel_hi:[1,1]
    v_cvt_pk_bf16_f32 v40, v40, v41
    v_cvt_pk_bf16_f32 v41, v42, v43
    ds_write_b64 v5, v[40:41] offset:128
    s_mov_b64 exec, -1
    v_mfma_f32_32x32x8_bf16 v[44:59], v[8:9], v[10:11], 0
    v_mfma_f32_32x32x8_bf16 v[28:43], v[8:9], v[10:11], 0
    s_waitcnt lgkmcnt(0)
    s_barrier
    ds_read_b128 v[16:19], v1 offset:0
    ds_read_b128 v[20:23], v1 offset:1024
    ds_write_b32 v14, v70 offset:12288
    ds_write_b32 v14, v71 offset:12320
    s_nop 1
    s_waitcnt lgkmcnt(3)
    v_smfmac_f32_16x16x64_bf16 v[44:47], v[16:19], v[160:167], v7
    s_waitcnt lgkmcnt(2)
    v_smfmac_f32_16x16x64_bf16 v[44:47], v[20:23], v[168:175], v7
    v_smfmac_f32_16x16x64_bf16 v[48:51], v[16:19], v[176:183], v7
    v_smfmac_f32_16x16x64_bf16 v[48:51], v[20:23], v[184:191], v7
    v_smfmac_f32_16x16x64_bf16 v[52:55], v[16:19], v[192:199], v7
    v_smfmac_f32_16x16x64_bf16 v[52:55], v[20:23], v[200:207], v7
    s_nop 3
    v_add_f32 v44, v44, v46
    v_add_f32 v45, v45, v47
    v_smfmac_f32_16x16x64_bf16 v[56:59], v[16:19], v[208:215], v7
    v_cvt_pk_bf16_f32 v24, v44, v45
    v_bfi_b32 v24, 1, s21, v24
    v_smfmac_f32_16x16x64_bf16 v[56:59], v[20:23], v[216:223], v7
    v_add_f32 v48, v48, v50
    v_permlane32_swap_b32 v24, v26
    v_smfmac_f32_16x16x64_bf16 v[28:31], v[16:19], v[224:231], v7
    v_add_f32 v49, v49, v51
    v_permlane16_swap_b32 v24, v25
    v_smfmac_f32_16x16x64_bf16 v[28:31], v[20:23], v[232:239], v7
    v_permlane16_swap_b32 v26, v27
    s_mov_b64 exec, 0xffff
    buffer_store_dwordx4 v[24:27], v0, s[8:11], s25 offen
    s_mov_b64 exec, -1
    v_cvt_pk_bf16_f32 v60, v48, v49
    v_bfi_b32 v60, 1, s21, v60
    v_add_f32 v52, v52, v54
    v_add_f32 v53, v53, v55
    v_cvt_pk_bf16_f32 v61, v52, v53
    v_add_f32 v56, v56, v58
    v_add_f32 v57, v57, v59
    v_cvt_pk_bf16_f32 v62, v56, v57
    v_bfi_b32 v62, 1, s21, v62
    v_add_f32 v28, v28, v30
    v_add_f32 v29, v29, v31
    v_cvt_pk_bf16_f32 v63, v28, v29
    buffer_store_dwordx4 v[60:63], v0, s[8:11], s24 offen
    ds_write_b128 v68, v[64:67] offset:10240
    s_branch R_comm_00
R_e_00:
    buffer_load_dwordx4 v[80:83], v0, s[8:11], s32 offen sc1
    buffer_load_dword v84, v68, s[8:11], s33 offen sc1
    s_waitcnt vmcnt(3)
    ds_write_b128 v15, v[52:55] offset:0
    s_waitcnt lgkmcnt(2)
    ds_read_b128 v[16:19], v1 offset:0
    s_waitcnt vmcnt(2)
    ds_write_b32 v13, v56 offset:0
    v_max3_u32 v14, v52, v53, v54
    v_max3_u32 v14, v14, v55, v56
    v_cmp_eq_u32 vcc, -1, v14
    s_cbranch_vccz R_eput_00
    buffer_load_dwordx4 v[52:55], v0, s[8:11], s32 offen sc1
    buffer_load_dword v56, v68, s[8:11], s33 offen sc1
    s_waitcnt vmcnt(3)
    ds_write_b128 v15, v[80:83] offset:0
    s_waitcnt lgkmcnt(2)
    ds_read_b128 v[16:19], v1 offset:0
    s_waitcnt vmcnt(2)
    ds_write_b32 v13, v84 offset:0
    v_max3_u32 v14, v80, v81, v82
    v_max3_u32 v14, v14, v83, v84
    v_cmp_eq_u32 vcc, -1, v14
    s_cbranch_vccz R_eput_00
    s_sub_u32 s40, s40, 1
    s_cbranch_scc0 R_e_00
    s_branch R_abort_00
R_slowl_00:
    v_lshrrev_b32 v14, 2, v0
    buffer_load_dwordx4 v[88:91], v0, s[8:11], s34 offen sc1
    buffer_load_dword v92, v14, s[8:11], s35 offen sc1
    s_sub_u32 s40, s40, 1
    s_cbranch_scc1 R_abort_00
    s_waitcnt vmcnt(1)
    v_max3_u32 v14, v88, v89, v90
    s_waitcnt vmcnt(0)
    v_max3_u32 v14, v14, v91, v92
    v_cmp_eq_u32 vcc, -1, v14
    s_cbranch_vccnz R_slowl_00
    ds_write_b128 v15, v[88:91] offset:5120
    ds_write_b32 v13, v92 offset:5120
    s_waitcnt lgkmcnt(0)
    s_branch R_contl_00
R_end_00:
    s_waitcnt lgkmcnt(0)
    s_lshl_b32 s64, s3, 12
    s_add_u32 s64, s64, 96337920
    s_cmp_eq_u32 s5, 0
    s_cbranch_scc0 R_endv_00
    v_lshrrev_b32 v68, 1, v0
    v_bfi_b32 v68, 24, v0, v68
    v_add_u32 v68, s59, v68
    buffer_store_dwordx4 v[64:67], v68, s[8:11], s64 offen sc1
    s_branch R_endw_00
R_endv_00:
    v_lshrrev_b32 v14, 2, v6
    v_add_u32 v14, s59, v14
    s_nop 4
    v_add_f32 v44, v44, v46
    v_add_f32 v45, v45, v47
    v_cvt_pk_bf16_f32 v44, v44, v45
    buffer_store_dword v44, v14, s[8:11], s64 offen offset:2048 sc1
    v_add_f32 v48, v48, v50
    v_add_f32 v49, v49, v51
    v_cvt_pk_bf16_f32 v48, v48, v49
    buffer_store_dword v48, v14, s[8:11], s64 offen offset:2080 sc1
R_endw_00:
    s_waitcnt vmcnt(0)
    s_barrier
R_abort_00:
    s_waitcnt vmcnt(0) lgkmcnt(0)
    s_branch R_exit
.p2align 6
R_comm_10:
    v_mov_b64 v[28:29], 0
    v_mov_b64 v[30:31], 0
    v_cndmask_b32 v16, v9, v12, s[44:45]
    v_cndmask_b32 v17, v9, v12, s[46:47]
    v_cndmask_b32 v18, v9, v12, s[48:49]
    v_cndmask_b32 v19, v9, v12, s[50:51]
    s_add_u32 s20, s20, 1
    s_add_u32 s22, s22, 0x80000
    s_add_u32 s23, s23, 0x80000
    s_add_u32 s36, s30, s38
    s_add_u32 s37, s30, s39
    s_add_u32 s32, s36, s56
    s_add_u32 s33, s36, s58
    s_add_u32 s34, s30, s6
    s_add_u32 s35, s34, s58
    s_add_u32 s34, s34, s56
    s_mov_b32 s41, s63
    s_add_u32 s63, s63, 0x20000
    s_add_u32 s30, s30, 16384
    s_cmp_eq_u32 s30, 49152
    s_cselect_b32 s30, 0, s30
    s_add_u32 s31, s31, 16384
    s_cmp_eq_u32 s31, 49152
    s_cselect_b32 s31, 0, s31
    ds_read_b128 v[60:63], v2 offset:2048
    ds_read_b128 v[64:67], v2 offset:3072
    v_lshrrev_b32 v68, 2, v0
    v_bfe_u32 v14, v68, 5, 2
    v_lshlrev_b32 v13, 8, v14
    v_and_b32 v69, 0x9c, v68
    v_add_u32 v13, v13, v69
    v_and_b32 v69, 64, v68
    v_xor_b32 v69, s71, v69
    v_add_u32 v13, v13, v69
    s_cmp_ge_u32 s3, 8
    s_cbranch_scc1 R_nored_10
    buffer_load_dwordx4 v[80:83], v3, s[8:11], s26 offen sc1
    buffer_load_dwordx4 v[84:87], v3, s[8:11], s27 offen sc1
    buffer_load_dwordx4 v[88:91], v3, s[8:11], s28 offen sc1
    buffer_load_dwordx4 v[92:95], v3, s[8:11], s29 offen sc1
    s_sleep 3
    buffer_load_dwordx4 v[44:47], v3, s[8:11], s26 offen sc1
    buffer_load_dwordx4 v[48:51], v3, s[8:11], s27 offen sc1
    buffer_load_dwordx4 v[52:55], v3, s[8:11], s28 offen sc1
    buffer_load_dwordx4 v[56:59], v3, s[8:11], s29 offen sc1
    s_cmp_eq_u32 s21, 0
    s_cbranch_scc1 R_rs0_10
R_rs1_10:
    s_waitcnt vmcnt(7)
    v_mfma_f32_16x16x32_bf16 v[20:23], v[80:83], v[16:19], 0
    s_waitcnt vmcnt(6)
    v_mfma_f32_16x16x32_bf16 v[20:23], v[84:87], v[16:19], v[20:23]
    v_bitop3_b32 v14, v80, v82, v84 bitop3:0x80
    s_waitcnt vmcnt(5)
    v_mfma_f32_16x16x32_bf16 v[20:23], v[88:91], v[16:19], v[20:23]
    v_bitop3_b32 v14, v14, v86, v88 bitop3:0x80
    s_waitcnt vmcnt(4)
    v_mfma_f32_16x16x32_bf16 v[20:23], v[92:95], v[16:19], v[20:23]
    v_bitop3_b32 v14, v14, v90, v92 bitop3:0x80
    v_bitop3_b32 v14, v14, v14, v94 bitop3:0x80
    v_and_b32 v14, 1, v14
    v_cmp_ne_u32 vcc, 1, v14
    s_nop 3
    v_permlane32_swap_b32 v20, v22
    v_permlane32_swap_b32 v21, v23
    v_add_f32 v20, v20, v22
    v_add_f32 v21, v21, v23
    v_cvt_pk_bf16_f32 v20, v20, v21
    v_min_u32 v20, -2, v20
    s_cbranch_vccnz R_rf10_10
    buffer_store_dword v20, v4, s[8:11], s36 offen
    buffer_store_dword v20, v4, s[8:11], s37 offen sc1
    s_branch R_rsok_10
R_rf10_10:
    buffer_load_dwordx4 v[80:83], v3, s[8:11], s26 offen sc1
    buffer_load_dwordx4 v[84:87], v3, s[8:11], s27 offen sc1
    buffer_load_dwordx4 v[88:91], v3, s[8:11], s28 offen sc1
    buffer_load_dwordx4 v[92:95], v3, s[8:11], s29 offen sc1
    s_waitcnt vmcnt(7)
    v_mfma_f32_16x16x32_bf16 v[20:23], v[44:47], v[16:19], 0
    s_waitcnt vmcnt(6)
    v_mfma_f32_16x16x32_bf16 v[20:23], v[48:51], v[16:19], v[20:23]
    v_bitop3_b32 v14, v44, v46, v48 bitop3:0x80
    s_waitcnt vmcnt(5)
    v_mfma_f32_16x16x32_bf16 v[20:23], v[52:55], v[16:19], v[20:23]
    v_bitop3_b32 v14, v14, v50, v52 bitop3:0x80
    s_waitcnt vmcnt(4)
    v_mfma_f32_16x16x32_bf16 v[20:23], v[56:59], v[16:19], v[20:23]
    v_bitop3_b32 v14, v14, v54, v56 bitop3:0x80
    v_bitop3_b32 v14, v14, v14, v58 bitop3:0x80
    v_and_b32 v14, 1, v14
    v_cmp_ne_u32 vcc, 1, v14
    s_nop 3
    v_permlane32_swap_b32 v20, v22
    v_permlane32_swap_b32 v21, v23
    v_add_f32 v20, v20, v22
    v_add_f32 v21, v21, v23
    v_cvt_pk_bf16_f32 v20, v20, v21
    v_min_u32 v20, -2, v20
    s_cbranch_vccnz R_rf11_10
    buffer_store_dword v20, v4, s[8:11], s36 offen
    buffer_store_dword v20, v4, s[8:11], s37 offen sc1
    s_branch R_rsok_10
R_rf11_10:
    buffer_load_dwordx4 v[44:47], v3, s[8:11], s26 offen sc1
    buffer_load_dwordx4 v[48:51], v3, s[8:11], s27 offen sc1
    buffer_load_dwordx4 v[52:55], v3, s[8:11], s28 offen sc1
    buffer_load_dwordx4 v[56:59], v3, s[8:11], s29 offen sc1
    s_sub_u32 s40, s40, 1
    s_cbranch_scc1 R_abort_10
    s_branch R_rs1_10
R_rs0_10:
    s_waitcnt vmcnt(7)
    v_mfma_f32_16x16x32_bf16 v[20:23], v[80:83], v[16:19], 0
    s_waitcnt vmcnt(6)
    v_mfma_f32_16x16x32_bf16 v[20:23], v[84:87], v[16:19], v[20:23]
    v_or3_b32 v14, v80, v82, v84
    s_waitcnt vmcnt(5)
    v_mfma_f32_16x16x32_bf16 v[20:23], v[88:91], v[16:19], v[20:23]
    v_or3_b32 v14, v14, v86, v88
    s_waitcnt vmcnt(4)
    v_mfma_f32_16x16x32_bf16 v[20:23], v[92:95], v[16:19], v[20:23]
    v_or3_b32 v14, v14, v90, v92
    v_or3_b32 v14, v14, v14, v94
    v_and_b32 v14, 1, v14
    v_cmp_ne_u32 vcc, 0, v14
    s_nop 3
    v_permlane32_swap_b32 v20, v22
    v_permlane32_swap_b32 v21, v23
    v_add_f32 v20, v20, v22
    v_add_f32 v21, v21, v23
    v_cvt_pk_bf16_f32 v20, v20, v21
    v_min_u32 v20, -2, v20
    s_cbranch_vccnz R_rf00_10
    buffer_store_dword v20, v4, s[8:11], s36 offen
    buffer_store_dword v20, v4, s[8:11], s37 offen sc1
    s_branch R_rsok_10
R_rf00_10:
    buffer_load_dwordx4 v[80:83], v3, s[8:11], s26 offen sc1
    buffer_load_dwordx4 v[84:87], v3, s[8:11], s27 offen sc1
    buffer_load_dwordx4 v[88:91], v3, s[8:11], s28 offen sc1
    buffer_load_dwordx4 v[92:95], v3, s[8:11], s29 offen sc1
    s_waitcnt vmcnt(7)
    v_mfma_f32_16x16x32_bf16 v[20:23], v[44:47], v[16:19], 0
    s_waitcnt vmcnt(6)
    v_mfma_f32_16x16x32_bf16 v[20:23], v[48:51], v[16:19], v[20:23]
    v_or3_b32 v14, v44, v46, v48
    s_waitcnt vmcnt(5)
    v_mfma_f32_16x16x32_bf16 v[20:23], v[52:55], v[16:19], v[20:23]
    v_or3_b32 v14, v14, v50, v52
    s_waitcnt vmcnt(4)
    v_mfma_f32_16x16x32_bf16 v[20:23], v[56:59], v[16:19], v[20:23]
    v_or3_b32 v14, v14, v54, v56
    v_or3_b32 v14, v14, v14, v58
    v_and_b32 v14, 1, v14
    v_cmp_ne_u32 vcc, 0, v14
    s_nop 3
    v_permlane32_swap_b32 v20, v22
    v_permlane32_swap_b32 v21, v23
    v_add_f32 v20, v20, v22
    v_add_f32 v21, v21, v23
    v_cvt_pk_bf16_f32 v20, v20, v21
    v_min_u32 v20, -2, v20
    s_cbranch_vccnz R_rf01_10
    buffer_store_dword v20, v4, s[8:11], s36 offen
    buffer_store_dword v20, v4, s[8:11], s37 offen sc1
    s_branch R_rsok_10
R_rf01_10:
    buffer_load_dwordx4 v[44:47], v3, s[8:11], s26 offen sc1
    buffer_load_dwordx4 v[48:51], v3, s[8:11], s27 offen sc1
    buffer_load_dwordx4 v[52:55], v3, s[8:11], s28 offen sc1
    buffer_load_dwordx4 v[56:59], v3, s[8:11], s29 offen sc1
    s_sub_u32 s40, s40, 1
    s_cbranch_scc1 R_abort_10
    s_branch R_rs0_10
R_rsok_10:
R_nored_10:
    s_waitcnt lgkmcnt(2)
    s_barrier
    s_xor_b32 s21, s21, 1
    s_sleep 4
    buffer_load_dwordx4 v[80:83], v0, s[8:11], s32 offen sc1
    buffer_load_dword v84, v68, s[8:11], s33 offen sc1
    s_sleep 3
    buffer_load_dwordx4 v[52:55], v0, s[8:11], s32 offen sc1
    buffer_load_dword v56, v68, s[8:11], s33 offen sc1
    s_waitcnt vmcnt(3)
    ds_write_b128 v15, v[80:83] offset:0
    ds_read_b128 v[16:19], v1 offset:1024
    s_waitcnt vmcnt(2)
    ds_write_b32 v13, v84 offset:0
    v_max3_u32 v14, v80, v81, v82
    v_max3_u32 v14, v14, v83, v84
    v_cmp_eq_u32 vcc, -1, v14
    s_cbranch_vccnz R_e_10
R_eput_10:
    buffer_load_dwordx4 v[88:91], v0, s[8:11], s34 offen sc1
    buffer_load_dword v92, v68, s[8:11], s35 offen sc1
R_top_10:
    s_waitcnt lgkmcnt(1)
    v_smfmac_f32_16x16x64_bf16 v[28:31], v[16:19], a[24:31], v7
    s_waitcnt lgkmcnt(0)
    s_barrier
    ds_read_b128 v[20:23], v1 offset:2048
    ds_read_b128 v[24:27], v1 offset:3072
    v_mov_b64 v[44:45], 0
    v_smfmac_f32_16x16x64_bf16 v[32:35], v[16:19], a[32:39], v7
    buffer_load_dwordx4 v[52:55], v6, s[8:11], s23 offen sc1
    v_mov_b64 v[46:47], 0
    v_smfmac_f32_16x16x64_bf16 v[36:39], v[16:19], a[40:47], v7
    buffer_load_dwordx4 v[56:59], v6, s[8:11], s23 offen offset:128 sc1
    v_mov_b64 v[48:49], 0
    v_smfmac_f32_16x16x64_bf16 v[40:43], v[16:19], v[60:67], v7
    s_waitcnt vmcnt(4)
    ds_read_b128 v[80:83], v2 offset:4096
    v_mov_b64 v[50:51], 0
    v_smfmac_f32_16x16x64_bf16 v[44:47], v[16:19], a[48:55], v7
    ds_read_b128 v[84:87], v2 offset:5120
    v_smfmac_f32_16x16x64_bf16 v[48:51], v[16:19], a[56:63], v7
    ds_read_b128 v[16:19], v1 offset:0
    s_waitcnt lgkmcnt(4)
    v_smfmac_f32_16x16x64_bf16 v[28:31], v[20:23], a[64:71], v7
    ds_read_b128 v[60:63], v2 offset:6144
    v_smfmac_f32_16x16x64_bf16 v[32:35], v[20:23], a[72:79], v7
    ds_read_b128 v[64:67], v2 offset:7168
    v_smfmac_f32_16x16x64_bf16 v[36:39], v[20:23], a[80:87], v7
    s_waitcnt lgkmcnt(3)
    v_smfmac_f32_16x16x64_bf16 v[40:43], v[20:23], v[80:87], v7
    ds_read_b128 v[80:83], v2 offset:0
    v_smfmac_f32_16x16x64_bf16 v[44:47], v[20:23], a[88:95], v7
    ds_read_b128 v[84:87], v2 offset:1024
    v_smfmac_f32_16x16x64_bf16 v[48:51], v[20:23], a[96:103], v7
    ds_read_b128 v[20:23], v1 offset:4096
    v_smfmac_f32_16x16x64_bf16 v[28:31], v[24:27], a[104:111], v7
    v_smfmac_f32_16x16x64_bf16 v[32:35], v[24:27], a[112:119], v7
    v_smfmac_f32_16x16x64_bf16 v[36:39], v[24:27], a[120:127], v7
    s_waitcnt lgkmcnt(3)
    v_smfmac_f32_16x16x64_bf16 v[40:43], v[24:27], v[60:67], v7
    ds_read_b128 v[60:63], v2 offset:8192
    v_smfmac_f32_16x16x64_bf16 v[44:47], v[24:27], a[128:135], v7
    ds_read_b128 v[64:67], v2 offset:9216
    v_smfmac_f32_16x16x64_bf16 v[48:51], v[24:27], a[136:143], v7
    v_smfmac_f32_16x16x64_bf16 v[28:31], v[16:19], v[240:247], v7
    s_waitcnt vmcnt(3)
    ds_write_b128 v15, v[88:91] offset:5120
    v_smfmac_f32_16x16x64_bf16 v[32:35], v[16:19], v[248:255], v7
    s_waitcnt vmcnt(2)
    ds_write_b32 v13, v92 offset:5120
    v_max3_u32 v14, v88, v89, v90
    v_smfmac_f32_16x16x64_bf16 v[36:39], v[16:19], a[0:7], v7
    v_max3_u32 v14, v14, v91, v92
    s_waitcnt lgkmcnt(5)
    v_smfmac_f32_16x16x64_bf16 v[40:43], v[16:19], v[80:87], v7
    ds_read_b128 v[80:83], v2 offset:10240
    v_cmp_eq_u32 vcc, -1, v14
    v_smfmac_f32_16x16x64_bf16 v[44:47], v[16:19], a[8:15], v7
    ds_read_b128 v[84:87], v2 offset:11264
    s_cbranch_vccnz R_slowl_10
R_contl_10:
    v_smfmac_f32_16x16x64_bf16 v[48:51], v[16:19], a[16:23], v7
    s_waitcnt lgkmcnt(2)
    s_barrier
    ds_read_b128 v[24:27], v1 offset:5120
    v_smfmac_f32_16x16x64_bf16 v[28:31], v[20:23], a[144:151], v7
    ds_read_b128 v[16:19], v1 offset:6144
    v_smfmac_f32_16x16x64_bf16 v[32:35], v[20:23], v[60:67], v7
    ds_read_b128 v[88:91], v2 offset:12288
    v_mov_b32 v14, -1
    v_smfmac_f32_16x16x64_bf16 v[36:39], v[20:23], a[152:159], v7
    ds_read_b128 v[92:95], v2 offset:13312
    s_add_u32 s64, s31, s38
    s_add_u32 s65, s31, s39
    buffer_store_dword v14, v4, s[8:11], s64 offen
    buffer_store_dword v14, v4, s[8:11], s65 offen sc1
    v_smfmac_f32_16x16x64_bf16 v[40:43], v[20:23], a[160:167], v7
    ds_read_b128 v[60:63], v2 offset:14336
    s_waitcnt lgkmcnt(5)
    v_smfmac_f32_16x16x64_bf16 v[44:47], v[20:23], v[80:87], v7
    ds_read_b128 v[64:67], v2 offset:15360
    v_smfmac_f32_16x16x64_bf16 v[48:51], v[20:23], a[168:175], v7
    ds_read_b128 v[20:23], v1 offset:7168
    s_waitcnt lgkmcnt(3)
    v_smfmac_f32_16x16x64_bf16 v[28:31], v[24:27], v[88:95], v7
    ds_read_b128 v[80:83], v2 offset:16384
    v_smfmac_f32_16x16x64_bf16 v[32:35], v[24:27], a[176:183], v7
    ds_read_b128 v[84:87], v2 offset:17408
    v_smfmac_f32_16x16x64_bf16 v[36:39], v[24:27], a[184:191], v7
    ds_read_b128 v[88:91], v2 offset:18432
    s_waitcnt lgkmcnt(4)
    v_smfmac_f32_16x16x64_bf16 v[40:43], v[24:27], v[60:67], v7
    ds_read_b128 v[24:27], v1 offset:8192
    v_smfmac_f32_16x16x64_bf16 v[28:31], v[16:19], a[192:199], v7
    ds_read_b128 v[92:95], v2 offset:19456
    s_waitcnt lgkmcnt(3)
    v_smfmac_f32_16x16x64_bf16 v[32:35], v[16:19], v[80:87], v7
    ds_read_b128 v[60:63], v2 offset:20480
    v_smfmac_f32_16x16x64_bf16 v[36:39], v[16:19], a[200:207], v7
    ds_read_b128 v[64:67], v2 offset:21504
    v_smfmac_f32_16x16x64_bf16 v[40:43], v[16:19], a[208:215], v7
    ds_read_b128 v[16:19], v1 offset:9216
    s_waitcnt lgkmcnt(3)
    v_smfmac_f32_16x16x64_bf16 v[28:31], v[20:23], v[88:95], v7
    ds_read_b128 v[80:83], v2 offset:22528
    v_smfmac_f32_16x16x64_bf16 v[32:35], v[20:23], a[216:223], v7
    ds_read_b128 v[84:87], v2 offset:23552
    v_smfmac_f32_16x16x64_bf16 v[28:31], v[24:27], a[224:231], v7
    ds_read_b128 v[88:91], v2 offset:24576
    s_waitcnt lgkmcnt(4)
    v_smfmac_f32_16x16x64_bf16 v[32:35], v[24:27], v[60:67], v7
    ds_read_b128 v[92:95], v2 offset:25600
    v_cndmask_b32 v8, v9, v12, s[52:53]
    s_waitcnt lgkmcnt(4)
    v_smfmac_f32_16x16x64_bf16 v[28:31], v[16:19], a[232:239], v7
    v_cndmask_b32 v11, v9, v12, s[52:53]
    s_waitcnt lgkmcnt(2)
    v_smfmac_f32_16x16x64_bf16 v[32:35], v[16:19], v[80:87], v7
    ds_read_b128 v[80:83], v2 offset:26624
    v_add_u32 v14, s57, v0
    v_smfmac_f32_16x16x64_bf16 v[36:39], v[20:23], a[240:247], v7
    ds_read_b128 v[84:87], v2 offset:27648
    v_smfmac_f32_16x16x64_bf16 v[40:43], v[20:23], a[248:255], v7
    s_waitcnt lgkmcnt(2)
    v_smfmac_f32_16x16x64_bf16 v[36:39], v[24:27], v[88:95], v7
    ds_read_b128 v[88:91], v2 offset:28672
    v_smfmac_f32_16x16x64_bf16 v[40:43], v[24:27], v[96:103], v7
    ds_read_b128 v[92:95], v2 offset:29696
    v_add_f32 v28, v28, v30
    v_add_f32 v29, v29, v31
    v_smfmac_f32_16x16x64_bf16 v[36:39], v[16:19], v[104:111], v7
    v_cvt_pk_bf16_f32 v68, v28, v29
    v_add_f32 v32, v32, v34
    v_smfmac_f32_16x16x64_bf16 v[40:43], v[16:19], v[112:119], v7
    v_add_f32 v33, v33, v35
    v_cvt_pk_bf16_f32 v69, v32, v33
    s_waitcnt lgkmcnt(2)
    v_smfmac_f32_16x16x64_bf16 v[44:47], v[20:23], v[80:87], v7
    ds_read_b128 v[80:83], v2 offset:30720
    v_mfma_f32_16x16x16_bf16 v[28:31], v[68:69], v[8:9], 0
    ds_read_b128 v[84:87], v2 offset:31744
    v_mfma_f32_16x16x16_bf16 v[32:35], v[68:69], v[10:11], 0
    v_smfmac_f32_16x16x64_bf16 v[48:51], v[20:23], v[120:127], v7
    ds_read_b128 v[20:23], v1 offset:5120
    v_add_f32 v36, v36, v38
    v_add_f32 v37, v37, v39
    v_cvt_pk_bf16_f32 v70, v36, v37
    v_add_f32 v40, v40, v42
    v_add_f32 v41, v41, v43
    v_cvt_pk_bf16_f32 v71, v40, v41
    v_cvt_pk_bf16_f32 v60, v28, v29
    v_cvt_pk_bf16_f32 v61, v30, v31
    v_mfma_f32_16x16x16_bf16 v[36:39], v[70:71], v[8:9], 0
    v_cvt_pk_bf16_f32 v62, v32, v33
    v_cvt_pk_bf16_f32 v63, v34, v35
    v_mfma_f32_16x16x16_bf16 v[40:43], v[70:71], v[10:11], 0
    s_nop 0
    v_mfma_f32_16x16x32_bf16 v[28:31], v[72:75], v[60:63], 0
    v_mfma_f32_16x16x32_bf16 v[32:35], v[76:79], v[60:63], 0
    s_waitcnt lgkmcnt(3)
    v_smfmac_f32_16x16x64_bf16 v[44:47], v[24:27], v[88:95], v7
    ds_read_b128 v[88:91], v2 offset:32768
    v_cvt_pk_bf16_f32 v64, v36, v37
    v_cvt_pk_bf16_f32 v65, v38, v39
    v_cvt_pk_bf16_f32 v66, v40, v41
    v_cvt_pk_bf16_f32 v67, v42, v43
    s_nop 0
    v_cndmask_b32 v28, v28, v32, s[54:55]
    v_cndmask_b32 v29, v29, v33, s[54:55]
    v_mfma_f32_16x16x32_bf16 v[36:39], v[64:67], v[60:63], 0
    v_cndmask_b32 v30, v30, v34, s[54:55]
    v_cndmask_b32 v31, v31, v35, s[54:55]
    ds_write_b128 v15, v[28:31] offset:10240
    v_smfmac_f32_16x16x64_bf16 v[48:51], v[24:27], v[128:135], v7
    ds_read_b128 v[24:27], v1 offset:6144
    s_nop 2
    v_cndmask_b32 v36, v36, v37, s[54:55]
    ds_write_b32 v14, v36 offset:14336
    buffer_load_dwordx4 v[72:75], v6, s[8:11], s22 offen sc1
    buffer_load_dwordx4 v[76:79], v6, s[8:11], s22 offen offset:128 sc1
    s_waitcnt lgkmcnt(5)
    v_smfmac_f32_16x16x64_bf16 v[44:47], v[16:19], v[80:87], v7
    ds_read_b128 v[92:95], v2 offset:33792
    ds_read_b128 v[80:83], v2 offset:34816
    v_smfmac_f32_16x16x64_bf16 v[48:51], v[16:19], v[136:143], v7
    ds_read_b128 v[84:87], v2 offset:35840
    s_waitcnt lgkmcnt(3)
    s_barrier
    ds_read_b128 v[68:71], v0 offset:14336
    ds_read_b128 v[32:35], v0 offset:12288
    ds_read_b128 v[36:39], v0 offset:13312
    ds_read_b128 v[40:43], v0 offset:10240
    s_cmp_eq_u32 s20, 63
    s_waitcnt lgkmcnt(6)
    v_smfmac_f32_16x16x64_bf16 v[44:47], v[20:23], v[88:95], v7
    v_smfmac_f32_16x16x64_bf16 v[48:51], v[20:23], v[144:151], v7
    s_waitcnt lgkmcnt(4)
    v_smfmac_f32_16x16x64_bf16 v[44:47], v[24:27], v[80:87], v7
    v_mov_b64 v[88:89], s[98:99]
    v_smfmac_f32_16x16x64_bf16 v[48:51], v[24:27], v[152:159], v7
    v_mov_b64 v[90:91], s[98:99]
    s_cbranch_scc1 R_end_10
    s_waitcnt lgkmcnt(3)
    v_pk_add_f32 v[68:69], v[68:69], v[70:71]
    s_waitcnt lgkmcnt(2)
    v_pk_add_f32 v[28:29], v[28:29], v[32:33]
    v_pk_add_f32 v[30:31], v[30:31], v[34:35]
    v_add_f32 v68, v68, v69
    s_waitcnt lgkmcnt(0)
    v_pk_add_f32 v[36:37], v[36:37], v[40:41]
    v_pk_add_f32 v[38:39], v[38:39], v[42:43]
    v_pk_add_f32 v[28:29], v[28:29], v[36:37]
    v_pk_add_f32 v[30:31], v[30:31], v[38:39]
    v_max3_f32 v13, v28, v29, v68
    v_max3_f32 v13, v30, v31, v13
    v_add_f32 v44, v44, v46
    v_add_f32 v45, v45, v47
    v_max_f32_dpp v13, v13, v13 quad_perm:[2,3,0,1] row_mask:0xf bank_mask:0xf
    v_mov_b32 v14, v13
    v_add_f32 v48, v48, v50
    v_add_f32 v49, v49, v51
    v_permlane16_swap_b32 v13, v14
    v_max_f32 v13, v13, v14
    v_mov_b32 v14, v13
    v_cvt_pk_bf16_f32 v70, v44, v45
    v_cvt_pk_bf16_f32 v71, v48, v49
    v_permlane32_swap_b32 v13, v14
    v_max_f32 v13, v13, v14
    v_mul_f32 v13, s60, v13
    v_fma_f32 v68, s60, v68, -v13
    v_pk_fma_f32 v[28:29], v[28:29], s[60:61], v[12:13] op_sel:[0,0,1] op_sel_hi:[1,0,1] neg_lo:[0,0,1] neg_hi:[0,0,1]
    v_pk_fma_f32 v[30:31], v[30:31], s[60:61], v[12:13] op_sel:[0,0,1] op_sel_hi:[1,0,1] neg_lo:[0,0,1] neg_hi:[0,0,1]
    v_exp_f32 v68, v68
    v_exp_f32 v28, v28
    v_exp_f32 v29, v29
    v_exp_f32 v30, v30
    v_exp_f32 v31, v31
    v_mov_b32_dpp v14, v68 quad_perm:[2,3,0,1] row_mask:0xf bank_mask:0xf
    v_cvt_pk_bf16_f32 v60, v28, v29
    v_cvt_pk_bf16_f32 v61, v30, v31
    v_cvt_pk_bf16_f32 v8, v68, v14
    v_cvt_pk_bf16_f32 v11, v68, v14
    v_mov_b32_dpp v62, v60 quad_perm:[2,3,0,1] row_mask:0xf bank_mask:0xf
    v_mfma_f32_16x16x16_bf16 v[28:31], v[88:89], v[8:9], 0
    v_mov_b32_dpp v63, v61 quad_perm:[2,3,0,1] row_mask:0xf bank_mask:0xf
    v_mfma_f32_16x16x16_bf16 v[36:39], v[70:71], v[8:9], 0
    v_lshrrev_b32 v14, 2, v6
    v_add_u32 v14, s59, v14
    v_mfma_f32_16x16x16_bf16 v[40:43], v[70:71], v[10:11], 0
    v_lshrrev_b32 v68, 1, v0
    v_mfma_f32_16x16x32_bf16 v[28:31], v[88:91], v[60:63], v[28:31]
    v_bfi_b32 v68, 24, v0, v68
    s_waitcnt vmcnt(5)
    v_mfma_f32_16x16x32_bf16 v[36:39], v[52:55], v[60:63], v[36:39]
    v_add_u32 v68, s59, v68
    s_waitcnt vmcnt(4)
    v_mfma_f32_16x16x32_bf16 v[40:43], v[56:59], v[60:63], v[40:43]
    s_nop 1
    v_rcp_f32 v13, v28
    s_mov_b64 exec, s[42:43]
    s_nop 0
    v_pk_mul_f32 v[36:37], v[36:37], v[12:13] op_sel:[0,1] op_sel_hi:[1,1]
    v_pk_mul_f32 v[38:39], v[38:39], v[12:13] op_sel:[0,1] op_sel_hi:[1,1]
    v_cvt_pk_bf16_f32 v36, v36, v37
    v_cvt_pk_bf16_f32 v37, v38, v39
    ds_write_b64 v5, v[36:37] offset:0
    v_pk_mul_f32 v[40:41], v[40:41], v[12:13] op_sel:[0,1] op_sel_hi:[1,1]
    v_pk_mul_f32 v[42:43], v[42:43], v[12:13] op_sel:[0,1] op_sel_hi:[1,1]
    v_cvt_pk_bf16_f32 v40, v40, v41
    v_cvt_pk_bf16_f32 v41, v42, v43
    ds_write_b64 v5, v[40:41] offset:128
    s_mov_b64 exec, -1
    v_mfma_f32_32x32x8_bf16 v[44:59], v[8:9], v[10:11], 0
    v_mfma_f32_32x32x8_bf16 v[28:43], v[8:9], v[10:11], 0
    s_waitcnt lgkmcnt(0)
    s_barrier
    ds_read_b128 v[16:19], v1 offset:0
    ds_read_b128 v[20:23], v1 offset:1024
    ds_write_b32 v14, v70 offset:12288
    ds_write_b32 v14, v71 offset:12320
    s_nop 1
    s_waitcnt lgkmcnt(3)
    v_smfmac_f32_16x16x64_bf16 v[44:47], v[16:19], v[160:167], v7
    s_waitcnt lgkmcnt(2)
    v_smfmac_f32_16x16x64_bf16 v[44:47], v[20:23], v[168:175], v7
    v_smfmac_f32_16x16x64_bf16 v[48:51], v[16:19], v[176:183], v7
    v_smfmac_f32_16x16x64_bf16 v[48:51], v[20:23], v[184:191], v7
    v_smfmac_f32_16x16x64_bf16 v[52:55], v[16:19], v[192:199], v7
    v_smfmac_f32_16x16x64_bf16 v[52:55], v[20:23], v[200:207], v7
    s_nop 3
    v_add_f32 v44, v44, v46
    v_add_f32 v45, v45, v47
    v_smfmac_f32_16x16x64_bf16 v[56:59], v[16:19], v[208:215], v7
    v_cvt_pk_bf16_f32 v24, v44, v45
    v_bfi_b32 v24, 1, s21, v24
    v_smfmac_f32_16x16x64_bf16 v[56:59], v[20:23], v[216:223], v7
    v_add_f32 v48, v48, v50
    v_permlane32_swap_b32 v24, v26
    v_smfmac_f32_16x16x64_bf16 v[28:31], v[16:19], v[224:231], v7
    v_add_f32 v49, v49, v51
    v_permlane16_swap_b32 v24, v25
    v_smfmac_f32_16x16x64_bf16 v[28:31], v[20:23], v[232:239], v7
    v_permlane16_swap_b32 v26, v27
    s_mov_b64 exec, 0xffff
    buffer_store_dwordx4 v[24:27], v0, s[8:11], s25 offen
    s_mov_b64 exec, -1
    v_cvt_pk_bf16_f32 v60, v48, v49
    v_bfi_b32 v60, 1, s21, v60
    v_add_f32 v52, v52, v54
    v_add_f32 v53, v53, v55
    v_cvt_pk_bf16_f32 v61, v52, v53
    v_add_f32 v56, v56, v58
    v_add_f32 v57, v57, v59
    v_cvt_pk_bf16_f32 v62, v56, v57
    v_bfi_b32 v62, 1, s21, v62
    v_add_f32 v28, v28, v30
    v_add_f32 v29, v29, v31
    v_cvt_pk_bf16_f32 v63, v28, v29
    buffer_store_dwordx4 v[60:63], v0, s[8:11], s24 offen
    ds_write_b128 v68, v[64:67] offset:10240
    s_branch R_comm_10
R_e_10:
    buffer_load_dwordx4 v[80:83], v0, s[8:11], s32 offen sc1
    buffer_load_dword v84, v68, s[8:11], s33 offen sc1
    s_waitcnt vmcnt(3)
    ds_write_b128 v15, v[52:55] offset:0
    s_waitcnt lgkmcnt(2)
    ds_read_b128 v[16:19], v1 offset:1024
    s_waitcnt vmcnt(2)
    ds_write_b32 v13, v56 offset:0
    v_max3_u32 v14, v52, v53, v54
    v_max3_u32 v14, v14, v55, v56
    v_cmp_eq_u32 vcc, -1, v14
    s_cbranch_vccz R_eput_10
    buffer_load_dwordx4 v[52:55], v0, s[8:11], s32 offen sc1
    buffer_load_dword v56, v68, s[8:11], s33 offen sc1
    s_waitcnt vmcnt(3)
    ds_write_b128 v15, v[80:83] offset:0
    s_waitcnt lgkmcnt(2)
    ds_read_b128 v[16:19], v1 offset:1024
    s_waitcnt vmcnt(2)
    ds_write_b32 v13, v84 offset:0
    v_max3_u32 v14, v80, v81, v82
    v_max3_u32 v14, v14, v83, v84
    v_cmp_eq_u32 vcc, -1, v14
    s_cbranch_vccz R_eput_10
    s_sub_u32 s40, s40, 1
    s_cbranch_scc0 R_e_10
    s_branch R_abort_10
R_slowl_10:
    v_lshrrev_b32 v14, 2, v0
    buffer_load_dwordx4 v[88:91], v0, s[8:11], s34 offen sc1
    buffer_load_dword v92, v14, s[8:11], s35 offen sc1
    s_sub_u32 s40, s40, 1
    s_cbranch_scc1 R_abort_10
    s_waitcnt vmcnt(1)
    v_max3_u32 v14, v88, v89, v90
    s_waitcnt vmcnt(0)
    v_max3_u32 v14, v14, v91, v92
    v_cmp_eq_u32 vcc, -1, v14
    s_cbranch_vccnz R_slowl_10
    ds_write_b128 v15, v[88:91] offset:5120
    ds_write_b32 v13, v92 offset:5120
    s_waitcnt lgkmcnt(0)
    s_branch R_contl_10
R_end_10:
    s_waitcnt lgkmcnt(0)
    s_lshl_b32 s64, s3, 12
    s_add_u32 s64, s64, 96337920
    s_cmp_eq_u32 s5, 0
    s_cbranch_scc0 R_endv_10
    v_lshrrev_b32 v68, 1, v0
    v_bfi_b32 v68, 24, v0, v68
    v_add_u32 v68, s59, v68
    buffer_store_dwordx4 v[64:67], v68, s[8:11], s64 offen sc1
    s_branch R_endw_10
R_endv_10:
    v_lshrrev_b32 v14, 2, v6
    v_add_u32 v14, s59, v14
    s_nop 4
    v_add_f32 v44, v44, v46
    v_add_f32 v45, v45, v47
    v_cvt_pk_bf16_f32 v44, v44, v45
    buffer_store_dword v44, v14, s[8:11], s64 offen offset:2048 sc1
    v_add_f32 v48, v48, v50
    v_add_f32 v49, v49, v51
    v_cvt_pk_bf16_f32 v48, v48, v49
    buffer_store_dword v48, v14, s[8:11], s64 offen offset:2080 sc1
R_endw_10:
    s_waitcnt vmcnt(0)
    s_barrier
R_abort_10:
    s_waitcnt vmcnt(0) lgkmcnt(0)
    s_branch R_exit
.p2align 6
R_comm_20:
    v_mfma_f32_32x32x8_bf16 v[44:59], v[8:9], v[10:11], 0
    v_mov_b64 v[28:29], 0
    v_mov_b64 v[30:31], 0
    s_add_u32 s20, s20, 1
    s_add_u32 s22, s22, 0x80000
    s_add_u32 s23, s23, 0x80000
    s_add_u32 s36, s30, s38
    s_add_u32 s37, s30, s39
    s_add_u32 s32, s36, s56
    s_add_u32 s33, s36, s58
    s_add_u32 s34, s30, s6
    s_add_u32 s35, s34, s58
    s_add_u32 s34, s34, s56
    s_mov_b32 s41, s63
    s_add_u32 s63, s63, 0x20000
    s_add_u32 s30, s30, 16384
    s_cmp_eq_u32 s30, 49152
    s_cselect_b32 s30, 0, s30
    s_add_u32 s31, s31, 16384
    s_cmp_eq_u32 s31, 49152
    s_cselect_b32 s31, 0, s31
    ds_read_b128 v[60:63], v2 offset:4096
    ds_read_b128 v[64:67], v2 offset:5120
    v_lshrrev_b32 v68, 2, v0
    v_bfe_u32 v14, v68, 5, 2
    v_lshlrev_b32 v13, 8, v14
    v_and_b32 v69, 0x9c, v68
    v_add_u32 v13, v13, v69
    v_and_b32 v69, 64, v68
    v_xor_b32 v69, s71, v69
    v_add_u32 v13, v13, v69
    s_waitcnt lgkmcnt(2)
    s_barrier
    s_xor_b32 s21, s21, 1
    s_sleep 4
    buffer_load_dwordx4 v[80:83], v0, s[8:11], s32 offen sc1
    buffer_load_dword v84, v68, s[8:11], s33 offen sc1
    s_sleep 3
    buffer_load_dwordx4 v[52:55], v0, s[8:11], s32 offen sc1
    buffer_load_dword v56, v68, s[8:11], s33 offen sc1
    s_waitcnt vmcnt(3)
    ds_write_b128 v15, v[80:83] offset:0
    ds_read_b128 v[16:19], v1 offset:2048
    s_waitcnt vmcnt(2)
    ds_write_b32 v13, v84 offset:0
    v_max3_u32 v14, v80, v81, v82
    v_max3_u32 v14, v14, v83, v84
    v_cmp_eq_u32 vcc, -1, v14
    s_cbranch_vccnz R_e_20
R_eput_20:
    buffer_load_dwordx4 v[88:91], v0, s[8:11], s34 offen sc1
    buffer_load_dword v92, v68, s[8:11], s35 offen sc1
R_top_20:
    s_waitcnt lgkmcnt(1)
    v_smfmac_f32_16x16x64_bf16 v[28:31], v[16:19], a[64:71], v7
    s_waitcnt lgkmcnt(0)
    s_barrier
    ds_read_b128 v[20:23], v1 offset:3072
    ds_read_b128 v[24:27], v1 offset:0
    v_smfmac_f32_16x16x64_bf16 v[32:35], v[16:19], a[72:79], v7
    buffer_load_dwordx4 v[52:55], v6, s[8:11], s23 offen sc1
    v_add_u32 v14, s62, v0
    v_smfmac_f32_16x16x64_bf16 v[36:39], v[16:19], a[80:87], v7
    buffer_load_dwordx4 v[56:59], v6, s[8:11], s23 offen offset:128 sc1
    v_smfmac_f32_16x16x64_bf16 v[40:43], v[16:19], v[60:67], v7
    s_waitcnt vmcnt(4)
    ds_read_b128 v[80:83], v2 offset:6144
    v_smfmac_f32_16x16x64_bf16 v[44:47], v[16:19], a[88:95], v7
    ds_read_b128 v[84:87], v2 offset:7168
    v_smfmac_f32_16x16x64_bf16 v[48:51], v[16:19], a[96:103], v7
    ds_read_b128 v[16:19], v1 offset:1024
    s_waitcnt lgkmcnt(4)
    v_smfmac_f32_16x16x64_bf16 v[28:31], v[20:23], a[104:111], v7
    ds_read_b128 v[60:63], v2 offset:0
    v_smfmac_f32_16x16x64_bf16 v[32:35], v[20:23], a[112:119], v7
    ds_read_b128 v[64:67], v2 offset:1024
    v_smfmac_f32_16x16x64_bf16 v[36:39], v[20:23], a[120:127], v7
    ds_read_b128 v[68:71], v14 offset:10240
    s_waitcnt lgkmcnt(4)
    v_smfmac_f32_16x16x64_bf16 v[40:43], v[20:23], v[80:87], v7
    ds_read_b128 v[80:83], v2 offset:2048
    v_smfmac_f32_16x16x64_bf16 v[44:47], v[20:23], a[128:135], v7
    ds_read_b128 v[84:87], v2 offset:3072
    v_smfmac_f32_16x16x64_bf16 v[48:51], v[20:23], a[136:143], v7
    ds_read_b128 v[20:23], v1 offset:4096
    v_smfmac_f32_16x16x64_bf16 v[28:31], v[24:27], v[240:247], v7
    v_smfmac_f32_16x16x64_bf16 v[32:35], v[24:27], v[248:255], v7
    v_smfmac_f32_16x16x64_bf16 v[36:39], v[24:27], a[0:7], v7
    s_waitcnt lgkmcnt(4)
    v_smfmac_f32_16x16x64_bf16 v[40:43], v[24:27], v[60:67], v7
    ds_read_b128 v[60:63], v2 offset:8192
    v_smfmac_f32_16x16x64_bf16 v[44:47], v[24:27], a[8:15], v7
    ds_read_b128 v[64:67], v2 offset:9216
    v_smfmac_f32_16x16x64_bf16 v[48:51], v[24:27], a[16:23], v7
    v_smfmac_f32_16x16x64_bf16 v[28:31], v[16:19], a[24:31], v7
    s_waitcnt vmcnt(3)
    ds_write_b128 v15, v[88:91] offset:5120
    v_smfmac_f32_16x16x64_bf16 v[32:35], v[16:19], a[32:39], v7
    s_waitcnt vmcnt(2)
    ds_write_b32 v13, v92 offset:5120
    v_max3_u32 v14, v88, v89, v90
    v_smfmac_f32_16x16x64_bf16 v[36:39], v[16:19], a[40:47], v7
    v_max3_u32 v14, v14, v91, v92
    s_waitcnt lgkmcnt(5)
    v_smfmac_f32_16x16x64_bf16 v[40:43], v[16:19], v[80:87], v7
    ds_read_b128 v[80:83], v2 offset:10240
    v_cmp_eq_u32 vcc, -1, v14
    v_smfmac_f32_16x16x64_bf16 v[44:47], v[16:19], a[48:55], v7
    ds_read_b128 v[84:87], v2 offset:11264
    s_cbranch_vccnz R_slowl_20
R_contl_20:
    v_smfmac_f32_16x16x64_bf16 v[48:51], v[16:19], a[56:63], v7
    s_waitcnt lgkmcnt(2)
    s_barrier
    ds_read_b128 v[24:27], v1 offset:5120
    v_smfmac_f32_16x16x64_bf16 v[28:31], v[20:23], a[144:151], v7
    ds_read_b128 v[16:19], v1 offset:6144
    buffer_store_dwordx4 v[68:71], v0, s[8:11], s41 offen sc1
    v_smfmac_f32_16x16x64_bf16 v[32:35], v[20:23], v[60:67], v7
    ds_read_b128 v[88:91], v2 offset:12288
    v_smfmac_f32_16x16x64_bf16 v[36:39], v[20:23], a[152:159], v7
    ds_read_b128 v[92:95], v2 offset:13312
    v_smfmac_f32_16x16x64_bf16 v[40:43], v[20:23], a[160:167], v7
    ds_read_b128 v[60:63], v2 offset:14336
    s_waitcnt lgkmcnt(5)
    v_smfmac_f32_16x16x64_bf16 v[44:47], v[20:23], v[80:87], v7
    ds_read_b128 v[64:67], v2 offset:15360
    v_smfmac_f32_16x16x64_bf16 v[48:51], v[20:23], a[168:175], v7
    ds_read_b128 v[20:23], v1 offset:7168
    s_waitcnt lgkmcnt(3)
    v_smfmac_f32_16x16x64_bf16 v[28:31], v[24:27], v[88:95], v7
    ds_read_b128 v[80:83], v2 offset:16384
    v_smfmac_f32_16x16x64_bf16 v[32:35], v[24:27], a[176:183], v7
    ds_read_b128 v[84:87], v2 offset:17408
    v_smfmac_f32_16x16x64_bf16 v[36:39], v[24:27], a[184:191], v7
    ds_read_b128 v[88:91], v2 offset:18432
    s_waitcnt lgkmcnt(4)
    v_smfmac_f32_16x16x64_bf16 v[40:43], v[24:27], v[60:67], v7
    ds_read_b128 v[24:27], v1 offset:8192
    v_smfmac_f32_16x16x64_bf16 v[28:31], v[16:19], a[192:199], v7
    ds_read_b128 v[92:95], v2 offset:19456
    s_waitcnt lgkmcnt(3)
    v_smfmac_f32_16x16x64_bf16 v[32:35], v[16:19], v[80:87], v7
    ds_read_b128 v[60:63], v2 offset:20480
    v_smfmac_f32_16x16x64_bf16 v[36:39], v[16:19], a[200:207], v7
    ds_read_b128 v[64:67], v2 offset:21504
    v_smfmac_f32_16x16x64_bf16 v[40:43], v[16:19], a[208:215], v7
    ds_read_b128 v[16:19], v1 offset:9216
    s_waitcnt lgkmcnt(3)
    v_smfmac_f32_16x16x64_bf16 v[28:31], v[20:23], v[88:95], v7
    ds_read_b128 v[80:83], v2 offset:22528
    v_smfmac_f32_16x16x64_bf16 v[32:35], v[20:23], a[216:223], v7
    ds_read_b128 v[84:87], v2 offset:23552
    v_smfmac_f32_16x16x64_bf16 v[28:31], v[24:27], a[224:231], v7
    ds_read_b128 v[88:91], v2 offset:24576
    s_waitcnt lgkmcnt(4)
    v_smfmac_f32_16x16x64_bf16 v[32:35], v[24:27], v[60:67], v7
    ds_read_b128 v[92:95], v2 offset:25600
    v_cndmask_b32 v8, v9, v12, s[52:53]
    s_waitcnt lgkmcnt(4)
    v_smfmac_f32_16x16x64_bf16 v[28:31], v[16:19], a[232:239], v7
    v_cndmask_b32 v11, v9, v12, s[52:53]
    s_waitcnt lgkmcnt(2)
    v_smfmac_f32_16x16x64_bf16 v[32:35], v[16:19], v[80:87], v7
    ds_read_b128 v[80:83], v2 offset:26624
    v_add_u32 v14, s57, v0
    v_smfmac_f32_16x16x64_bf16 v[36:39], v[20:23], a[240:247], v7
    ds_read_b128 v[84:87], v2 offset:27648
    v_smfmac_f32_16x16x64_bf16 v[40:43], v[20:23], a[248:255], v7
    s_waitcnt lgkmcnt(2)
    v_smfmac_f32_16x16x64_bf16 v[36:39], v[24:27], v[88:95], v7
    ds_read_b128 v[88:91], v2 offset:28672
    v_smfmac_f32_16x16x64_bf16 v[40:43], v[24:27], v[96:103], v7
    ds_read_b128 v[92:95], v2 offset:29696
    v_add_f32 v28, v28, v30
    v_add_f32 v29, v29, v31
    v_smfmac_f32_16x16x64_bf16 v[36:39], v[16:19], v[104:111], v7
    v_cvt_pk_bf16_f32 v68, v28, v29
    v_add_f32 v32, v32, v34
    v_smfmac_f32_16x16x64_bf16 v[40:43], v[16:19], v[112:119], v7
    v_add_f32 v33, v33, v35
    v_cvt_pk_bf16_f32 v69, v32, v33
    s_waitcnt lgkmcnt(2)
    v_smfmac_f32_16x16x64_bf16 v[44:47], v[20:23], v[80:87], v7
    ds_read_b128 v[80:83], v2 offset:30720
    v_mfma_f32_16x16x16_bf16 v[28:31], v[68:69], v[8:9], 0
    ds_read_b128 v[84:87], v2 offset:31744
    v_mfma_f32_16x16x16_bf16 v[32:35], v[68:69], v[10:11], 0
    v_smfmac_f32_16x16x64_bf16 v[48:51], v[20:23], v[120:127], v7
    ds_read_b128 v[20:23], v1 offset:5120
    v_add_f32 v36, v36, v38
    v_add_f32 v37, v37, v39
    v_cvt_pk_bf16_f32 v70, v36, v37
    v_add_f32 v40, v40, v42
    v_add_f32 v41, v41, v43
    v_cvt_pk_bf16_f32 v71, v40, v41
    v_cvt_pk_bf16_f32 v60, v28, v29
    v_cvt_pk_bf16_f32 v61, v30, v31
    v_mfma_f32_16x16x16_bf16 v[36:39], v[70:71], v[8:9], 0
    v_cvt_pk_bf16_f32 v62, v32, v33
    v_cvt_pk_bf16_f32 v63, v34, v35
    v_mfma_f32_16x16x16_bf16 v[40:43], v[70:71], v[10:11], 0
    s_nop 0
    v_mfma_f32_16x16x32_bf16 v[28:31], v[72:75], v[60:63], 0
    v_mfma_f32_16x16x32_bf16 v[32:35], v[76:79], v[60:63], 0
    s_waitcnt lgkmcnt(3)
    v_smfmac_f32_16x16x64_bf16 v[44:47], v[24:27], v[88:95], v7
    ds_read_b128 v[88:91], v2 offset:32768
    v_cvt_pk_bf16_f32 v64, v36, v37
    v_cvt_pk_bf16_f32 v65, v38, v39
    v_cvt_pk_bf16_f32 v66, v40, v41
    v_cvt_pk_bf16_f32 v67, v42, v43
    s_nop 0
    v_cndmask_b32 v28, v28, v32, s[54:55]
    v_cndmask_b32 v29, v29, v33, s[54:55]
    v_mfma_f32_16x16x32_bf16 v[36:39], v[64:67], v[60:63], 0
    v_cndmask_b32 v30, v30, v34, s[54:55]
    v_cndmask_b32 v31, v31, v35, s[54:55]
    ds_write_b128 v15, v[28:31] offset:10240
    v_smfmac_f32_16x16x64_bf16 v[48:51], v[24:27], v[128:135], v7
    ds_read_b128 v[24:27], v1 offset:6144
    s_nop 2
    v_cndmask_b32 v36, v36, v37, s[54:55]
    ds_write_b32 v14, v36 offset:14336
    buffer_load_dwordx4 v[72:75], v6, s[8:11], s22 offen sc1
    buffer_load_dwordx4 v[76:79], v6, s[8:11], s22 offen offset:128 sc1
    s_waitcnt lgkmcnt(5)
    v_smfmac_f32_16x16x64_bf16 v[44:47], v[16:19], v[80:87], v7
    ds_read_b128 v[92:95], v2 offset:33792
    ds_read_b128 v[80:83], v2 offset:34816
    v_smfmac_f32_16x16x64_bf16 v[48:51], v[16:19], v[136:143], v7
    ds_read_b128 v[84:87], v2 offset:35840
    s_waitcnt lgkmcnt(3)
    s_barrier
    ds_read_b128 v[68:71], v0 offset:14336
    ds_read_b128 v[32:35], v0 offset:13312
    ds_read_b128 v[36:39], v0 offset:10240
    ds_read_b128 v[40:43], v0 offset:11264
    s_cmp_eq_u32 s20, 63
    s_waitcnt lgkmcnt(6)
    v_smfmac_f32_16x16x64_bf16 v[44:47], v[20:23], v[88:95], v7
    v_smfmac_f32_16x16x64_bf16 v[48:51], v[20:23], v[144:151], v7
    s_waitcnt lgkmcnt(4)
    v_smfmac_f32_16x16x64_bf16 v[44:47], v[24:27], v[80:87], v7
    v_mov_b64 v[88:89], s[98:99]
    v_smfmac_f32_16x16x64_bf16 v[48:51], v[24:27], v[152:159], v7
    v_mov_b64 v[90:91], s[98:99]
    s_cbranch_scc1 R_end_20
    s_waitcnt lgkmcnt(3)
    v_pk_add_f32 v[68:69], v[68:69], v[70:71]
    s_waitcnt lgkmcnt(2)
    v_pk_add_f32 v[28:29], v[28:29], v[32:33]
    v_pk_add_f32 v[30:31], v[30:31], v[34:35]
    v_add_f32 v68, v68, v69
    s_waitcnt lgkmcnt(0)
    v_pk_add_f32 v[36:37], v[36:37], v[40:41]
    v_pk_add_f32 v[38:39], v[38:39], v[42:43]
    v_pk_add_f32 v[28:29], v[28:29], v[36:37]
    v_pk_add_f32 v[30:31], v[30:31], v[38:39]
    v_max3_f32 v13, v28, v29, v68
    v_max3_f32 v13, v30, v31, v13
    v_add_f32 v44, v44, v46
    v_add_f32 v45, v45, v47
    v_max_f32_dpp v13, v13, v13 quad_perm:[2,3,0,1] row_mask:0xf bank_mask:0xf
    v_mov_b32 v14, v13
    v_add_f32 v48, v48, v50
    v_add_f32 v49, v49, v51
    v_permlane16_swap_b32 v13, v14
    v_max_f32 v13, v13, v14
    v_mov_b32 v14, v13
    v_cvt_pk_bf16_f32 v70, v44, v45
    v_cvt_pk_bf16_f32 v71, v48, v49
    v_permlane32_swap_b32 v13, v14
    v_max_f32 v13, v13, v14
    v_mul_f32 v13, s60, v13
    v_fma_f32 v68, s60, v68, -v13
    v_pk_fma_f32 v[28:29], v[28:29], s[60:61], v[12:13] op_sel:[0,0,1] op_sel_hi:[1,0,1] neg_lo:[0,0,1] neg_hi:[0,0,1]
    v_pk_fma_f32 v[30:31], v[30:31], s[60:61], v[12:13] op_sel:[0,0,1] op_sel_hi:[1,0,1] neg_lo:[0,0,1] neg_hi:[0,0,1]
    v_exp_f32 v68, v68
    v_exp_f32 v28, v28
    v_exp_f32 v29, v29
    v_exp_f32 v30, v30
    v_exp_f32 v31, v31
    v_mov_b32_dpp v14, v68 quad_perm:[2,3,0,1] row_mask:0xf bank_mask:0xf
    v_cvt_pk_bf16_f32 v60, v28, v29
    v_cvt_pk_bf16_f32 v61, v30, v31
    v_cvt_pk_bf16_f32 v8, v68, v14
    v_cvt_pk_bf16_f32 v11, v68, v14
    v_mov_b32_dpp v62, v60 quad_perm:[2,3,0,1] row_mask:0xf bank_mask:0xf
    v_mfma_f32_16x16x16_bf16 v[28:31], v[88:89], v[8:9], 0
    v_mov_b32_dpp v63, v61 quad_perm:[2,3,0,1] row_mask:0xf bank_mask:0xf
    v_mfma_f32_16x16x16_bf16 v[36:39], v[70:71], v[8:9], 0
    v_lshrrev_b32 v14, 2, v6
    v_add_u32 v14, s59, v14
    v_mfma_f32_16x16x16_bf16 v[40:43], v[70:71], v[10:11], 0
    v_lshrrev_b32 v68, 1, v0
    v_mfma_f32_16x16x32_bf16 v[28:31], v[88:91], v[60:63], v[28:31]
    v_bfi_b32 v68, 24, v0, v68
    s_waitcnt vmcnt(4)
    v_mfma_f32_16x16x32_bf16 v[36:39], v[52:55], v[60:63], v[36:39]
    v_add_u32 v68, s59, v68
    s_waitcnt vmcnt(3)
    v_mfma_f32_16x16x32_bf16 v[40:43], v[56:59], v[60:63], v[40:43]
    s_nop 1
    v_rcp_f32 v13, v28
    s_mov_b64 exec, s[42:43]
    s_nop 0
    v_pk_mul_f32 v[36:37], v[36:37], v[12:13] op_sel:[0,1] op_sel_hi:[1,1]
    v_pk_mul_f32 v[38:39], v[38:39], v[12:13] op_sel:[0,1] op_sel_hi:[1,1]
    v_cvt_pk_bf16_f32 v36, v36, v37
    v_cvt_pk_bf16_f32 v37, v38, v39
    ds_write_b64 v5, v[36:37] offset:0
    v_pk_mul_f32 v[40:41], v[40:41], v[12:13] op_sel:[0,1] op_sel_hi:[1,1]
    v_pk_mul_f32 v[42:43], v[42:43], v[12:13] op_sel:[0,1] op_sel_hi:[1,1]
    v_cvt_pk_bf16_f32 v40, v40, v41
    v_cvt_pk_bf16_f32 v41, v42, v43
    ds_write_b64 v5, v[40:41] offset:128
    s_mov_b64 exec, -1
    v_mfma_f32_32x32x8_bf16 v[44:59], v[8:9], v[10:11], 0
    v_mfma_f32_32x32x8_bf16 v[28:43], v[8:9], v[10:11], 0
    s_waitcnt lgkmcnt(0)
    s_barrier
    ds_read_b128 v[16:19], v1 offset:0
    ds_read_b128 v[20:23], v1 offset:1024
    ds_write_b32 v14, v70 offset:12288
    ds_write_b32 v14, v71 offset:12320
    s_nop 1
    s_waitcnt lgkmcnt(3)
    v_smfmac_f32_16x16x64_bf16 v[44:47], v[16:19], v[160:167], v7
    s_waitcnt lgkmcnt(2)
    v_smfmac_f32_16x16x64_bf16 v[44:47], v[20:23], v[168:175], v7
    v_smfmac_f32_16x16x64_bf16 v[48:51], v[16:19], v[176:183], v7
    v_smfmac_f32_16x16x64_bf16 v[48:51], v[20:23], v[184:191], v7
    v_smfmac_f32_16x16x64_bf16 v[52:55], v[16:19], v[192:199], v7
    v_smfmac_f32_16x16x64_bf16 v[52:55], v[20:23], v[200:207], v7
    s_nop 3
    v_add_f32 v44, v44, v46
    v_add_f32 v45, v45, v47
    v_smfmac_f32_16x16x64_bf16 v[56:59], v[16:19], v[208:215], v7
    v_cvt_pk_bf16_f32 v24, v44, v45
    v_bfi_b32 v24, 1, s21, v24
    v_smfmac_f32_16x16x64_bf16 v[56:59], v[20:23], v[216:223], v7
    v_add_f32 v48, v48, v50
    v_permlane32_swap_b32 v24, v26
    v_smfmac_f32_16x16x64_bf16 v[28:31], v[16:19], v[224:231], v7
    v_add_f32 v49, v49, v51
    v_permlane16_swap_b32 v24, v25
    v_smfmac_f32_16x16x64_bf16 v[28:31], v[20:23], v[232:239], v7
    v_permlane16_swap_b32 v26, v27
    s_mov_b64 exec, 0xffff
    buffer_store_dwordx4 v[24:27], v0, s[8:11], s25 offen
    s_mov_b64 exec, -1
    v_cvt_pk_bf16_f32 v60, v48, v49
    v_bfi_b32 v60, 1, s21, v60
    v_add_f32 v52, v52, v54
    v_add_f32 v53, v53, v55
    v_cvt_pk_bf16_f32 v61, v52, v53
    v_add_f32 v56, v56, v58
    v_add_f32 v57, v57, v59
    v_cvt_pk_bf16_f32 v62, v56, v57
    v_bfi_b32 v62, 1, s21, v62
    v_add_f32 v28, v28, v30
    v_add_f32 v29, v29, v31
    v_cvt_pk_bf16_f32 v63, v28, v29
    buffer_store_dwordx4 v[60:63], v0, s[8:11], s24 offen
    ds_write_b128 v68, v[64:67] offset:10240
    s_branch R_comm_20
R_e_20:
    buffer_load_dwordx4 v[80:83], v0, s[8:11], s32 offen sc1
    buffer_load_dword v84, v68, s[8:11], s33 offen sc1
    s_waitcnt vmcnt(3)
    ds_write_b128 v15, v[52:55] offset:0
    s_waitcnt lgkmcnt(2)
    ds_read_b128 v[16:19], v1 offset:2048
    s_waitcnt vmcnt(2)
    ds_write_b32 v13, v56 offset:0
    v_max3_u32 v14, v52, v53, v54
    v_max3_u32 v14, v14, v55, v56
    v_cmp_eq_u32 vcc, -1, v14
    s_cbranch_vccz R_eput_20
    buffer_load_dwordx4 v[52:55], v0, s[8:11], s32 offen sc1
    buffer_load_dword v56, v68, s[8:11], s33 offen sc1
    s_waitcnt vmcnt(3)
    ds_write_b128 v15, v[80:83] offset:0
    s_waitcnt lgkmcnt(2)
    ds_read_b128 v[16:19], v1 offset:2048
    s_waitcnt vmcnt(2)
    ds_write_b32 v13, v84 offset:0
    v_max3_u32 v14, v80, v81, v82
    v_max3_u32 v14, v14, v83, v84
    v_cmp_eq_u32 vcc, -1, v14
    s_cbranch_vccz R_eput_20
    s_sub_u32 s40, s40, 1
    s_cbranch_scc0 R_e_20
    s_branch R_abort_20
R_slowl_20:
    v_lshrrev_b32 v14, 2, v0
    buffer_load_dwordx4 v[88:91], v0, s[8:11], s34 offen sc1
    buffer_load_dword v92, v14, s[8:11], s35 offen sc1
    s_sub_u32 s40, s40, 1
    s_cbranch_scc1 R_abort_20
    s_waitcnt vmcnt(1)
    v_max3_u32 v14, v88, v89, v90
    s_waitcnt vmcnt(0)
    v_max3_u32 v14, v14, v91, v92
    v_cmp_eq_u32 vcc, -1, v14
    s_cbranch_vccnz R_slowl_20
    ds_write_b128 v15, v[88:91] offset:5120
    ds_write_b32 v13, v92 offset:5120
    s_waitcnt lgkmcnt(0)
    s_branch R_contl_20
R_end_20:
    s_waitcnt lgkmcnt(0)
    s_lshl_b32 s64, s3, 12
    s_add_u32 s64, s64, 96337920
    s_cmp_eq_u32 s5, 0
    s_cbranch_scc0 R_endv_20
    v_lshrrev_b32 v68, 1, v0
    v_bfi_b32 v68, 24, v0, v68
    v_add_u32 v68, s59, v68
    buffer_store_dwordx4 v[64:67], v68, s[8:11], s64 offen sc1
    s_branch R_endw_20
R_endv_20:
    v_lshrrev_b32 v14, 2, v6
    v_add_u32 v14, s59, v14
    s_nop 4
    v_add_f32 v44, v44, v46
    v_add_f32 v45, v45, v47
    v_cvt_pk_bf16_f32 v44, v44, v45
    buffer_store_dword v44, v14, s[8:11], s64 offen offset:2048 sc1
    v_add_f32 v48, v48, v50
    v_add_f32 v49, v49, v51
    v_cvt_pk_bf16_f32 v48, v48, v49
    buffer_store_dword v48, v14, s[8:11], s64 offen offset:2080 sc1
R_endw_20:
    s_waitcnt vmcnt(0)
    s_barrier
R_abort_20:
    s_waitcnt vmcnt(0) lgkmcnt(0)
    s_branch R_exit
.p2align 6
R_comm_30:
    v_mfma_f32_32x32x8_bf16 v[44:59], v[8:9], v[10:11], 0
    v_mov_b64 v[28:29], 0
    v_mov_b64 v[30:31], 0
    v_mov_b32 v3, s20
    s_waitcnt vmcnt(5)
    v_cmp_eq_u32 vcc, 0, v4
    s_cbranch_vccnz R_slowk_30
R_contk_30:
    s_add_u32 s64, s20, 3
    s_lshr_b32 s64, s64, 1
    s_min_u32 s64, s64, 31
    s_lshl_b32 s64, s64, 2
    s_add_u32 s7, s64, s96
    s_add_u32 s20, s20, 1
    s_add_u32 s22, s22, 0x80000
    s_add_u32 s23, s23, 0x80000
    s_add_u32 s36, s30, s38
    s_add_u32 s37, s30, s39
    s_add_u32 s32, s36, s56
    s_add_u32 s33, s36, s58
    s_add_u32 s34, s30, s6
    s_add_u32 s35, s34, s58
    s_add_u32 s34, s34, s56
    s_mov_b32 s41, s63
    s_add_u32 s63, s63, 0x20000
    s_add_u32 s30, s30, 16384
    s_cmp_eq_u32 s30, 49152
    s_cselect_b32 s30, 0, s30
    s_add_u32 s31, s31, 16384
    s_cmp_eq_u32 s31, 49152
    s_cselect_b32 s31, 0, s31
    ds_read_b128 v[60:63], v2 offset:6144
    ds_read_b128 v[64:67], v2 offset:7168
    v_lshrrev_b32 v68, 2, v0
    v_bfe_u32 v14, v68, 5, 2
    v_lshlrev_b32 v13, 8, v14
    v_and_b32 v69, 0x9c, v68
    v_add_u32 v13, v13, v69
    v_and_b32 v69, 64, v68
    v_xor_b32 v69, s71, v69
    v_add_u32 v13, v13, v69
    s_waitcnt lgkmcnt(2)
    s_barrier
    s_xor_b32 s21, s21, 1
    s_sleep 4
    buffer_load_dwordx4 v[80:83], v0, s[8:11], s32 offen sc1
    buffer_load_dword v84, v68, s[8:11], s33 offen sc1
    s_sleep 3
    buffer_load_dwordx4 v[52:55], v0, s[8:11], s32 offen sc1
    buffer_load_dword v56, v68, s[8:11], s33 offen sc1
    s_waitcnt vmcnt(3)
    ds_write_b128 v15, v[80:83] offset:0
    ds_read_b128 v[16:19], v1 offset:3072
    s_waitcnt vmcnt(2)
    ds_write_b32 v13, v84 offset:0
    v_max3_u32 v14, v80, v81, v82
    v_max3_u32 v14, v14, v83, v84
    v_cmp_eq_u32 vcc, -1, v14
    s_cbranch_vccnz R_e_30
R_eput_30:
    buffer_load_dwordx4 v[88:91], v0, s[8:11], s34 offen sc1
    buffer_load_dword v92, v68, s[8:11], s35 offen sc1
R_top_30:
    s_waitcnt lgkmcnt(1)
    v_smfmac_f32_16x16x64_bf16 v[28:31], v[16:19], a[104:111], v7
    s_waitcnt lgkmcnt(0)
    s_barrier
    ds_read_b128 v[20:23], v1 offset:0
    ds_read_b128 v[24:27], v1 offset:1024
    v_smfmac_f32_16x16x64_bf16 v[32:35], v[16:19], a[112:119], v7
    buffer_load_dwordx4 v[52:55], v6, s[8:11], s23 offen sc1
    v_add_u32 v14, s62, v0
    v_smfmac_f32_16x16x64_bf16 v[36:39], v[16:19], a[120:127], v7
    buffer_load_dwordx4 v[56:59], v6, s[8:11], s23 offen offset:128 sc1
    v_smfmac_f32_16x16x64_bf16 v[40:43], v[16:19], v[60:67], v7
    s_waitcnt vmcnt(4)
    ds_read_b128 v[80:83], v2 offset:0
    v_smfmac_f32_16x16x64_bf16 v[44:47], v[16:19], a[128:135], v7
    ds_read_b128 v[84:87], v2 offset:1024
    v_smfmac_f32_16x16x64_bf16 v[48:51], v[16:19], a[136:143], v7
    ds_read_b128 v[16:19], v1 offset:2048
    s_waitcnt lgkmcnt(4)
    v_smfmac_f32_16x16x64_bf16 v[28:31], v[20:23], v[240:247], v7
    ds_read_b128 v[60:63], v2 offset:2048
    v_smfmac_f32_16x16x64_bf16 v[32:35], v[20:23], v[248:255], v7
    ds_read_b128 v[64:67], v2 offset:3072
    v_smfmac_f32_16x16x64_bf16 v[36:39], v[20:23], a[0:7], v7
    ds_read_b128 v[68:71], v14 offset:10240
    s_waitcnt lgkmcnt(4)
    v_smfmac_f32_16x16x64_bf16 v[40:43], v[20:23], v[80:87], v7
    ds_read_b128 v[80:83], v2 offset:4096
    v_smfmac_f32_16x16x64_bf16 v[44:47], v[20:23], a[8:15], v7
    ds_read_b128 v[84:87], v2 offset:5120
    v_smfmac_f32_16x16x64_bf16 v[48:51], v[20:23], a[16:23], v7
    ds_read_b128 v[20:23], v1 offset:4096
    v_smfmac_f32_16x16x64_bf16 v[28:31], v[24:27], a[24:31], v7
    v_smfmac_f32_16x16x64_bf16 v[32:35], v[24:27], a[32:39], v7
    v_smfmac_f32_16x16x64_bf16 v[36:39], v[24:27], a[40:47], v7
    s_waitcnt lgkmcnt(4)
    v_smfmac_f32_16x16x64_bf16 v[40:43], v[24:27], v[60:67], v7
    ds_read_b128 v[60:63], v2 offset:8192
    v_smfmac_f32_16x16x64_bf16 v[44:47], v[24:27], a[48:55], v7
    ds_read_b128 v[64:67], v2 offset:9216
    v_smfmac_f32_16x16x64_bf16 v[48:51], v[24:27], a[56:63], v7
    v_smfmac_f32_16x16x64_bf16 v[28:31], v[16:19], a[64:71], v7
    s_waitcnt vmcnt(3)
    ds_write_b128 v15, v[88:91] offset:5120
    v_smfmac_f32_16x16x64_bf16 v[32:35], v[16:19], a[72:79], v7
    s_waitcnt vmcnt(2)
    ds_write_b32 v13, v92 offset:5120
    v_max3_u32 v14, v88, v89, v90
    v_smfmac_f32_16x16x64_bf16 v[36:39], v[16:19], a[80:87], v7
    v_max3_u32 v14, v14, v91, v92
    s_waitcnt lgkmcnt(5)
    v_smfmac_f32_16x16x64_bf16 v[40:43], v[16:19], v[80:87], v7
    ds_read_b128 v[80:83], v2 offset:10240
    v_cmp_eq_u32 vcc, -1, v14
    v_and_b32 v14, 16, v0
    v_smfmac_f32_16x16x64_bf16 v[44:47], v[16:19], a[88:95], v7
    ds_read_b128 v[84:87], v2 offset:11264
    s_cbranch_vccnz R_slowl_30
R_contl_30:
    v_lshlrev_b32 v14, 7, v14
    v_smfmac_f32_16x16x64_bf16 v[48:51], v[16:19], a[96:103], v7
    s_waitcnt lgkmcnt(2)
    s_barrier
    ds_read_b128 v[24:27], v1 offset:5120
    v_smfmac_f32_16x16x64_bf16 v[28:31], v[20:23], a[144:151], v7
    ds_read_b128 v[16:19], v1 offset:6144
    buffer_store_dwordx4 v[68:71], v0, s[8:11], s41 offen sc1
    v_smfmac_f32_16x16x64_bf16 v[32:35], v[20:23], v[60:67], v7
    ds_read_b128 v[88:91], v2 offset:12288
    buffer_load_dword v4, v14, s[8:11], s7 offen sc1
    v_smfmac_f32_16x16x64_bf16 v[36:39], v[20:23], a[152:159], v7
    ds_read_b128 v[92:95], v2 offset:13312
    s_mov_b64 exec, 1
    buffer_store_dword v3, off, s[8:11], s61 sc1
    s_mov_b64 exec, -1
    v_smfmac_f32_16x16x64_bf16 v[40:43], v[20:23], a[160:167], v7
    ds_read_b128 v[60:63], v2 offset:14336
    s_waitcnt lgkmcnt(5)
    v_smfmac_f32_16x16x64_bf16 v[44:47], v[20:23], v[80:87], v7
    ds_read_b128 v[64:67], v2 offset:15360
    v_smfmac_f32_16x16x64_bf16 v[48:51], v[20:23], a[168:175], v7
    ds_read_b128 v[20:23], v1 offset:7168
    s_waitcnt lgkmcnt(3)
    v_smfmac_f32_16x16x64_bf16 v[28:31], v[24:27], v[88:95], v7
    ds_read_b128 v[80:83], v2 offset:16384
    v_smfmac_f32_16x16x64_bf16 v[32:35], v[24:27], a[176:183], v7
    ds_read_b128 v[84:87], v2 offset:17408
    v_smfmac_f32_16x16x64_bf16 v[36:39], v[24:27], a[184:191], v7
    ds_read_b128 v[88:91], v2 offset:18432
    s_waitcnt lgkmcnt(4)
    v_smfmac_f32_16x16x64_bf16 v[40:43], v[24:27], v[60:67], v7
    ds_read_b128 v[24:27], v1 offset:8192
    v_smfmac_f32_16x16x64_bf16 v[28:31], v[16:19], a[192:199], v7
    ds_read_b128 v[92:95], v2 offset:19456
    s_waitcnt lgkmcnt(3)
    v_smfmac_f32_16x16x64_bf16 v[32:35], v[16:19], v[80:87], v7
    ds_read_b128 v[60:63], v2 offset:20480
    v_smfmac_f32_16x16x64_bf16 v[36:39], v[16:19], a[200:207], v7
    ds_read_b128 v[64:67], v2 offset:21504
    v_smfmac_f32_16x16x64_bf16 v[40:43], v[16:19], a[208:215], v7
    ds_read_b128 v[16:19], v1 offset:9216
    s_waitcnt lgkmcnt(3)
    v_smfmac_f32_16x16x64_bf16 v[28:31], v[20:23], v[88:95], v7
    ds_read_b128 v[80:83], v2 offset:22528
    v_smfmac_f32_16x16x64_bf16 v[32:35], v[20:23], a[216:223], v7
    ds_read_b128 v[84:87], v2 offset:23552
    v_smfmac_f32_16x16x64_bf16 v[28:31], v[24:27], a[224:231], v7
    ds_read_b128 v[88:91], v2 offset:24576
    s_waitcnt lgkmcnt(4)
    v_smfmac_f32_16x16x64_bf16 v[32:35], v[24:27], v[60:67], v7
    ds_read_b128 v[92:95], v2 offset:25600
    v_cndmask_b32 v8, v9, v12, s[52:53]
    s_waitcnt lgkmcnt(4)
    v_smfmac_f32_16x16x64_bf16 v[28:31], v[16:19], a[232:239], v7
    v_cndmask_b32 v11, v9, v12, s[52:53]
    s_waitcnt lgkmcnt(2)
    v_smfmac_f32_16x16x64_bf16 v[32:35], v[16:19], v[80:87], v7
    ds_read_b128 v[80:83], v2 offset:26624
    v_add_u32 v14, s57, v0
    v_smfmac_f32_16x16x64_bf16 v[36:39], v[20:23], a[240:247], v7
    ds_read_b128 v[84:87], v2 offset:27648
    v_smfmac_f32_16x16x64_bf16 v[40:43], v[20:23], a[248:255], v7
    s_waitcnt lgkmcnt(2)
    v_smfmac_f32_16x16x64_bf16 v[36:39], v[24:27], v[88:95], v7
    ds_read_b128 v[88:91], v2 offset:28672
    v_smfmac_f32_16x16x64_bf16 v[40:43], v[24:27], v[96:103], v7
    ds_read_b128 v[92:95], v2 offset:29696
    v_add_f32 v28, v28, v30
    v_add_f32 v29, v29, v31
    v_smfmac_f32_16x16x64_bf16 v[36:39], v[16:19], v[104:111], v7
    v_cvt_pk_bf16_f32 v68, v28, v29
    v_add_f32 v32, v32, v34
    v_smfmac_f32_16x16x64_bf16 v[40:43], v[16:19], v[112:119], v7
    v_add_f32 v33, v33, v35
    v_cvt_pk_bf16_f32 v69, v32, v33
    s_waitcnt lgkmcnt(2)
    v_smfmac_f32_16x16x64_bf16 v[44:47], v[20:23], v[80:87], v7
    ds_read_b128 v[80:83], v2 offset:30720
    v_mfma_f32_16x16x16_bf16 v[28:31], v[68:69], v[8:9], 0
    ds_read_b128 v[84:87], v2 offset:31744
    v_mfma_f32_16x16x16_bf16 v[32:35], v[68:69], v[10:11], 0
    v_smfmac_f32_16x16x64_bf16 v[48:51], v[20:23], v[120:127], v7
    ds_read_b128 v[20:23], v1 offset:5120
    v_add_f32 v36, v36, v38
    v_add_f32 v37, v37, v39
    v_cvt_pk_bf16_f32 v70, v36, v37
    v_add_f32 v40, v40, v42
    v_add_f32 v41, v41, v43
    v_cvt_pk_bf16_f32 v71, v40, v41
    v_cvt_pk_bf16_f32 v60, v28, v29
    v_cvt_pk_bf16_f32 v61, v30, v31
    v_mfma_f32_16x16x16_bf16 v[36:39], v[70:71], v[8:9], 0
    v_cvt_pk_bf16_f32 v62, v32, v33
    v_cvt_pk_bf16_f32 v63, v34, v35
    v_mfma_f32_16x16x16_bf16 v[40:43], v[70:71], v[10:11], 0
    s_nop 0
    v_mfma_f32_16x16x32_bf16 v[28:31], v[72:75], v[60:63], 0
    v_mfma_f32_16x16x32_bf16 v[32:35], v[76:79], v[60:63], 0
    s_waitcnt lgkmcnt(3)
    v_smfmac_f32_16x16x64_bf16 v[44:47], v[24:27], v[88:95], v7
    ds_read_b128 v[88:91], v2 offset:32768
    v_cvt_pk_bf16_f32 v64, v36, v37
    v_cvt_pk_bf16_f32 v65, v38, v39
    v_cvt_pk_bf16_f32 v66, v40, v41
    v_cvt_pk_bf16_f32 v67, v42, v43
    s_nop 0
    v_cndmask_b32 v28, v28, v32, s[54:55]
    v_cndmask_b32 v29, v29, v33, s[54:55]
    v_mfma_f32_16x16x32_bf16 v[36:39], v[64:67], v[60:63], 0
    v_cndmask_b32 v30, v30, v34, s[54:55]
    v_cndmask_b32 v31, v31, v35, s[54:55]
    ds_write_b128 v15, v[28:31] offset:10240
    v_smfmac_f32_16x16x64_bf16 v[48:51], v[24:27], v[128:135], v7
    ds_read_b128 v[24:27], v1 offset:6144
    s_nop 2
    v_cndmask_b32 v36, v36, v37, s[54:55]
    ds_write_b32 v14, v36 offset:14336
    buffer_load_dwordx4 v[72:75], v6, s[8:11], s22 offen sc1
    buffer_load_dwordx4 v[76:79], v6, s[8:11], s22 offen offset:128 sc1
    s_waitcnt lgkmcnt(5)
    v_smfmac_f32_16x16x64_bf16 v[44:47], v[16:19], v[80:87], v7
    ds_read_b128 v[92:95], v2 offset:33792
    ds_read_b128 v[80:83], v2 offset:34816
    v_smfmac_f32_16x16x64_bf16 v[48:51], v[16:19], v[136:143], v7
    ds_read_b128 v[84:87], v2 offset:35840
    s_waitcnt lgkmcnt(3)
    s_barrier
    ds_read_b128 v[68:71], v0 offset:14336
    ds_read_b128 v[32:35], v0 offset:10240
    ds_read_b128 v[36:39], v0 offset:11264
    ds_read_b128 v[40:43], v0 offset:12288
    s_cmp_eq_u32 s20, 63
    s_waitcnt lgkmcnt(6)
    v_smfmac_f32_16x16x64_bf16 v[44:47], v[20:23], v[88:95], v7
    v_smfmac_f32_16x16x64_bf16 v[48:51], v[20:23], v[144:151], v7
    s_waitcnt lgkmcnt(4)
    v_smfmac_f32_16x16x64_bf16 v[44:47], v[24:27], v[80:87], v7
    v_mov_b64 v[88:89], s[98:99]
    v_smfmac_f32_16x16x64_bf16 v[48:51], v[24:27], v[152:159], v7
    v_mov_b64 v[90:91], s[98:99]
    s_cbranch_scc1 R_end_30
    s_waitcnt lgkmcnt(3)
    v_pk_add_f32 v[68:69], v[68:69], v[70:71]
    s_waitcnt lgkmcnt(2)
    v_pk_add_f32 v[28:29], v[28:29], v[32:33]
    v_pk_add_f32 v[30:31], v[30:31], v[34:35]
    v_add_f32 v68, v68, v69
    s_waitcnt lgkmcnt(0)
    v_pk_add_f32 v[36:37], v[36:37], v[40:41]
    v_pk_add_f32 v[38:39], v[38:39], v[42:43]
    v_pk_add_f32 v[28:29], v[28:29], v[36:37]
    v_pk_add_f32 v[30:31], v[30:31], v[38:39]
    v_max3_f32 v13, v28, v29, v68
    v_max3_f32 v13, v30, v31, v13
    v_add_f32 v44, v44, v46
    v_add_f32 v45, v45, v47
    v_max_f32_dpp v13, v13, v13 quad_perm:[2,3,0,1] row_mask:0xf bank_mask:0xf
    v_mov_b32 v14, v13
    v_add_f32 v48, v48, v50
    v_add_f32 v49, v49, v51
    v_permlane16_swap_b32 v13, v14
    v_max_f32 v13, v13, v14
    v_mov_b32 v14, v13
    v_cvt_pk_bf16_f32 v70, v44, v45
    v_cvt_pk_bf16_f32 v71, v48, v49
    v_permlane32_swap_b32 v13, v14
    v_max_f32 v13, v13, v14
    v_mul_f32 v13, s60, v13
    v_fma_f32 v68, s60, v68, -v13
    v_pk_fma_f32 v[28:29], v[28:29], s[60:61], v[12:13] op_sel:[0,0,1] op_sel_hi:[1,0,1] neg_lo:[0,0,1] neg_hi:[0,0,1]
    v_pk_fma_f32 v[30:31], v[30:31], s[60:61], v[12:13] op_sel:[0,0,1] op_sel_hi:[1,0,1] neg_lo:[0,0,1] neg_hi:[0,0,1]
    v_exp_f32 v68, v68
    v_exp_f32 v28, v28
    v_exp_f32 v29, v29
    v_exp_f32 v30, v30
    v_exp_f32 v31, v31
    v_mov_b32_dpp v14, v68 quad_perm:[2,3,0,1] row_mask:0xf bank_mask:0xf
    v_cvt_pk_bf16_f32 v60, v28, v29
    v_cvt_pk_bf16_f32 v61, v30, v31
    v_cvt_pk_bf16_f32 v8, v68, v14
    v_cvt_pk_bf16_f32 v11, v68, v14
    v_mov_b32_dpp v62, v60 quad_perm:[2,3,0,1] row_mask:0xf bank_mask:0xf
    v_mfma_f32_16x16x16_bf16 v[28:31], v[88:89], v[8:9], 0
    v_mov_b32_dpp v63, v61 quad_perm:[2,3,0,1] row_mask:0xf bank_mask:0xf
    v_mfma_f32_16x16x16_bf16 v[36:39], v[70:71], v[8:9], 0
    v_lshrrev_b32 v14, 2, v6
    v_add_u32 v14, s59, v14
    v_mfma_f32_16x16x16_bf16 v[40:43], v[70:71], v[10:11], 0
    v_lshrrev_b32 v68, 1, v0
    v_mfma_f32_16x16x32_bf16 v[28:31], v[88:91], v[60:63], v[28:31]
    v_bfi_b32 v68, 24, v0, v68
    s_waitcnt vmcnt(6)
    v_mfma_f32_16x16x32_bf16 v[36:39], v[52:55], v[60:63], v[36:39]
    v_add_u32 v68, s59, v68
    s_waitcnt vmcnt(5)
    v_mfma_f32_16x16x32_bf16 v[40:43], v[56:59], v[60:63], v[40:43]
    s_nop 1
    v_rcp_f32 v13, v28
    s_mov_b64 exec, s[42:43]
    s_nop 0
    v_pk_mul_f32 v[36:37], v[36:37], v[12:13] op_sel:[0,1] op_sel_hi:[1,1]
    v_pk_mul_f32 v[38:39], v[38:39], v[12:13] op_sel:[0,1] op_sel_hi:[1,1]
    v_cvt_pk_bf16_f32 v36, v36, v37
    v_cvt_pk_bf16_f32 v37, v38, v39
    ds_write_b64 v5, v[36:37] offset:0
    v_pk_mul_f32 v[40:41], v[40:41], v[12:13] op_sel:[0,1] op_sel_hi:[1,1]
    v_pk_mul_f32 v[42:43], v[42:43], v[12:13] op_sel:[0,1] op_sel_hi:[1,1]
    v_cvt_pk_bf16_f32 v40, v40, v41
    v_cvt_pk_bf16_f32 v41, v42, v43
    ds_write_b64 v5, v[40:41] offset:128
    s_mov_b64 exec, -1
    v_mfma_f32_32x32x8_bf16 v[44:59], v[8:9], v[10:11], 0
    v_mfma_f32_32x32x8_bf16 v[28:43], v[8:9], v[10:11], 0
    s_waitcnt lgkmcnt(0)
    s_barrier
    ds_read_b128 v[16:19], v1 offset:0
    ds_read_b128 v[20:23], v1 offset:1024
    ds_write_b32 v14, v70 offset:12288
    ds_write_b32 v14, v71 offset:12320
    s_nop 1
    s_waitcnt lgkmcnt(3)
    v_smfmac_f32_16x16x64_bf16 v[44:47], v[16:19], v[160:167], v7
    s_waitcnt lgkmcnt(2)
    v_smfmac_f32_16x16x64_bf16 v[44:47], v[20:23], v[168:175], v7
    v_smfmac_f32_16x16x64_bf16 v[48:51], v[16:19], v[176:183], v7
    v_smfmac_f32_16x16x64_bf16 v[48:51], v[20:23], v[184:191], v7
    v_smfmac_f32_16x16x64_bf16 v[52:55], v[16:19], v[192:199], v7
    v_smfmac_f32_16x16x64_bf16 v[52:55], v[20:23], v[200:207], v7
    s_nop 3
    v_add_f32 v44, v44, v46
    v_add_f32 v45, v45, v47
    v_smfmac_f32_16x16x64_bf16 v[56:59], v[16:19], v[208:215], v7
    v_cvt_pk_bf16_f32 v24, v44, v45
    v_bfi_b32 v24, 1, s21, v24
    v_smfmac_f32_16x16x64_bf16 v[56:59], v[20:23], v[216:223], v7
    v_add_f32 v48, v48, v50
    v_permlane32_swap_b32 v24, v26
    v_smfmac_f32_16x16x64_bf16 v[28:31], v[16:19], v[224:231], v7
    v_add_f32 v49, v49, v51
    v_permlane16_swap_b32 v24, v25
    v_smfmac_f32_16x16x64_bf16 v[28:31], v[20:23], v[232:239], v7
    v_permlane16_swap_b32 v26, v27
    s_mov_b64 exec, 0xffff
    buffer_store_dwordx4 v[24:27], v0, s[8:11], s25 offen
    s_mov_b64 exec, -1
    v_cvt_pk_bf16_f32 v60, v48, v49
    v_bfi_b32 v60, 1, s21, v60
    v_add_f32 v52, v52, v54
    v_add_f32 v53, v53, v55
    v_cvt_pk_bf16_f32 v61, v52, v53
    v_add_f32 v56, v56, v58
    v_add_f32 v57, v57, v59
    v_cvt_pk_bf16_f32 v62, v56, v57
    v_bfi_b32 v62, 1, s21, v62
    v_add_f32 v28, v28, v30
    v_add_f32 v29, v29, v31
    v_cvt_pk_bf16_f32 v63, v28, v29
    buffer_store_dwordx4 v[60:63], v0, s[8:11], s24 offen
    ds_write_b128 v68, v[64:67] offset:10240
    s_branch R_comm_30
R_e_30:
    buffer_load_dwordx4 v[80:83], v0, s[8:11], s32 offen sc1
    buffer_load_dword v84, v68, s[8:11], s33 offen sc1
    s_waitcnt vmcnt(3)
    ds_write_b128 v15, v[52:55] offset:0
    s_waitcnt lgkmcnt(2)
    ds_read_b128 v[16:19], v1 offset:3072
    s_waitcnt vmcnt(2)
    ds_write_b32 v13, v56 offset:0
    v_max3_u32 v14, v52, v53, v54
    v_max3_u32 v14, v14, v55, v56
    v_cmp_eq_u32 vcc, -1, v14
    s_cbranch_vccz R_eput_30
    buffer_load_dwordx4 v[52:55], v0, s[8:11], s32 offen sc1
    buffer_load_dword v56, v68, s[8:11], s33 offen sc1
    s_waitcnt vmcnt(3)
    ds_write_b128 v15, v[80:83] offset:0
    s_waitcnt lgkmcnt(2)
    ds_read_b128 v[16:19], v1 offset:3072
    s_waitcnt vmcnt(2)
    ds_write_b32 v13, v84 offset:0
    v_max3_u32 v14, v80, v81, v82
    v_max3_u32 v14, v14, v83, v84
    v_cmp_eq_u32 vcc, -1, v14
    s_cbranch_vccz R_eput_30
    s_sub_u32 s40, s40, 1
    s_cbranch_scc0 R_e_30
    s_branch R_abort_30
R_slowl_30:
    v_lshrrev_b32 v14, 2, v0
    buffer_load_dwordx4 v[88:91], v0, s[8:11], s34 offen sc1
    buffer_load_dword v92, v14, s[8:11], s35 offen sc1
    s_sub_u32 s40, s40, 1
    s_cbranch_scc1 R_abort_30
    s_waitcnt vmcnt(1)
    v_max3_u32 v14, v88, v89, v90
    s_waitcnt vmcnt(0)
    v_max3_u32 v14, v14, v91, v92
    v_cmp_eq_u32 vcc, -1, v14
    s_cbranch_vccnz R_slowl_30
    ds_write_b128 v15, v[88:91] offset:5120
    ds_write_b32 v13, v92 offset:5120
    s_waitcnt lgkmcnt(0)
    s_branch R_contl_30
R_slowk_30:
    v_and_b32 v14, 16, v0
    v_lshlrev_b32 v14, 7, v14
    buffer_load_dword v4, v14, s[8:11], s7 offen sc1
    s_sub_u32 s40, s40, 1
    s_cbranch_scc1 R_abort_30
    s_waitcnt vmcnt(0)
    v_cmp_eq_u32 vcc, 0, v4
    s_cbranch_vccnz R_slowk_30
    s_branch R_contk_30
R_end_30:
    s_waitcnt lgkmcnt(0)
    s_lshl_b32 s64, s3, 12
    s_add_u32 s64, s64, 96337920
    s_cmp_eq_u32 s5, 0
    s_cbranch_scc0 R_endv_30
    v_lshrrev_b32 v68, 1, v0
    v_bfi_b32 v68, 24, v0, v68
    v_add_u32 v68, s59, v68
    buffer_store_dwordx4 v[64:67], v68, s[8:11], s64 offen sc1
    s_branch R_endw_30
R_endv_30:
    v_lshrrev_b32 v14, 2, v6
    v_add_u32 v14, s59, v14
    s_nop 4
    v_add_f32 v44, v44, v46
    v_add_f32 v45, v45, v47
    v_cvt_pk_bf16_f32 v44, v44, v45
    buffer_store_dword v44, v14, s[8:11], s64 offen offset:2048 sc1
    v_add_f32 v48, v48, v50
    v_add_f32 v49, v49, v51
    v_cvt_pk_bf16_f32 v48, v48, v49
    buffer_store_dword v48, v14, s[8:11], s64 offen offset:2080 sc1
R_endw_30:
    s_waitcnt vmcnt(0)
    s_barrier
    v_mov_b32 v14, 64
    s_mov_b64 exec, 1
    buffer_store_dword v14, off, s[8:11], s61 sc1
    s_mov_b64 exec, -1
R_abort_30:
    s_waitcnt vmcnt(0) lgkmcnt(0)
    s_branch R_exit
.p2align 6
R_comm_01:
    v_mov_b64 v[28:29], 0
    v_mov_b64 v[30:31], 0
    v_cndmask_b32 v16, v9, v12, s[44:45]
    v_cndmask_b32 v17, v9, v12, s[46:47]
    v_cndmask_b32 v18, v9, v12, s[48:49]
    v_cndmask_b32 v19, v9, v12, s[50:51]
    s_add_u32 s20, s20, 1
    s_add_u32 s22, s22, 0x80000
    s_add_u32 s23, s23, 0x80000
    s_add_u32 s36, s30, s38
    s_add_u32 s37, s30, s39
    s_add_u32 s32, s36, s56
    s_add_u32 s33, s36, s58
    s_add_u32 s34, s30, s6
    s_add_u32 s35, s34, s58
    s_add_u32 s34, s34, s56
    s_mov_b32 s41, s63
    s_add_u32 s63, s63, 0x20000
    s_add_u32 s30, s30, 16384
    s_cmp_eq_u32 s30, 49152
    s_cselect_b32 s30, 0, s30
    s_add_u32 s31, s31, 16384
    s_cmp_eq_u32 s31, 49152
    s_cselect_b32 s31, 0, s31
    ds_read_b128 v[60:63], v2 offset:0
    ds_read_b128 v[64:67], v2 offset:1024
    v_lshrrev_b32 v68, 2, v0
    v_bfe_u32 v14, v68, 5, 2
    v_lshlrev_b32 v13, 8, v14
    v_and_b32 v69, 0x9c, v68
    v_add_u32 v13, v13, v69
    v_and_b32 v69, 64, v68
    v_xor_b32 v69, s71, v69
    v_add_u32 v13, v13, v69
    buffer_load_dwordx4 v[80:83], v3, s[8:11], s26 offen sc1
    buffer_load_dwordx4 v[84:87], v3, s[8:11], s27 offen sc1
    buffer_load_dwordx4 v[88:91], v3, s[8:11], s28 offen sc1
    buffer_load_dwordx4 v[92:95], v3, s[8:11], s29 offen sc1
    s_sleep 3
    buffer_load_dwordx4 v[44:47], v3, s[8:11], s26 offen sc1
    buffer_load_dwordx4 v[48:51], v3, s[8:11], s27 offen sc1
    buffer_load_dwordx4 v[52:55], v3, s[8:11], s28 offen sc1
    buffer_load_dwordx4 v[56:59], v3, s[8:11], s29 offen sc1
    s_cmp_eq_u32 s21, 0
    s_cbranch_scc1 R_rs0_01
R_rs1_01:
    s_waitcnt vmcnt(7)
    v_mfma_f32_16x16x32_bf16 v[20:23], v[80:83], v[16:19], 0
    s_waitcnt vmcnt(6)
    v_mfma_f32_16x16x32_bf16 v[20:23], v[84:87], v[16:19], v[20:23]
    v_bitop3_b32 v14, v80, v82, v84 bitop3:0x80
    s_waitcnt vmcnt(5)
    v_mfma_f32_16x16x32_bf16 v[20:23], v[88:91], v[16:19], v[20:23]
    v_bitop3_b32 v14, v14, v86, v88 bitop3:0x80
    s_waitcnt vmcnt(4)
    v_mfma_f32_16x16x32_bf16 v[20:23], v[92:95], v[16:19], v[20:23]
    v_bitop3_b32 v14, v14, v90, v92 bitop3:0x80
    v_bitop3_b32 v14, v14, v14, v94 bitop3:0x80
    v_and_b32 v14, 1, v14
    v_cmp_ne_u32 vcc, 1, v14
    s_nop 3
    v_permlane32_swap_b32 v20, v22
    v_permlane32_swap_b32 v21, v23
    v_add_f32 v20, v20, v22
    v_add_f32 v21, v21, v23
    v_cvt_pk_bf16_f32 v20, v20, v21
    v_min_u32 v20, -2, v20
    s_cbranch_vccnz R_rf10_01
    buffer_store_dword v20, v4, s[8:11], s36 offen sc1
    buffer_store_dword v20, v4, s[8:11], s37 offen sc1
    s_branch R_rsok_01
R_rf10_01:
    buffer_load_dwordx4 v[80:83], v3, s[8:11], s26 offen sc1
    buffer_load_dwordx4 v[84:87], v3, s[8:11], s27 offen sc1
    buffer_load_dwordx4 v[88:91], v3, s[8:11], s28 offen sc1
    buffer_load_dwordx4 v[92:95], v3, s[8:11], s29 offen sc1
    s_waitcnt vmcnt(7)
    v_mfma_f32_16x16x32_bf16 v[20:23], v[44:47], v[16:19], 0
    s_waitcnt vmcnt(6)
    v_mfma_f32_16x16x32_bf16 v[20:23], v[48:51], v[16:19], v[20:23]
    v_bitop3_b32 v14, v44, v46, v48 bitop3:0x80
    s_waitcnt vmcnt(5)
    v_mfma_f32_16x16x32_bf16 v[20:23], v[52:55], v[16:19], v[20:23]
    v_bitop3_b32 v14, v14, v50, v52 bitop3:0x80
    s_waitcnt vmcnt(4)
    v_mfma_f32_16x16x32_bf16 v[20:23], v[56:59], v[16:19], v[20:23]
    v_bitop3_b32 v14, v14, v54, v56 bitop3:0x80
    v_bitop3_b32 v14, v14, v14, v58 bitop3:0x80
    v_and_b32 v14, 1, v14
    v_cmp_ne_u32 vcc, 1, v14
    s_nop 3
    v_permlane32_swap_b32 v20, v22
    v_permlane32_swap_b32 v21, v23
    v_add_f32 v20, v20, v22
    v_add_f32 v21, v21, v23
    v_cvt_pk_bf16_f32 v20, v20, v21
    v_min_u32 v20, -2, v20
    s_cbranch_vccnz R_rf11_01
    buffer_store_dword v20, v4, s[8:11], s36 offen sc1
    buffer_store_dword v20, v4, s[8:11], s37 offen sc1
    s_branch R_rsok_01
R_rf11_01:
    buffer_load_dwordx4 v[44:47], v3, s[8:11], s26 offen sc1
    buffer_load_dwordx4 v[48:51], v3, s[8:11], s27 offen sc1
    buffer_load_dwordx4 v[52:55], v3, s[8:11], s28 offen sc1
    buffer_load_dwordx4 v[56:59], v3, s[8:11], s29 offen sc1
    s_sub_u32 s40, s40, 1
    s_cbranch_scc1 R_abort_01
    s_branch R_rs1_01
R_rs0_01:
    s_waitcnt vmcnt(7)
    v_mfma_f32_16x16x32_bf16 v[20:23], v[80:83], v[16:19], 0
    s_waitcnt vmcnt(6)
    v_mfma_f32_16x16x32_bf16 v[20:23], v[84:87], v[16:19], v[20:23]
    v_or3_b32 v14, v80, v82, v84
    s_waitcnt vmcnt(5)
    v_mfma_f32_16x16x32_bf16 v[20:23], v[88:91], v[16:19], v[20:23]
    v_or3_b32 v14, v14, v86, v88
    s_waitcnt vmcnt(4)
    v_mfma_f32_16x16x32_bf16 v[20:23], v[92:95], v[16:19], v[20:23]
    v_or3_b32 v14, v14, v90, v92
    v_or3_b32 v14, v14, v14, v94
    v_and_b32 v14, 1, v14
    v_cmp_ne_u32 vcc, 0, v14
    s_nop 3
    v_permlane32_swap_b32 v20, v22
    v_permlane32_swap_b32 v21, v23
    v_add_f32 v20, v20, v22
    v_add_f32 v21, v21, v23
    v_cvt_pk_bf16_f32 v20, v20, v21
    v_min_u32 v20, -2, v20
    s_cbranch_vccnz R_rf00_01
    buffer_store_dword v20, v4, s[8:11], s36 offen sc1
    buffer_store_dword v20, v4, s[8:11], s37 offen sc1
    s_branch R_rsok_01
R_rf00_01:
    buffer_load_dwordx4 v[80:83], v3, s[8:11], s26 offen sc1
    buffer_load_dwordx4 v[84:87], v3, s[8:11], s27 offen sc1
    buffer_load_dwordx4 v[88:91], v3, s[8:11], s28 offen sc1
    buffer_load_dwordx4 v[92:95], v3, s[8:11], s29 offen sc1
    s_waitcnt vmcnt(7)
    v_mfma_f32_16x16x32_bf16 v[20:23], v[44:47], v[16:19], 0
    s_waitcnt vmcnt(6)
    v_mfma_f32_16x16x32_bf16 v[20:23], v[48:51], v[16:19], v[20:23]
    v_or3_b32 v14, v44, v46, v48
    s_waitcnt vmcnt(5)
    v_mfma_f32_16x16x32_bf16 v[20:23], v[52:55], v[16:19], v[20:23]
    v_or3_b32 v14, v14, v50, v52
    s_waitcnt vmcnt(4)
    v_mfma_f32_16x16x32_bf16 v[20:23], v[56:59], v[16:19], v[20:23]
    v_or3_b32 v14, v14, v54, v56
    v_or3_b32 v14, v14, v14, v58
    v_and_b32 v14, 1, v14
    v_cmp_ne_u32 vcc, 0, v14
    s_nop 3
    v_permlane32_swap_b32 v20, v22
    v_permlane32_swap_b32 v21, v23
    v_add_f32 v20, v20, v22
    v_add_f32 v21, v21, v23
    v_cvt_pk_bf16_f32 v20, v20, v21
    v_min_u32 v20, -2, v20
    s_cbranch_vccnz R_rf01_01
    buffer_store_dword v20, v4, s[8:11], s36 offen sc1
    buffer_store_dword v20, v4, s[8:11], s37 offen sc1
    s_branch R_rsok_01
R_rf01_01:
    buffer_load_dwordx4 v[44:47], v3, s[8:11], s26 offen sc1
    buffer_load_dwordx4 v[48:51], v3, s[8:11], s27 offen sc1
    buffer_load_dwordx4 v[52:55], v3, s[8:11], s28 offen sc1
    buffer_load_dwordx4 v[56:59], v3, s[8:11], s29 offen sc1
    s_sub_u32 s40, s40, 1
    s_cbranch_scc1 R_abort_01
    s_branch R_rs0_01
R_rsok_01:
    s_waitcnt lgkmcnt(2)
    s_barrier
    s_xor_b32 s21, s21, 1
    s_sleep 4
    buffer_load_dwordx4 v[80:83], v0, s[8:11], s32 offen sc1
    buffer_load_dword v84, v68, s[8:11], s33 offen sc1
    s_sleep 3
    buffer_load_dwordx4 v[52:55], v0, s[8:11], s32 offen sc1
    buffer_load_dword v56, v68, s[8:11], s33 offen sc1
    s_waitcnt vmcnt(3)
    ds_write_b128 v15, v[80:83] offset:0
    ds_read_b128 v[16:19], v1 offset:0
    s_waitcnt vmcnt(2)
    ds_write_b32 v13, v84 offset:0
    v_max3_u32 v14, v80, v81, v82
    v_max3_u32 v14, v14, v83, v84
    v_cmp_eq_u32 vcc, -1, v14
    s_cbranch_vccnz R_e_01
R_eput_01:
    buffer_load_dwordx4 v[88:91], v0, s[8:11], s34 offen sc1
    buffer_load_dword v92, v68, s[8:11], s35 offen sc1
R_top_01:
    s_waitcnt lgkmcnt(1)
    v_smfmac_f32_16x16x64_bf16 v[28:31], v[16:19], v[240:247], v7
    s_waitcnt lgkmcnt(0)
    s_barrier
    ds_read_b128 v[20:23], v1 offset:1024
    ds_read_b128 v[24:27], v1 offset:2048
    v_mov_b64 v[44:45], 0
    v_smfmac_f32_16x16x64_bf16 v[32:35], v[16:19], v[248:255], v7
    buffer_load_dwordx4 v[52:55], v6, s[8:11], s23 offen sc1
    v_mov_b64 v[46:47], 0
    v_smfmac_f32_16x16x64_bf16 v[36:39], v[16:19], a[0:7], v7
    buffer_load_dwordx4 v[56:59], v6, s[8:11], s23 offen offset:128 sc1
    v_mov_b64 v[48:49], 0
    v_smfmac_f32_16x16x64_bf16 v[40:43], v[16:19], v[60:67], v7
    s_waitcnt vmcnt(4)
    ds_read_b128 v[80:83], v2 offset:2048
    v_mov_b64 v[50:51], 0
    v_smfmac_f32_16x16x64_bf16 v[44:47], v[16:19], a[8:15], v7
    ds_read_b128 v[84:87], v2 offset:3072
    v_smfmac_f32_16x16x64_bf16 v[48:51], v[16:19], a[16:23], v7
    ds_read_b128 v[16:19], v1 offset:3072
    s_waitcnt lgkmcnt(4)
    v_smfmac_f32_16x16x64_bf16 v[28:31], v[20:23], a[24:31], v7
    ds_read_b128 v[60:63], v2 offset:4096
    v_smfmac_f32_16x16x64_bf16 v[32:35], v[20:23], a[32:39], v7
    ds_read_b128 v[64:67], v2 offset:5120
    v_smfmac_f32_16x16x64_bf16 v[36:39], v[20:23], a[40:47], v7
    s_waitcnt lgkmcnt(3)
    v_smfmac_f32_16x16x64_bf16 v[40:43], v[20:23], v[80:87], v7
    ds_read_b128 v[80:83], v2 offset:6144
    v_smfmac_f32_16x16x64_bf16 v[44:47], v[20:23], a[48:55], v7
    ds_read_b128 v[84:87], v2 offset:7168
    v_smfmac_f32_16x16x64_bf16 v[48:51], v[20:23], a[56:63], v7
    ds_read_b128 v[20:23], v1 offset:4096
    v_smfmac_f32_16x16x64_bf16 v[28:31], v[24:27], a[64:71], v7
    v_smfmac_f32_16x16x64_bf16 v[32:35], v[24:27], a[72:79], v7
    v_smfmac_f32_16x16x64_bf16 v[36:39], v[24:27], a[80:87], v7
    s_waitcnt lgkmcnt(3)
    v_smfmac_f32_16x16x64_bf16 v[40:43], v[24:27], v[60:67], v7
    ds_read_b128 v[60:63], v2 offset:8192
    v_smfmac_f32_16x16x64_bf16 v[44:47], v[24:27], a[88:95], v7
    ds_read_b128 v[64:67], v2 offset:9216
    v_smfmac_f32_16x16x64_bf16 v[48:51], v[24:27], a[96:103], v7
    v_smfmac_f32_16x16x64_bf16 v[28:31], v[16:19], a[104:111], v7
    s_waitcnt vmcnt(3)
    ds_write_b128 v15, v[88:91] offset:5120
    v_smfmac_f32_16x16x64_bf16 v[32:35], v[16:19], a[112:119], v7
    s_waitcnt vmcnt(2)
    ds_write_b32 v13, v92 offset:5120
    v_max3_u32 v14, v88, v89, v90
    v_smfmac_f32_16x16x64_bf16 v[36:39], v[16:19], a[120:127], v7
    v_max3_u32 v14, v14, v91, v92
    s_waitcnt lgkmcnt(5)
    v_smfmac_f32_16x16x64_bf16 v[40:43], v[16:19], v[80:87], v7
    ds_read_b128 v[80:83], v2 offset:10240
    v_cmp_eq_u32 vcc, -1, v14
    v_smfmac_f32_16x16x64_bf16 v[44:47], v[16:19], a[128:135], v7
    ds_read_b128 v[84:87], v2 offset:11264
    s_cbranch_vccnz R_slowl_01
R_contl_01:
    v_smfmac_f32_16x16x64_bf16 v[48:51], v[16:19], a[136:143], v7
    s_waitcnt lgkmcnt(2)
    s_barrier
    ds_read_b128 v[24:27], v1 offset:5120
    v_smfmac_f32_16x16x64_bf16 v[28:31], v[20:23], a[144:151], v7
    ds_read_b128 v[16:19], v1 offset:6144
    v_smfmac_f32_16x16x64_bf16 v[32:35], v[20:23], v[60:67], v7
    ds_read_b128 v[88:91], v2 offset:12288
    v_mov_b32 v14, -1
    v_smfmac_f32_16x16x64_bf16 v[36:39], v[20:23], a[152:159], v7
    ds_read_b128 v[92:95], v2 offset:13312
    s_add_u32 s64, s31, s38
    s_add_u32 s65, s31, s39
    buffer_store_dword v14, v4, s[8:11], s64 offen sc1
    buffer_store_dword v14, v4, s[8:11], s65 offen sc1
    v_smfmac_f32_16x16x64_bf16 v[40:43], v[20:23], a[160:167], v7
    ds_read_b128 v[60:63], v2 offset:14336
    s_waitcnt lgkmcnt(5)
    v_smfmac_f32_16x16x64_bf16 v[44:47], v[20:23], v[80:87], v7
    ds_read_b128 v[64:67], v2 offset:15360
    v_smfmac_f32_16x16x64_bf16 v[48:51], v[20:23], a[168:175], v7
    ds_read_b128 v[20:23], v1 offset:7168
    s_waitcnt lgkmcnt(3)
    v_smfmac_f32_16x16x64_bf16 v[28:31], v[24:27], v[88:95], v7
    ds_read_b128 v[80:83], v2 offset:16384
    v_smfmac_f32_16x16x64_bf16 v[32:35], v[24:27], a[176:183], v7
    ds_read_b128 v[84:87], v2 offset:17408
    v_smfmac_f32_16x16x64_bf16 v[36:39], v[24:27], a[184:191], v7
    ds_read_b128 v[88:91], v2 offset:18432
    s_waitcnt lgkmcnt(4)
    v_smfmac_f32_16x16x64_bf16 v[40:43], v[24:27], v[60:67], v7
    ds_read_b128 v[24:27], v1 offset:8192
    v_smfmac_f32_16x16x64_bf16 v[28:31], v[16:19], a[192:199], v7
    ds_read_b128 v[92:95], v2 offset:19456
    s_waitcnt lgkmcnt(3)
    v_smfmac_f32_16x16x64_bf16 v[32:35], v[16:19], v[80:87], v7
    ds_read_b128 v[60:63], v2 offset:20480
    v_smfmac_f32_16x16x64_bf16 v[36:39], v[16:19], a[200:207], v7
    ds_read_b128 v[64:67], v2 offset:21504
    v_smfmac_f32_16x16x64_bf16 v[40:43], v[16:19], a[208:215], v7
    ds_read_b128 v[16:19], v1 offset:9216
    s_waitcnt lgkmcnt(3)
    v_smfmac_f32_16x16x64_bf16 v[28:31], v[20:23], v[88:95], v7
    ds_read_b128 v[80:83], v2 offset:22528
    v_smfmac_f32_16x16x64_bf16 v[32:35], v[20:23], a[216:223], v7
    ds_read_b128 v[84:87], v2 offset:23552
    v_smfmac_f32_16x16x64_bf16 v[28:31], v[24:27], a[224:231], v7
    ds_read_b128 v[88:91], v2 offset:24576
    s_waitcnt lgkmcnt(4)
    v_smfmac_f32_16x16x64_bf16 v[32:35], v[24:27], v[60:67], v7
    ds_read_b128 v[92:95], v2 offset:25600
    v_cndmask_b32 v8, v9, v12, s[52:53]
    s_waitcnt lgkmcnt(4)
    v_smfmac_f32_16x16x64_bf16 v[28:31], v[16:19], a[232:239], v7
    v_cndmask_b32 v11, v9, v12, s[52:53]
    s_waitcnt lgkmcnt(2)
    v_smfmac_f32_16x16x64_bf16 v[32:35], v[16:19], v[80:87], v7
    ds_read_b128 v[80:83], v2 offset:26624
    v_add_u32 v14, s57, v0
    v_smfmac_f32_16x16x64_bf16 v[36:39], v[20:23], a[240:247], v7
    ds_read_b128 v[84:87], v2 offset:27648
    v_smfmac_f32_16x16x64_bf16 v[40:43], v[20:23], a[248:255], v7
    s_waitcnt lgkmcnt(2)
    v_smfmac_f32_16x16x64_bf16 v[36:39], v[24:27], v[88:95], v7
    ds_read_b128 v[88:91], v2 offset:28672
    v_smfmac_f32_16x16x64_bf16 v[40:43], v[24:27], v[96:103], v7
    ds_read_b128 v[92:95], v2 offset:29696
    v_add_f32 v28, v28, v30
    v_add_f32 v29, v29, v31
    v_smfmac_f32_16x16x64_bf16 v[36:39], v[16:19], v[104:111], v7
    v_cvt_pk_bf16_f32 v68, v28, v29
    v_add_f32 v32, v32, v34
    v_smfmac_f32_16x16x64_bf16 v[40:43], v[16:19], v[112:119], v7
    v_add_f32 v33, v33, v35
    v_cvt_pk_bf16_f32 v69, v32, v33
    s_waitcnt lgkmcnt(2)
    v_smfmac_f32_16x16x64_bf16 v[44:47], v[20:23], v[80:87], v7
    ds_read_b128 v[80:83], v2 offset:30720
    v_mfma_f32_16x16x16_bf16 v[28:31], v[68:69], v[8:9], 0
    ds_read_b128 v[84:87], v2 offset:31744
    v_mfma_f32_16x16x16_bf16 v[32:35], v[68:69], v[10:11], 0
    v_smfmac_f32_16x16x64_bf16 v[48:51], v[20:23], v[120:127], v7
    ds_read_b128 v[20:23], v1 offset:5120
    v_add_f32 v36, v36, v38
    v_add_f32 v37, v37, v39
    v_cvt_pk_bf16_f32 v70, v36, v37
    v_add_f32 v40, v40, v42
    v_add_f32 v41, v41, v43
    v_cvt_pk_bf16_f32 v71, v40, v41
    v_cvt_pk_bf16_f32 v60, v28, v29
    v_cvt_pk_bf16_f32 v61, v30, v31
    v_mfma_f32_16x16x16_bf16 v[36:39], v[70:71], v[8:9], 0
    v_cvt_pk_bf16_f32 v62, v32, v33
    v_cvt_pk_bf16_f32 v63, v34, v35
    v_mfma_f32_16x16x16_bf16 v[40:43], v[70:71], v[10:11], 0
    s_nop 0
    v_mfma_f32_16x16x32_bf16 v[28:31], v[72:75], v[60:63], 0
    v_mfma_f32_16x16x32_bf16 v[32:35], v[76:79], v[60:63], 0
    s_waitcnt lgkmcnt(3)
    v_smfmac_f32_16x16x64_bf16 v[44:47], v[24:27], v[88:95], v7
    ds_read_b128 v[88:91], v2 offset:32768
    v_cvt_pk_bf16_f32 v64, v36, v37
    v_cvt_pk_bf16_f32 v65, v38, v39
    v_cvt_pk_bf16_f32 v66, v40, v41
    v_cvt_pk_bf16_f32 v67, v42, v43
    s_nop 0
    v_cndmask_b32 v28, v28, v32, s[54:55]
    v_cndmask_b32 v29, v29, v33, s[54:55]
    v_mfma_f32_16x16x32_bf16 v[36:39], v[64:67], v[60:63], 0
    v_cndmask_b32 v30, v30, v34, s[54:55]
    v_cndmask_b32 v31, v31, v35, s[54:55]
    ds_write_b128 v15, v[28:31] offset:10240
    v_smfmac_f32_16x16x64_bf16 v[48:51], v[24:27], v[128:135], v7
    ds_read_b128 v[24:27], v1 offset:6144
    s_nop 2
    v_cndmask_b32 v36, v36, v37, s[54:55]
    ds_write_b32 v14, v36 offset:14336
    buffer_load_dwordx4 v[72:75], v6, s[8:11], s22 offen sc1
    buffer_load_dwordx4 v[76:79], v6, s[8:11], s22 offen offset:128 sc1
    s_waitcnt lgkmcnt(5)
    v_smfmac_f32_16x16x64_bf16 v[44:47], v[16:19], v[80:87], v7
    ds_read_b128 v[92:95], v2 offset:33792
    ds_read_b128 v[80:83], v2 offset:34816
    v_smfmac_f32_16x16x64_bf16 v[48:51], v[16:19], v[136:143], v7
    ds_read_b128 v[84:87], v2 offset:35840
    s_waitcnt lgkmcnt(3)
    s_barrier
    ds_read_b128 v[68:71], v0 offset:14336
    ds_read_b128 v[32:35], v0 offset:11264
    ds_read_b128 v[36:39], v0 offset:12288
    ds_read_b128 v[40:43], v0 offset:13312
    s_cmp_eq_u32 s20, 63
    s_waitcnt lgkmcnt(6)
    v_smfmac_f32_16x16x64_bf16 v[44:47], v[20:23], v[88:95], v7
    v_smfmac_f32_16x16x64_bf16 v[48:51], v[20:23], v[144:151], v7
    s_waitcnt lgkmcnt(4)
    v_smfmac_f32_16x16x64_bf16 v[44:47], v[24:27], v[80:87], v7
    v_mov_b64 v[88:89], s[98:99]
    v_smfmac_f32_16x16x64_bf16 v[48:51], v[24:27], v[152:159], v7
    v_mov_b64 v[90:91], s[98:99]
    s_cbranch_scc1 R_end_01
    s_waitcnt lgkmcnt(3)
    v_pk_add_f32 v[68:69], v[68:69], v[70:71]
    s_waitcnt lgkmcnt(2)
    v_pk_add_f32 v[28:29], v[28:29], v[32:33]
    v_pk_add_f32 v[30:31], v[30:31], v[34:35]
    v_add_f32 v68, v68, v69
    s_waitcnt lgkmcnt(0)
    v_pk_add_f32 v[36:37], v[36:37], v[40:41]
    v_pk_add_f32 v[38:39], v[38:39], v[42:43]
    v_pk_add_f32 v[28:29], v[28:29], v[36:37]
    v_pk_add_f32 v[30:31], v[30:31], v[38:39]
    v_max3_f32 v13, v28, v29, v68
    v_max3_f32 v13, v30, v31, v13
    v_add_f32 v44, v44, v46
    v_add_f32 v45, v45, v47
    v_max_f32_dpp v13, v13, v13 quad_perm:[2,3,0,1] row_mask:0xf bank_mask:0xf
    v_mov_b32 v14, v13
    v_add_f32 v48, v48, v50
    v_add_f32 v49, v49, v51
    v_permlane16_swap_b32 v13, v14
    v_max_f32 v13, v13, v14
    v_mov_b32 v14, v13
    v_cvt_pk_bf16_f32 v70, v44, v45
    v_cvt_pk_bf16_f32 v71, v48, v49
    v_permlane32_swap_b32 v13, v14
    v_max_f32 v13, v13, v14
    v_mul_f32 v13, s60, v13
    v_fma_f32 v68, s60, v68, -v13
    v_pk_fma_f32 v[28:29], v[28:29], s[60:61], v[12:13] op_sel:[0,0,1] op_sel_hi:[1,0,1] neg_lo:[0,0,1] neg_hi:[0,0,1]
    v_pk_fma_f32 v[30:31], v[30:31], s[60:61], v[12:13] op_sel:[0,0,1] op_sel_hi:[1,0,1] neg_lo:[0,0,1] neg_hi:[0,0,1]
    v_exp_f32 v68, v68
    v_exp_f32 v28, v28
    v_exp_f32 v29, v29
    v_exp_f32 v30, v30
    v_exp_f32 v31, v31
    v_mov_b32_dpp v14, v68 quad_perm:[2,3,0,1] row_mask:0xf bank_mask:0xf
    v_cvt_pk_bf16_f32 v60, v28, v29
    v_cvt_pk_bf16_f32 v61, v30, v31
    v_cvt_pk_bf16_f32 v8, v68, v14
    v_cvt_pk_bf16_f32 v11, v68, v14
    v_mov_b32_dpp v62, v60 quad_perm:[2,3,0,1] row_mask:0xf bank_mask:0xf
    v_mfma_f32_16x16x16_bf16 v[28:31], v[88:89], v[8:9], 0
    v_mov_b32_dpp v63, v61 quad_perm:[2,3,0,1] row_mask:0xf bank_mask:0xf
    v_mfma_f32_16x16x16_bf16 v[36:39], v[70:71], v[8:9], 0
    v_lshrrev_b32 v14, 2, v6
    v_add_u32 v14, s59, v14
    v_mfma_f32_16x16x16_bf16 v[40:43], v[70:71], v[10:11], 0
    v_lshrrev_b32 v68, 1, v0
    v_mfma_f32_16x16x32_bf16 v[28:31], v[88:91], v[60:63], v[28:31]
    v_bfi_b32 v68, 24, v0, v68
    s_waitcnt vmcnt(5)
    v_mfma_f32_16x16x32_bf16 v[36:39], v[52:55], v[60:63], v[36:39]
    v_add_u32 v68, s59, v68
    s_waitcnt vmcnt(4)
    v_mfma_f32_16x16x32_bf16 v[40:43], v[56:59], v[60:63], v[40:43]
    s_nop 1
    v_rcp_f32 v13, v28
    s_mov_b64 exec, s[42:43]
    s_nop 0
    v_pk_mul_f32 v[36:37], v[36:37], v[12:13] op_sel:[0,1] op_sel_hi:[1,1]
    v_pk_mul_f32 v[38:39], v[38:39], v[12:13] op_sel:[0,1] op_sel_hi:[1,1]
    v_cvt_pk_bf16_f32 v36, v36, v37
    v_cvt_pk_bf16_f32 v37, v38, v39
    ds_write_b64 v5, v[36:37] offset:0
    v_pk_mul_f32 v[40:41], v[40:41], v[12:13] op_sel:[0,1] op_sel_hi:[1,1]
    v_pk_mul_f32 v[42:43], v[42:43], v[12:13] op_sel:[0,1] op_sel_hi:[1,1]
    v_cvt_pk_bf16_f32 v40, v40, v41
    v_cvt_pk_bf16_f32 v41, v42, v43
    ds_write_b64 v5, v[40:41] offset:128
    s_mov_b64 exec, -1
    v_mfma_f32_32x32x8_bf16 v[44:59], v[8:9], v[10:11], 0
    v_mfma_f32_32x32x8_bf16 v[28:43], v[8:9], v[10:11], 0
    s_waitcnt lgkmcnt(0)
    s_barrier
    ds_read_b128 v[16:19], v1 offset:0
    ds_read_b128 v[20:23], v1 offset:1024
    ds_write_b32 v14, v70 offset:12288
    ds_write_b32 v14, v71 offset:12320
    s_nop 1
    s_waitcnt lgkmcnt(3)
    v_smfmac_f32_16x16x64_bf16 v[44:47], v[16:19], v[160:167], v7
    s_waitcnt lgkmcnt(2)
    v_smfmac_f32_16x16x64_bf16 v[44:47], v[20:23], v[168:175], v7
    v_smfmac_f32_16x16x64_bf16 v[48:51], v[16:19], v[176:183], v7
    v_smfmac_f32_16x16x64_bf16 v[48:51], v[20:23], v[184:191], v7
    v_smfmac_f32_16x16x64_bf16 v[52:55], v[16:19], v[192:199], v7
    v_smfmac_f32_16x16x64_bf16 v[52:55], v[20:23], v[200:207], v7
    s_nop 3
    v_add_f32 v44, v44, v46
    v_add_f32 v45, v45, v47
    v_smfmac_f32_16x16x64_bf16 v[56:59], v[16:19], v[208:215], v7
    v_cvt_pk_bf16_f32 v24, v44, v45
    v_bfi_b32 v24, 1, s21, v24
    v_smfmac_f32_16x16x64_bf16 v[56:59], v[20:23], v[216:223], v7
    v_add_f32 v48, v48, v50
    v_permlane32_swap_b32 v24, v26
    v_smfmac_f32_16x16x64_bf16 v[28:31], v[16:19], v[224:231], v7
    v_add_f32 v49, v49, v51
    v_permlane16_swap_b32 v24, v25
    v_smfmac_f32_16x16x64_bf16 v[28:31], v[20:23], v[232:239], v7
    v_permlane16_swap_b32 v26, v27
    s_mov_b64 exec, 0xffff
    buffer_store_dwordx4 v[24:27], v0, s[8:11], s25 offen sc1
    s_mov_b64 exec, -1
    v_cvt_pk_bf16_f32 v60, v48, v49
    v_bfi_b32 v60, 1, s21, v60
    v_add_f32 v52, v52, v54
    v_add_f32 v53, v53, v55
    v_cvt_pk_bf16_f32 v61, v52, v53
    v_add_f32 v56, v56, v58
    v_add_f32 v57, v57, v59
    v_cvt_pk_bf16_f32 v62, v56, v57
    v_bfi_b32 v62, 1, s21, v62
    v_add_f32 v28, v28, v30
    v_add_f32 v29, v29, v31
    v_cvt_pk_bf16_f32 v63, v28, v29
    buffer_store_dwordx4 v[60:63], v0, s[8:11], s24 offen sc1
    ds_write_b128 v68, v[64:67] offset:10240
    s_branch R_comm_01
R_e_01:
    buffer_load_dwordx4 v[80:83], v0, s[8:11], s32 offen sc1
    buffer_load_dword v84, v68, s[8:11], s33 offen sc1
    s_waitcnt vmcnt(3)
    ds_write_b128 v15, v[52:55] offset:0
    s_waitcnt lgkmcnt(2)
    ds_read_b128 v[16:19], v1 offset:0
    s_waitcnt vmcnt(2)
    ds_write_b32 v13, v56 offset:0
    v_max3_u32 v14, v52, v53, v54
    v_max3_u32 v14, v14, v55, v56
    v_cmp_eq_u32 vcc, -1, v14
    s_cbranch_vccz R_eput_01
    buffer_load_dwordx4 v[52:55], v0, s[8:11], s32 offen sc1
    buffer_load_dword v56, v68, s[8:11], s33 offen sc1
    s_waitcnt vmcnt(3)
    ds_write_b128 v15, v[80:83] offset:0
    s_waitcnt lgkmcnt(2)
    ds_read_b128 v[16:19], v1 offset:0
    s_waitcnt vmcnt(2)
    ds_write_b32 v13, v84 offset:0
    v_max3_u32 v14, v80, v81, v82
    v_max3_u32 v14, v14, v83, v84
    v_cmp_eq_u32 vcc, -1, v14
    s_cbranch_vccz R_eput_01
    s_sub_u32 s40, s40, 1
    s_cbranch_scc0 R_e_01
    s_branch R_abort_01
R_slowl_01:
    v_lshrrev_b32 v14, 2, v0
    buffer_load_dwordx4 v[88:91], v0, s[8:11], s34 offen sc1
    buffer_load_dword v92, v14, s[8:11], s35 offen sc1
    s_sub_u32 s40, s40, 1
    s_cbranch_scc1 R_abort_01
    s_waitcnt vmcnt(1)
    v_max3_u32 v14, v88, v89, v90
    s_waitcnt vmcnt(0)
    v_max3_u32 v14, v14, v91, v92
    v_cmp_eq_u32 vcc, -1, v14
    s_cbranch_vccnz R_slowl_01
    ds_write_b128 v15, v[88:91] offset:5120
    ds_write_b32 v13, v92 offset:5120
    s_waitcnt lgkmcnt(0)
    s_branch R_contl_01
R_end_01:
    s_waitcnt lgkmcnt(0)
    s_lshl_b32 s64, s3, 12
    s_add_u32 s64, s64, 96337920
    s_cmp_eq_u32 s5, 0
    s_cbranch_scc0 R_endv_01
    v_lshrrev_b32 v68, 1, v0
    v_bfi_b32 v68, 24, v0, v68
    v_add_u32 v68, s59, v68
    buffer_store_dwordx4 v[64:67], v68, s[8:11], s64 offen sc1
    s_branch R_endw_01
R_endv_01:
    v_lshrrev_b32 v14, 2, v6
    v_add_u32 v14, s59, v14
    s_nop 4
    v_add_f32 v44, v44, v46
    v_add_f32 v45, v45, v47
    v_cvt_pk_bf16_f32 v44, v44, v45
    buffer_store_dword v44, v14, s[8:11], s64 offen offset:2048 sc1
    v_add_f32 v48, v48, v50
    v_add_f32 v49, v49, v51
    v_cvt_pk_bf16_f32 v48, v48, v49
    buffer_store_dword v48, v14, s[8:11], s64 offen offset:2080 sc1
R_endw_01:
    s_waitcnt vmcnt(0)
    s_barrier
R_abort_01:
    s_waitcnt vmcnt(0) lgkmcnt(0)
    s_branch R_exit
.p2align 6
R_comm_11:
    v_mov_b64 v[28:29], 0
    v_mov_b64 v[30:31], 0
    v_cndmask_b32 v16, v9, v12, s[44:45]
    v_cndmask_b32 v17, v9, v12, s[46:47]
    v_cndmask_b32 v18, v9, v12, s[48:49]
    v_cndmask_b32 v19, v9, v12, s[50:51]
    s_add_u32 s20, s20, 1
    s_add_u32 s22, s22, 0x80000
    s_add_u32 s23, s23, 0x80000
    s_add_u32 s36, s30, s38
    s_add_u32 s37, s30, s39
    s_add_u32 s32, s36, s56
    s_add_u32 s33, s36, s58
    s_add_u32 s34, s30, s6
    s_add_u32 s35, s34, s58
    s_add_u32 s34, s34, s56
    s_mov_b32 s41, s63
    s_add_u32 s63, s63, 0x20000
    s_add_u32 s30, s30, 16384
    s_cmp_eq_u32 s30, 49152
    s_cselect_b32 s30, 0, s30
    s_add_u32 s31, s31, 16384
    s_cmp_eq_u32 s31, 49152
    s_cselect_b32 s31, 0, s31
    ds_read_b128 v[60:63], v2 offset:2048
    ds_read_b128 v[64:67], v2 offset:3072
    v_lshrrev_b32 v68, 2, v0
    v_bfe_u32 v14, v68, 5, 2
    v_lshlrev_b32 v13, 8, v14
    v_and_b32 v69, 0x9c, v68
    v_add_u32 v13, v13, v69
    v_and_b32 v69, 64, v68
    v_xor_b32 v69, s71, v69
    v_add_u32 v13, v13, v69
    s_cmp_ge_u32 s3, 8
    s_cbranch_scc1 R_nored_11
    buffer_load_dwordx4 v[80:83], v3, s[8:11], s26 offen sc1
    buffer_load_dwordx4 v[84:87], v3, s[8:11], s27 offen sc1
    buffer_load_dwordx4 v[88:91], v3, s[8:11], s28 offen sc1
    buffer_load_dwordx4 v[92:95], v3, s[8:11], s29 offen sc1
    s_sleep 3
    buffer_load_dwordx4 v[44:47], v3, s[8:11], s26 offen sc1
    buffer_load_dwordx4 v[48:51], v3, s[8:11], s27 offen sc1
    buffer_load_dwordx4 v[52:55], v3, s[8:11], s28 offen sc1
    buffer_load_dwordx4 v[56:59], v3, s[8:11], s29 offen sc1
    s_cmp_eq_u32 s21, 0
    s_cbranch_scc1 R_rs0_11
R_rs1_11:
    s_waitcnt vmcnt(7)
    v_mfma_f32_16x16x32_bf16 v[20:23], v[80:83], v[16:19], 0
    s_waitcnt vmcnt(6)
    v_mfma_f32_16x16x32_bf16 v[20:23], v[84:87], v[16:19], v[20:23]
    v_bitop3_b32 v14, v80, v82, v84 bitop3:0x80
    s_waitcnt vmcnt(5)
    v_mfma_f32_16x16x32_bf16 v[20:23], v[88:91], v[16:19], v[20:23]
    v_bitop3_b32 v14, v14, v86, v88 bitop3:0x80
    s_waitcnt vmcnt(4)
    v_mfma_f32_16x16x32_bf16 v[20:23], v[92:95], v[16:19], v[20:23]
    v_bitop3_b32 v14, v14, v90, v92 bitop3:0x80
    v_bitop3_b32 v14, v14, v14, v94 bitop3:0x80
    v_and_b32 v14, 1, v14
    v_cmp_ne_u32 vcc, 1, v14
    s_nop 3
    v_permlane32_swap_b32 v20, v22
    v_permlane32_swap_b32 v21, v23
    v_add_f32 v20, v20, v22
    v_add_f32 v21, v21, v23
    v_cvt_pk_bf16_f32 v20, v20, v21
    v_min_u32 v20, -2, v20
    s_cbranch_vccnz R_rf10_11
    buffer_store_dword v20, v4, s[8:11], s36 offen sc1
    buffer_store_dword v20, v4, s[8:11], s37 offen sc1
    s_branch R_rsok_11
R_rf10_11:
    buffer_load_dwordx4 v[80:83], v3, s[8:11], s26 offen sc1
    buffer_load_dwordx4 v[84:87], v3, s[8:11], s27 offen sc1
    buffer_load_dwordx4 v[88:91], v3, s[8:11], s28 offen sc1
    buffer_load_dwordx4 v[92:95], v3, s[8:11], s29 offen sc1
    s_waitcnt vmcnt(7)
    v_mfma_f32_16x16x32_bf16 v[20:23], v[44:47], v[16:19], 0
    s_waitcnt vmcnt(6)
    v_mfma_f32_16x16x32_bf16 v[20:23], v[48:51], v[16:19], v[20:23]
    v_bitop3_b32 v14, v44, v46, v48 bitop3:0x80
    s_waitcnt vmcnt(5)
    v_mfma_f32_16x16x32_bf16 v[20:23], v[52:55], v[16:19], v[20:23]
    v_bitop3_b32 v14, v14, v50, v52 bitop3:0x80
    s_waitcnt vmcnt(4)
    v_mfma_f32_16x16x32_bf16 v[20:23], v[56:59], v[16:19], v[20:23]
    v_bitop3_b32 v14, v14, v54, v56 bitop3:0x80
    v_bitop3_b32 v14, v14, v14, v58 bitop3:0x80
    v_and_b32 v14, 1, v14
    v_cmp_ne_u32 vcc, 1, v14
    s_nop 3
    v_permlane32_swap_b32 v20, v22
    v_permlane32_swap_b32 v21, v23
    v_add_f32 v20, v20, v22
    v_add_f32 v21, v21, v23
    v_cvt_pk_bf16_f32 v20, v20, v21
    v_min_u32 v20, -2, v20
    s_cbranch_vccnz R_rf11_11
    buffer_store_dword v20, v4, s[8:11], s36 offen sc1
    buffer_store_dword v20, v4, s[8:11], s37 offen sc1
    s_branch R_rsok_11
R_rf11_11:
    buffer_load_dwordx4 v[44:47], v3, s[8:11], s26 offen sc1
    buffer_load_dwordx4 v[48:51], v3, s[8:11], s27 offen sc1
    buffer_load_dwordx4 v[52:55], v3, s[8:11], s28 offen sc1
    buffer_load_dwordx4 v[56:59], v3, s[8:11], s29 offen sc1
    s_sub_u32 s40, s40, 1
    s_cbranch_scc1 R_abort_11
    s_branch R_rs1_11
R_rs0_11:
    s_waitcnt vmcnt(7)
    v_mfma_f32_16x16x32_bf16 v[20:23], v[80:83], v[16:19], 0
    s_waitcnt vmcnt(6)
    v_mfma_f32_16x16x32_bf16 v[20:23], v[84:87], v[16:19], v[20:23]
    v_or3_b32 v14, v80, v82, v84
    s_waitcnt vmcnt(5)
    v_mfma_f32_16x16x32_bf16 v[20:23], v[88:91], v[16:19], v[20:23]
    v_or3_b32 v14, v14, v86, v88
    s_waitcnt vmcnt(4)
    v_mfma_f32_16x16x32_bf16 v[20:23], v[92:95], v[16:19], v[20:23]
    v_or3_b32 v14, v14, v90, v92
    v_or3_b32 v14, v14, v14, v94
    v_and_b32 v14, 1, v14
    v_cmp_ne_u32 vcc, 0, v14
    s_nop 3
    v_permlane32_swap_b32 v20, v22
    v_permlane32_swap_b32 v21, v23
    v_add_f32 v20, v20, v22
    v_add_f32 v21, v21, v23
    v_cvt_pk_bf16_f32 v20, v20, v21
    v_min_u32 v20, -2, v20
    s_cbranch_vccnz R_rf00_11
    buffer_store_dword v20, v4, s[8:11], s36 offen sc1
    buffer_store_dword v20, v4, s[8:11], s37 offen sc1
    s_branch R_rsok_11
R_rf00_11:
    buffer_load_dwordx4 v[80:83], v3, s[8:11], s26 offen sc1
    buffer_load_dwordx4 v[84:87], v3, s[8:11], s27 offen sc1
    buffer_load_dwordx4 v[88:91], v3, s[8:11], s28 offen sc1
    buffer_load_dwordx4 v[92:95], v3, s[8:11], s29 offen sc1
    s_waitcnt vmcnt(7)
    v_mfma_f32_16x16x32_bf16 v[20:23], v[44:47], v[16:19], 0
    s_waitcnt vmcnt(6)
    v_mfma_f32_16x16x32_bf16 v[20:23], v[48:51], v[16:19], v[20:23]
    v_or3_b32 v14, v44, v46, v48
    s_waitcnt vmcnt(5)
    v_mfma_f32_16x16x32_bf16 v[20:23], v[52:55], v[16:19], v[20:23]
    v_or3_b32 v14, v14, v50, v52
    s_waitcnt vmcnt(4)
    v_mfma_f32_16x16x32_bf16 v[20:23], v[56:59], v[16:19], v[20:23]
    v_or3_b32 v14, v14, v54, v56
    v_or3_b32 v14, v14, v14, v58
    v_and_b32 v14, 1, v14
    v_cmp_ne_u32 vcc, 0, v14
    s_nop 3
    v_permlane32_swap_b32 v20, v22
    v_permlane32_swap_b32 v21, v23
    v_add_f32 v20, v20, v22
    v_add_f32 v21, v21, v23
    v_cvt_pk_bf16_f32 v20, v20, v21
    v_min_u32 v20, -2, v20
    s_cbranch_vccnz R_rf01_11
    buffer_store_dword v20, v4, s[8:11], s36 offen sc1
    buffer_store_dword v20, v4, s[8:11], s37 offen sc1
    s_branch R_rsok_11
R_rf01_11:
    buffer_load_dwordx4 v[44:47], v3, s[8:11], s26 offen sc1
    buffer_load_dwordx4 v[48:51], v3, s[8:11], s27 offen sc1
    buffer_load_dwordx4 v[52:55], v3, s[8:11], s28 offen sc1
    buffer_load_dwordx4 v[56:59], v3, s[8:11], s29 offen sc1
    s_sub_u32 s40, s40, 1
    s_cbranch_scc1 R_abort_11
    s_branch R_rs0_11
R_rsok_11:
R_nored_11:
    s_waitcnt lgkmcnt(2)
    s_barrier
    s_xor_b32 s21, s21, 1
    s_sleep 4
    buffer_load_dwordx4 v[80:83], v0, s[8:11], s32 offen sc1
    buffer_load_dword v84, v68, s[8:11], s33 offen sc1
    s_sleep 3
    buffer_load_dwordx4 v[52:55], v0, s[8:11], s32 offen sc1
    buffer_load_dword v56, v68, s[8:11], s33 offen sc1
    s_waitcnt vmcnt(3)
    ds_write_b128 v15, v[80:83] offset:0
    ds_read_b128 v[16:19], v1 offset:1024
    s_waitcnt vmcnt(2)
    ds_write_b32 v13, v84 offset:0
    v_max3_u32 v14, v80, v81, v82
    v_max3_u32 v14, v14, v83, v84
    v_cmp_eq_u32 vcc, -1, v14
    s_cbranch_vccnz R_e_11
R_eput_11:
    buffer_load_dwordx4 v[88:91], v0, s[8:11], s34 offen sc1
    buffer_load_dword v92, v68, s[8:11], s35 offen sc1
R_top_11:
    s_waitcnt lgkmcnt(1)
    v_smfmac_f32_16x16x64_bf16 v[28:31], v[16:19], a[24:31], v7
    s_waitcnt lgkmcnt(0)
    s_barrier
    ds_read_b128 v[20:23], v1 offset:2048
    ds_read_b128 v[24:27], v1 offset:3072
    v_mov_b64 v[44:45], 0
    v_smfmac_f32_16x16x64_bf16 v[32:35], v[16:19], a[32:39], v7
    buffer_load_dwordx4 v[52:55], v6, s[8:11], s23 offen sc1
    v_mov_b64 v[46:47], 0
    v_smfmac_f32_16x16x64_bf16 v[36:39], v[16:19], a[40:47], v7
    buffer_load_dwordx4 v[56:59], v6, s[8:11], s23 offen offset:128 sc1
    v_mov_b64 v[48:49], 0
    v_smfmac_f32_16x16x64_bf16 v[40:43], v[16:19], v[60:67], v7
    s_waitcnt vmcnt(4)
    ds_read_b128 v[80:83], v2 offset:4096
    v_mov_b64 v[50:51], 0
    v_smfmac_f32_16x16x64_bf16 v[44:47], v[16:19], a[48:55], v7
    ds_read_b128 v[84:87], v2 offset:5120
    v_smfmac_f32_16x16x64_bf16 v[48:51], v[16:19], a[56:63], v7
    ds_read_b128 v[16:19], v1 offset:0
    s_waitcnt lgkmcnt(4)
    v_smfmac_f32_16x16x64_bf16 v[28:31], v[20:23], a[64:71], v7
    ds_read_b128 v[60:63], v2 offset:6144
    v_smfmac_f32_16x16x64_bf16 v[32:35], v[20:23], a[72:79], v7
    ds_read_b128 v[64:67], v2 offset:7168
    v_smfmac_f32_16x16x64_bf16 v[36:39], v[20:23], a[80:87], v7
    s_waitcnt lgkmcnt(3)
    v_smfmac_f32_16x16x64_bf16 v[40:43], v[20:23], v[80:87], v7
    ds_read_b128 v[80:83], v2 offset:0
    v_smfmac_f32_16x16x64_bf16 v[44:47], v[20:23], a[88:95], v7
    ds_read_b128 v[84:87], v2 offset:1024
    v_smfmac_f32_16x16x64_bf16 v[48:51], v[20:23], a[96:103], v7
    ds_read_b128 v[20:23], v1 offset:4096
    v_smfmac_f32_16x16x64_bf16 v[28:31], v[24:27], a[104:111], v7
    v_smfmac_f32_16x16x64_bf16 v[32:35], v[24:27], a[112:119], v7
    v_smfmac_f32_16x16x64_bf16 v[36:39], v[24:27], a[120:127], v7
    s_waitcnt lgkmcnt(3)
    v_smfmac_f32_16x16x64_bf16 v[40:43], v[24:27], v[60:67], v7
    ds_read_b128 v[60:63], v2 offset:8192
    v_smfmac_f32_16x16x64_bf16 v[44:47], v[24:27], a[128:135], v7
    ds_read_b128 v[64:67], v2 offset:9216
    v_smfmac_f32_16x16x64_bf16 v[48:51], v[24:27], a[136:143], v7
    v_smfmac_f32_16x16x64_bf16 v[28:31], v[16:19], v[240:247], v7
    s_waitcnt vmcnt(3)
    ds_write_b128 v15, v[88:91] offset:5120
    v_smfmac_f32_16x16x64_bf16 v[32:35], v[16:19], v[248:255], v7
    s_waitcnt vmcnt(2)
    ds_write_b32 v13, v92 offset:5120
    v_max3_u32 v14, v88, v89, v90
    v_smfmac_f32_16x16x64_bf16 v[36:39], v[16:19], a[0:7], v7
    v_max3_u32 v14, v14, v91, v92
    s_waitcnt lgkmcnt(5)
    v_smfmac_f32_16x16x64_bf16 v[40:43], v[16:19], v[80:87], v7
    ds_read_b128 v[80:83], v2 offset:10240
    v_cmp_eq_u32 vcc, -1, v14
    v_smfmac_f32_16x16x64_bf16 v[44:47], v[16:19], a[8:15], v7
    ds_read_b128 v[84:87], v2 offset:11264
    s_cbranch_vccnz R_slowl_11
R_contl_11:
    v_smfmac_f32_16x16x64_bf16 v[48:51], v[16:19], a[16:23], v7
    s_waitcnt lgkmcnt(2)
    s_barrier
    ds_read_b128 v[24:27], v1 offset:5120
    v_smfmac_f32_16x16x64_bf16 v[28:31], v[20:23], a[144:151], v7
    ds_read_b128 v[16:19], v1 offset:6144
    v_smfmac_f32_16x16x64_bf16 v[32:35], v[20:23], v[60:67], v7
    ds_read_b128 v[88:91], v2 offset:12288
    v_mov_b32 v14, -1
    v_smfmac_f32_16x16x64_bf16 v[36:39], v[20:23], a[152:159], v7
    ds_read_b128 v[92:95], v2 offset:13312
    s_add_u32 s64, s31, s38
    s_add_u32 s65, s31, s39
    buffer_store_dword v14, v4, s[8:11], s64 offen sc1
    buffer_store_dword v14, v4, s[8:11], s65 offen sc1
    v_smfmac_f32_16x16x64_bf16 v[40:43], v[20:23], a[160:167], v7
    ds_read_b128 v[60:63], v2 offset:14336
    s_waitcnt lgkmcnt(5)
    v_smfmac_f32_16x16x64_bf16 v[44:47], v[20:23], v[80:87], v7
    ds_read_b128 v[64:67], v2 offset:15360
    v_smfmac_f32_16x16x64_bf16 v[48:51], v[20:23], a[168:175], v7
    ds_read_b128 v[20:23], v1 offset:7168
    s_waitcnt lgkmcnt(3)
    v_smfmac_f32_16x16x64_bf16 v[28:31], v[24:27], v[88:95], v7
    ds_read_b128 v[80:83], v2 offset:16384
    v_smfmac_f32_16x16x64_bf16 v[32:35], v[24:27], a[176:183], v7
    ds_read_b128 v[84:87], v2 offset:17408
    v_smfmac_f32_16x16x64_bf16 v[36:39], v[24:27], a[184:191], v7
    ds_read_b128 v[88:91], v2 offset:18432
    s_waitcnt lgkmcnt(4)
    v_smfmac_f32_16x16x64_bf16 v[40:43], v[24:27], v[60:67], v7
    ds_read_b128 v[24:27], v1 offset:8192
    v_smfmac_f32_16x16x64_bf16 v[28:31], v[16:19], a[192:199], v7
    ds_read_b128 v[92:95], v2 offset:19456
    s_waitcnt lgkmcnt(3)
    v_smfmac_f32_16x16x64_bf16 v[32:35], v[16:19], v[80:87], v7
    ds_read_b128 v[60:63], v2 offset:20480
    v_smfmac_f32_16x16x64_bf16 v[36:39], v[16:19], a[200:207], v7
    ds_read_b128 v[64:67], v2 offset:21504
    v_smfmac_f32_16x16x64_bf16 v[40:43], v[16:19], a[208:215], v7
    ds_read_b128 v[16:19], v1 offset:9216
    s_waitcnt lgkmcnt(3)
    v_smfmac_f32_16x16x64_bf16 v[28:31], v[20:23], v[88:95], v7
    ds_read_b128 v[80:83], v2 offset:22528
    v_smfmac_f32_16x16x64_bf16 v[32:35], v[20:23], a[216:223], v7
    ds_read_b128 v[84:87], v2 offset:23552
    v_smfmac_f32_16x16x64_bf16 v[28:31], v[24:27], a[224:231], v7
    ds_read_b128 v[88:91], v2 offset:24576
    s_waitcnt lgkmcnt(4)
    v_smfmac_f32_16x16x64_bf16 v[32:35], v[24:27], v[60:67], v7
    ds_read_b128 v[92:95], v2 offset:25600
    v_cndmask_b32 v8, v9, v12, s[52:53]
    s_waitcnt lgkmcnt(4)
    v_smfmac_f32_16x16x64_bf16 v[28:31], v[16:19], a[232:239], v7
    v_cndmask_b32 v11, v9, v12, s[52:53]
    s_waitcnt lgkmcnt(2)
    v_smfmac_f32_16x16x64_bf16 v[32:35], v[16:19], v[80:87], v7
    ds_read_b128 v[80:83], v2 offset:26624
    v_add_u32 v14, s57, v0
    v_smfmac_f32_16x16x64_bf16 v[36:39], v[20:23], a[240:247], v7
    ds_read_b128 v[84:87], v2 offset:27648
    v_smfmac_f32_16x16x64_bf16 v[40:43], v[20:23], a[248:255], v7
    s_waitcnt lgkmcnt(2)
    v_smfmac_f32_16x16x64_bf16 v[36:39], v[24:27], v[88:95], v7
    ds_read_b128 v[88:91], v2 offset:28672
    v_smfmac_f32_16x16x64_bf16 v[40:43], v[24:27], v[96:103], v7
    ds_read_b128 v[92:95], v2 offset:29696
    v_add_f32 v28, v28, v30
    v_add_f32 v29, v29, v31
    v_smfmac_f32_16x16x64_bf16 v[36:39], v[16:19], v[104:111], v7
    v_cvt_pk_bf16_f32 v68, v28, v29
    v_add_f32 v32, v32, v34
    v_smfmac_f32_16x16x64_bf16 v[40:43], v[16:19], v[112:119], v7
    v_add_f32 v33, v33, v35
    v_cvt_pk_bf16_f32 v69, v32, v33
    s_waitcnt lgkmcnt(2)
    v_smfmac_f32_16x16x64_bf16 v[44:47], v[20:23], v[80:87], v7
    ds_read_b128 v[80:83], v2 offset:30720
    v_mfma_f32_16x16x16_bf16 v[28:31], v[68:69], v[8:9], 0
    ds_read_b128 v[84:87], v2 offset:31744
    v_mfma_f32_16x16x16_bf16 v[32:35], v[68:69], v[10:11], 0
    v_smfmac_f32_16x16x64_bf16 v[48:51], v[20:23], v[120:127], v7
    ds_read_b128 v[20:23], v1 offset:5120
    v_add_f32 v36, v36, v38
    v_add_f32 v37, v37, v39
    v_cvt_pk_bf16_f32 v70, v36, v37
    v_add_f32 v40, v40, v42
    v_add_f32 v41, v41, v43
    v_cvt_pk_bf16_f32 v71, v40, v41
    v_cvt_pk_bf16_f32 v60, v28, v29
    v_cvt_pk_bf16_f32 v61, v30, v31
    v_mfma_f32_16x16x16_bf16 v[36:39], v[70:71], v[8:9], 0
    v_cvt_pk_bf16_f32 v62, v32, v33
    v_cvt_pk_bf16_f32 v63, v34, v35
    v_mfma_f32_16x16x16_bf16 v[40:43], v[70:71], v[10:11], 0
    s_nop 0
    v_mfma_f32_16x16x32_bf16 v[28:31], v[72:75], v[60:63], 0
    v_mfma_f32_16x16x32_bf16 v[32:35], v[76:79], v[60:63], 0
    s_waitcnt lgkmcnt(3)
    v_smfmac_f32_16x16x64_bf16 v[44:47], v[24:27], v[88:95], v7
    ds_read_b128 v[88:91], v2 offset:32768
    v_cvt_pk_bf16_f32 v64, v36, v37
    v_cvt_pk_bf16_f32 v65, v38, v39
    v_cvt_pk_bf16_f32 v66, v40, v41
    v_cvt_pk_bf16_f32 v67, v42, v43
    s_nop 0
    v_cndmask_b32 v28, v28, v32, s[54:55]
    v_cndmask_b32 v29, v29, v33, s[54:55]
    v_mfma_f32_16x16x32_bf16 v[36:39], v[64:67], v[60:63], 0
    v_cndmask_b32 v30, v30, v34, s[54:55]
    v_cndmask_b32 v31, v31, v35, s[54:55]
    ds_write_b128 v15, v[28:31] offset:10240
    v_smfmac_f32_16x16x64_bf16 v[48:51], v[24:27], v[128:135], v7
    ds_read_b128 v[24:27], v1 offset:6144
    s_nop 2
    v_cndmask_b32 v36, v36, v37, s[54:55]
    ds_write_b32 v14, v36 offset:14336
    buffer_load_dwordx4 v[72:75], v6, s[8:11], s22 offen sc1
    buffer_load_dwordx4 v[76:79], v6, s[8:11], s22 offen offset:128 sc1
    s_waitcnt lgkmcnt(5)
    v_smfmac_f32_16x16x64_bf16 v[44:47], v[16:19], v[80:87], v7
    ds_read_b128 v[92:95], v2 offset:33792
    ds_read_b128 v[80:83], v2 offset:34816
    v_smfmac_f32_16x16x64_bf16 v[48:51], v[16:19], v[136:143], v7
    ds_read_b128 v[84:87], v2 offset:35840
    s_waitcnt lgkmcnt(3)
    s_barrier
    ds_read_b128 v[68:71], v0 offset:14336
    ds_read_b128 v[32:35], v0 offset:12288
    ds_read_b128 v[36:39], v0 offset:13312
    ds_read_b128 v[40:43], v0 offset:10240
    s_cmp_eq_u32 s20, 63
    s_waitcnt lgkmcnt(6)
    v_smfmac_f32_16x16x64_bf16 v[44:47], v[20:23], v[88:95], v7
    v_smfmac_f32_16x16x64_bf16 v[48:51], v[20:23], v[144:151], v7
    s_waitcnt lgkmcnt(4)
    v_smfmac_f32_16x16x64_bf16 v[44:47], v[24:27], v[80:87], v7
    v_mov_b64 v[88:89], s[98:99]
    v_smfmac_f32_16x16x64_bf16 v[48:51], v[24:27], v[152:159], v7
    v_mov_b64 v[90:91], s[98:99]
    s_cbranch_scc1 R_end_11
    s_waitcnt lgkmcnt(3)
    v_pk_add_f32 v[68:69], v[68:69], v[70:71]
    s_waitcnt lgkmcnt(2)
    v_pk_add_f32 v[28:29], v[28:29], v[32:33]
    v_pk_add_f32 v[30:31], v[30:31], v[34:35]
    v_add_f32 v68, v68, v69
    s_waitcnt lgkmcnt(0)
    v_pk_add_f32 v[36:37], v[36:37], v[40:41]
    v_pk_add_f32 v[38:39], v[38:39], v[42:43]
    v_pk_add_f32 v[28:29], v[28:29], v[36:37]
    v_pk_add_f32 v[30:31], v[30:31], v[38:39]
    v_max3_f32 v13, v28, v29, v68
    v_max3_f32 v13, v30, v31, v13
    v_add_f32 v44, v44, v46
    v_add_f32 v45, v45, v47
    v_max_f32_dpp v13, v13, v13 quad_perm:[2,3,0,1] row_mask:0xf bank_mask:0xf
    v_mov_b32 v14, v13
    v_add_f32 v48, v48, v50
    v_add_f32 v49, v49, v51
    v_permlane16_swap_b32 v13, v14
    v_max_f32 v13, v13, v14
    v_mov_b32 v14, v13
    v_cvt_pk_bf16_f32 v70, v44, v45
    v_cvt_pk_bf16_f32 v71, v48, v49
    v_permlane32_swap_b32 v13, v14
    v_max_f32 v13, v13, v14
    v_mul_f32 v13, s60, v13
    v_fma_f32 v68, s60, v68, -v13
    v_pk_fma_f32 v[28:29], v[28:29], s[60:61], v[12:13] op_sel:[0,0,1] op_sel_hi:[1,0,1] neg_lo:[0,0,1] neg_hi:[0,0,1]
    v_pk_fma_f32 v[30:31], v[30:31], s[60:61], v[12:13] op_sel:[0,0,1] op_sel_hi:[1,0,1] neg_lo:[0,0,1] neg_hi:[0,0,1]
    v_exp_f32 v68, v68
    v_exp_f32 v28, v28
    v_exp_f32 v29, v29
    v_exp_f32 v30, v30
    v_exp_f32 v31, v31
    v_mov_b32_dpp v14, v68 quad_perm:[2,3,0,1] row_mask:0xf bank_mask:0xf
    v_cvt_pk_bf16_f32 v60, v28, v29
    v_cvt_pk_bf16_f32 v61, v30, v31
    v_cvt_pk_bf16_f32 v8, v68, v14
    v_cvt_pk_bf16_f32 v11, v68, v14
    v_mov_b32_dpp v62, v60 quad_perm:[2,3,0,1] row_mask:0xf bank_mask:0xf
    v_mfma_f32_16x16x16_bf16 v[28:31], v[88:89], v[8:9], 0
    v_mov_b32_dpp v63, v61 quad_perm:[2,3,0,1] row_mask:0xf bank_mask:0xf
    v_mfma_f32_16x16x16_bf16 v[36:39], v[70:71], v[8:9], 0
    v_lshrrev_b32 v14, 2, v6
    v_add_u32 v14, s59, v14
    v_mfma_f32_16x16x16_bf16 v[40:43], v[70:71], v[10:11], 0
    v_lshrrev_b32 v68, 1, v0
    v_mfma_f32_16x16x32_bf16 v[28:31], v[88:91], v[60:63], v[28:31]
    v_bfi_b32 v68, 24, v0, v68
    s_waitcnt vmcnt(5)
    v_mfma_f32_16x16x32_bf16 v[36:39], v[52:55], v[60:63], v[36:39]
    v_add_u32 v68, s59, v68
    s_waitcnt vmcnt(4)
    v_mfma_f32_16x16x32_bf16 v[40:43], v[56:59], v[60:63], v[40:43]
    s_nop 1
    v_rcp_f32 v13, v28
    s_mov_b64 exec, s[42:43]
    s_nop 0
    v_pk_mul_f32 v[36:37], v[36:37], v[12:13] op_sel:[0,1] op_sel_hi:[1,1]
    v_pk_mul_f32 v[38:39], v[38:39], v[12:13] op_sel:[0,1] op_sel_hi:[1,1]
    v_cvt_pk_bf16_f32 v36, v36, v37
    v_cvt_pk_bf16_f32 v37, v38, v39
    ds_write_b64 v5, v[36:37] offset:0
    v_pk_mul_f32 v[40:41], v[40:41], v[12:13] op_sel:[0,1] op_sel_hi:[1,1]
    v_pk_mul_f32 v[42:43], v[42:43], v[12:13] op_sel:[0,1] op_sel_hi:[1,1]
    v_cvt_pk_bf16_f32 v40, v40, v41
    v_cvt_pk_bf16_f32 v41, v42, v43
    ds_write_b64 v5, v[40:41] offset:128
    s_mov_b64 exec, -1
    v_mfma_f32_32x32x8_bf16 v[44:59], v[8:9], v[10:11], 0
    v_mfma_f32_32x32x8_bf16 v[28:43], v[8:9], v[10:11], 0
    s_waitcnt lgkmcnt(0)
    s_barrier
    ds_read_b128 v[16:19], v1 offset:0
    ds_read_b128 v[20:23], v1 offset:1024
    ds_write_b32 v14, v70 offset:12288
    ds_write_b32 v14, v71 offset:12320
    s_nop 1
    s_waitcnt lgkmcnt(3)
    v_smfmac_f32_16x16x64_bf16 v[44:47], v[16:19], v[160:167], v7
    s_waitcnt lgkmcnt(2)
    v_smfmac_f32_16x16x64_bf16 v[44:47], v[20:23], v[168:175], v7
    v_smfmac_f32_16x16x64_bf16 v[48:51], v[16:19], v[176:183], v7
    v_smfmac_f32_16x16x64_bf16 v[48:51], v[20:23], v[184:191], v7
    v_smfmac_f32_16x16x64_bf16 v[52:55], v[16:19], v[192:199], v7
    v_smfmac_f32_16x16x64_bf16 v[52:55], v[20:23], v[200:207], v7
    s_nop 3
    v_add_f32 v44, v44, v46
    v_add_f32 v45, v45, v47
    v_smfmac_f32_16x16x64_bf16 v[56:59], v[16:19], v[208:215], v7
    v_cvt_pk_bf16_f32 v24, v44, v45
    v_bfi_b32 v24, 1, s21, v24
    v_smfmac_f32_16x16x64_bf16 v[56:59], v[20:23], v[216:223], v7
    v_add_f32 v48, v48, v50
    v_permlane32_swap_b32 v24, v26
    v_smfmac_f32_16x16x64_bf16 v[28:31], v[16:19], v[224:231], v7
    v_add_f32 v49, v49, v51
    v_permlane16_swap_b32 v24, v25
    v_smfmac_f32_16x16x64_bf16 v[28:31], v[20:23], v[232:239], v7
    v_permlane16_swap_b32 v26, v27
    s_mov_b64 exec, 0xffff
    buffer_store_dwordx4 v[24:27], v0, s[8:11], s25 offen sc1
    s_mov_b64 exec, -1
    v_cvt_pk_bf16_f32 v60, v48, v49
    v_bfi_b32 v60, 1, s21, v60
    v_add_f32 v52, v52, v54
    v_add_f32 v53, v53, v55
    v_cvt_pk_bf16_f32 v61, v52, v53
    v_add_f32 v56, v56, v58
    v_add_f32 v57, v57, v59
    v_cvt_pk_bf16_f32 v62, v56, v57
    v_bfi_b32 v62, 1, s21, v62
    v_add_f32 v28, v28, v30
    v_add_f32 v29, v29, v31
    v_cvt_pk_bf16_f32 v63, v28, v29
    buffer_store_dwordx4 v[60:63], v0, s[8:11], s24 offen sc1
    ds_write_b128 v68, v[64:67] offset:10240
    s_branch R_comm_11
R_e_11:
    buffer_load_dwordx4 v[80:83], v0, s[8:11], s32 offen sc1
    buffer_load_dword v84, v68, s[8:11], s33 offen sc1
    s_waitcnt vmcnt(3)
    ds_write_b128 v15, v[52:55] offset:0
    s_waitcnt lgkmcnt(2)
    ds_read_b128 v[16:19], v1 offset:1024
    s_waitcnt vmcnt(2)
    ds_write_b32 v13, v56 offset:0
    v_max3_u32 v14, v52, v53, v54
    v_max3_u32 v14, v14, v55, v56
    v_cmp_eq_u32 vcc, -1, v14
    s_cbranch_vccz R_eput_11
    buffer_load_dwordx4 v[52:55], v0, s[8:11], s32 offen sc1
    buffer_load_dword v56, v68, s[8:11], s33 offen sc1
    s_waitcnt vmcnt(3)
    ds_write_b128 v15, v[80:83] offset:0
    s_waitcnt lgkmcnt(2)
    ds_read_b128 v[16:19], v1 offset:1024
    s_waitcnt vmcnt(2)
    ds_write_b32 v13, v84 offset:0
    v_max3_u32 v14, v80, v81, v82
    v_max3_u32 v14, v14, v83, v84
    v_cmp_eq_u32 vcc, -1, v14
    s_cbranch_vccz R_eput_11
    s_sub_u32 s40, s40, 1
    s_cbranch_scc0 R_e_11
    s_branch R_abort_11
R_slowl_11:
    v_lshrrev_b32 v14, 2, v0
    buffer_load_dwordx4 v[88:91], v0, s[8:11], s34 offen sc1
    buffer_load_dword v92, v14, s[8:11], s35 offen sc1
    s_sub_u32 s40, s40, 1
    s_cbranch_scc1 R_abort_11
    s_waitcnt vmcnt(1)
    v_max3_u32 v14, v88, v89, v90
    s_waitcnt vmcnt(0)
    v_max3_u32 v14, v14, v91, v92
    v_cmp_eq_u32 vcc, -1, v14
    s_cbranch_vccnz R_slowl_11
    ds_write_b128 v15, v[88:91] offset:5120
    ds_write_b32 v13, v92 offset:5120
    s_waitcnt lgkmcnt(0)
    s_branch R_contl_11
R_end_11:
    s_waitcnt lgkmcnt(0)
    s_lshl_b32 s64, s3, 12
    s_add_u32 s64, s64, 96337920
    s_cmp_eq_u32 s5, 0
    s_cbranch_scc0 R_endv_11
    v_lshrrev_b32 v68, 1, v0
    v_bfi_b32 v68, 24, v0, v68
    v_add_u32 v68, s59, v68
    buffer_store_dwordx4 v[64:67], v68, s[8:11], s64 offen sc1
    s_branch R_endw_11
R_endv_11:
    v_lshrrev_b32 v14, 2, v6
    v_add_u32 v14, s59, v14
    s_nop 4
    v_add_f32 v44, v44, v46
    v_add_f32 v45, v45, v47
    v_cvt_pk_bf16_f32 v44, v44, v45
    buffer_store_dword v44, v14, s[8:11], s64 offen offset:2048 sc1
    v_add_f32 v48, v48, v50
    v_add_f32 v49, v49, v51
    v_cvt_pk_bf16_f32 v48, v48, v49
    buffer_store_dword v48, v14, s[8:11], s64 offen offset:2080 sc1
R_endw_11:
    s_waitcnt vmcnt(0)
    s_barrier
R_abort_11:
    s_waitcnt vmcnt(0) lgkmcnt(0)
    s_branch R_exit
.p2align 6
R_comm_21:
    v_mfma_f32_32x32x8_bf16 v[44:59], v[8:9], v[10:11], 0
    v_mov_b64 v[28:29], 0
    v_mov_b64 v[30:31], 0
    s_add_u32 s20, s20, 1
    s_add_u32 s22, s22, 0x80000
    s_add_u32 s23, s23, 0x80000
    s_add_u32 s36, s30, s38
    s_add_u32 s37, s30, s39
    s_add_u32 s32, s36, s56
    s_add_u32 s33, s36, s58
    s_add_u32 s34, s30, s6
    s_add_u32 s35, s34, s58
    s_add_u32 s34, s34, s56
    s_mov_b32 s41, s63
    s_add_u32 s63, s63, 0x20000
    s_add_u32 s30, s30, 16384
    s_cmp_eq_u32 s30, 49152
    s_cselect_b32 s30, 0, s30
    s_add_u32 s31, s31, 16384
    s_cmp_eq_u32 s31, 49152
    s_cselect_b32 s31, 0, s31
    ds_read_b128 v[60:63], v2 offset:4096
    ds_read_b128 v[64:67], v2 offset:5120
    v_lshrrev_b32 v68, 2, v0
    v_bfe_u32 v14, v68, 5, 2
    v_lshlrev_b32 v13, 8, v14
    v_and_b32 v69, 0x9c, v68
    v_add_u32 v13, v13, v69
    v_and_b32 v69, 64, v68
    v_xor_b32 v69, s71, v69
    v_add_u32 v13, v13, v69
    s_waitcnt lgkmcnt(2)
    s_barrier
    s_xor_b32 s21, s21, 1
    s_sleep 4
    buffer_load_dwordx4 v[80:83], v0, s[8:11], s32 offen sc1
    buffer_load_dword v84, v68, s[8:11], s33 offen sc1
    s_sleep 3
    buffer_load_dwordx4 v[52:55], v0, s[8:11], s32 offen sc1
    buffer_load_dword v56, v68, s[8:11], s33 offen sc1
    s_waitcnt vmcnt(3)
    ds_write_b128 v15, v[80:83] offset:0
    ds_read_b128 v[16:19], v1 offset:2048
    s_waitcnt vmcnt(2)
    ds_write_b32 v13, v84 offset:0
    v_max3_u32 v14, v80, v81, v82
    v_max3_u32 v14, v14, v83, v84
    v_cmp_eq_u32 vcc, -1, v14
    s_cbranch_vccnz R_e_21
R_eput_21:
    buffer_load_dwordx4 v[88:91], v0, s[8:11], s34 offen sc1
    buffer_load_dword v92, v68, s[8:11], s35 offen sc1
R_top_21:
    s_waitcnt lgkmcnt(1)
    v_smfmac_f32_16x16x64_bf16 v[28:31], v[16:19], a[64:71], v7
    s_waitcnt lgkmcnt(0)
    s_barrier
    ds_read_b128 v[20:23], v1 offset:3072
    ds_read_b128 v[24:27], v1 offset:0
    v_smfmac_f32_16x16x64_bf16 v[32:35], v[16:19], a[72:79], v7
    buffer_load_dwordx4 v[52:55], v6, s[8:11], s23 offen sc1
    v_add_u32 v14, s62, v0
    v_smfmac_f32_16x16x64_bf16 v[36:39], v[16:19], a[80:87], v7
    buffer_load_dwordx4 v[56:59], v6, s[8:11], s23 offen offset:128 sc1
    v_smfmac_f32_16x16x64_bf16 v[40:43], v[16:19], v[60:67], v7
    s_waitcnt vmcnt(4)
    ds_read_b128 v[80:83], v2 offset:6144
    v_smfmac_f32_16x16x64_bf16 v[44:47], v[16:19], a[88:95], v7
    ds_read_b128 v[84:87], v2 offset:7168
    v_smfmac_f32_16x16x64_bf16 v[48:51], v[16:19], a[96:103], v7
    ds_read_b128 v[16:19], v1 offset:1024
    s_waitcnt lgkmcnt(4)
    v_smfmac_f32_16x16x64_bf16 v[28:31], v[20:23], a[104:111], v7
    ds_read_b128 v[60:63], v2 offset:0
    v_smfmac_f32_16x16x64_bf16 v[32:35], v[20:23], a[112:119], v7
    ds_read_b128 v[64:67], v2 offset:1024
    v_smfmac_f32_16x16x64_bf16 v[36:39], v[20:23], a[120:127], v7
    ds_read_b128 v[68:71], v14 offset:10240
    s_waitcnt lgkmcnt(4)
    v_smfmac_f32_16x16x64_bf16 v[40:43], v[20:23], v[80:87], v7
    ds_read_b128 v[80:83], v2 offset:2048
    v_smfmac_f32_16x16x64_bf16 v[44:47], v[20:23], a[128:135], v7
    ds_read_b128 v[84:87], v2 offset:3072
    v_smfmac_f32_16x16x64_bf16 v[48:51], v[20:23], a[136:143], v7
    ds_read_b128 v[20:23], v1 offset:4096
    v_smfmac_f32_16x16x64_bf16 v[28:31], v[24:27], v[240:247], v7
    v_smfmac_f32_16x16x64_bf16 v[32:35], v[24:27], v[248:255], v7
    v_smfmac_f32_16x16x64_bf16 v[36:39], v[24:27], a[0:7], v7
    s_waitcnt lgkmcnt(4)
    v_smfmac_f32_16x16x64_bf16 v[40:43], v[24:27], v[60:67], v7
    ds_read_b128 v[60:63], v2 offset:8192
    v_smfmac_f32_16x16x64_bf16 v[44:47], v[24:27], a[8:15], v7
    ds_read_b128 v[64:67], v2 offset:9216
    v_smfmac_f32_16x16x64_bf16 v[48:51], v[24:27], a[16:23], v7
    v_smfmac_f32_16x16x64_bf16 v[28:31], v[16:19], a[24:31], v7
    s_waitcnt vmcnt(3)
    ds_write_b128 v15, v[88:91] offset:5120
    v_smfmac_f32_16x16x64_bf16 v[32:35], v[16:19], a[32:39], v7
    s_waitcnt vmcnt(2)
    ds_write_b32 v13, v92 offset:5120
    v_max3_u32 v14, v88, v89, v90
    v_smfmac_f32_16x16x64_bf16 v[36:39], v[16:19], a[40:47], v7
    v_max3_u32 v14, v14, v91, v92
    s_waitcnt lgkmcnt(5)
    v_smfmac_f32_16x16x64_bf16 v[40:43], v[16:19], v[80:87], v7
    ds_read_b128 v[80:83], v2 offset:10240
    v_cmp_eq_u32 vcc, -1, v14
    v_smfmac_f32_16x16x64_bf16 v[44:47], v[16:19], a[48:55], v7
    ds_read_b128 v[84:87], v2 offset:11264
    s_cbranch_vccnz R_slowl_21
R_contl_21:
    v_smfmac_f32_16x16x64_bf16 v[48:51], v[16:19], a[56:63], v7
    s_waitcnt lgkmcnt(2)
    s_barrier
    ds_read_b128 v[24:27], v1 offset:5120
    v_smfmac_f32_16x16x64_bf16 v[28:31], v[20:23], a[144:151], v7
    ds_read_b128 v[16:19], v1 offset:6144
    buffer_store_dwordx4 v[68:71], v0, s[8:11], s41 offen sc1
    v_smfmac_f32_16x16x64_bf16 v[32:35], v[20:23], v[60:67], v7
    ds_read_b128 v[88:91], v2 offset:12288
    v_smfmac_f32_16x16x64_bf16 v[36:39], v[20:23], a[152:159], v7
    ds_read_b128 v[92:95], v2 offset:13312
    v_smfmac_f32_16x16x64_bf16 v[40:43], v[20:23], a[160:167], v7
    ds_read_b128 v[60:63], v2 offset:14336
    s_waitcnt lgkmcnt(5)
    v_smfmac_f32_16x16x64_bf16 v[44:47], v[20:23], v[80:87], v7
    ds_read_b128 v[64:67], v2 offset:15360
    v_smfmac_f32_16x16x64_bf16 v[48:51], v[20:23], a[168:175], v7
    ds_read_b128 v[20:23], v1 offset:7168
    s_waitcnt lgkmcnt(3)
    v_smfmac_f32_16x16x64_bf16 v[28:31], v[24:27], v[88:95], v7
    ds_read_b128 v[80:83], v2 offset:16384
    v_smfmac_f32_16x16x64_bf16 v[32:35], v[24:27], a[176:183], v7
    ds_read_b128 v[84:87], v2 offset:17408
    v_smfmac_f32_16x16x64_bf16 v[36:39], v[24:27], a[184:191], v7
    ds_read_b128 v[88:91], v2 offset:18432
    s_waitcnt lgkmcnt(4)
    v_smfmac_f32_16x16x64_bf16 v[40:43], v[24:27], v[60:67], v7
    ds_read_b128 v[24:27], v1 offset:8192
    v_smfmac_f32_16x16x64_bf16 v[28:31], v[16:19], a[192:199], v7
    ds_read_b128 v[92:95], v2 offset:19456
    s_waitcnt lgkmcnt(3)
    v_smfmac_f32_16x16x64_bf16 v[32:35], v[16:19], v[80:87], v7
    ds_read_b128 v[60:63], v2 offset:20480
    v_smfmac_f32_16x16x64_bf16 v[36:39], v[16:19], a[200:207], v7
    ds_read_b128 v[64:67], v2 offset:21504
    v_smfmac_f32_16x16x64_bf16 v[40:43], v[16:19], a[208:215], v7
    ds_read_b128 v[16:19], v1 offset:9216
    s_waitcnt lgkmcnt(3)
    v_smfmac_f32_16x16x64_bf16 v[28:31], v[20:23], v[88:95], v7
    ds_read_b128 v[80:83], v2 offset:22528
    v_smfmac_f32_16x16x64_bf16 v[32:35], v[20:23], a[216:223], v7
    ds_read_b128 v[84:87], v2 offset:23552
    v_smfmac_f32_16x16x64_bf16 v[28:31], v[24:27], a[224:231], v7
    ds_read_b128 v[88:91], v2 offset:24576
    s_waitcnt lgkmcnt(4)
    v_smfmac_f32_16x16x64_bf16 v[32:35], v[24:27], v[60:67], v7
    ds_read_b128 v[92:95], v2 offset:25600
    v_cndmask_b32 v8, v9, v12, s[52:53]
    s_waitcnt lgkmcnt(4)
    v_smfmac_f32_16x16x64_bf16 v[28:31], v[16:19], a[232:239], v7
    v_cndmask_b32 v11, v9, v12, s[52:53]
    s_waitcnt lgkmcnt(2)
    v_smfmac_f32_16x16x64_bf16 v[32:35], v[16:19], v[80:87], v7
    ds_read_b128 v[80:83], v2 offset:26624
    v_add_u32 v14, s57, v0
    v_smfmac_f32_16x16x64_bf16 v[36:39], v[20:23], a[240:247], v7
    ds_read_b128 v[84:87], v2 offset:27648
    v_smfmac_f32_16x16x64_bf16 v[40:43], v[20:23], a[248:255], v7
    s_waitcnt lgkmcnt(2)
    v_smfmac_f32_16x16x64_bf16 v[36:39], v[24:27], v[88:95], v7
    ds_read_b128 v[88:91], v2 offset:28672
    v_smfmac_f32_16x16x64_bf16 v[40:43], v[24:27], v[96:103], v7
    ds_read_b128 v[92:95], v2 offset:29696
    v_add_f32 v28, v28, v30
    v_add_f32 v29, v29, v31
    v_smfmac_f32_16x16x64_bf16 v[36:39], v[16:19], v[104:111], v7
    v_cvt_pk_bf16_f32 v68, v28, v29
    v_add_f32 v32, v32, v34
    v_smfmac_f32_16x16x64_bf16 v[40:43], v[16:19], v[112:119], v7
    v_add_f32 v33, v33, v35
    v_cvt_pk_bf16_f32 v69, v32, v33
    s_waitcnt lgkmcnt(2)
    v_smfmac_f32_16x16x64_bf16 v[44:47], v[20:23], v[80:87], v7
    ds_read_b128 v[80:83], v2 offset:30720
    v_mfma_f32_16x16x16_bf16 v[28:31], v[68:69], v[8:9], 0
    ds_read_b128 v[84:87], v2 offset:31744
    v_mfma_f32_16x16x16_bf16 v[32:35], v[68:69], v[10:11], 0
    v_smfmac_f32_16x16x64_bf16 v[48:51], v[20:23], v[120:127], v7
    ds_read_b128 v[20:23], v1 offset:5120
    v_add_f32 v36, v36, v38
    v_add_f32 v37, v37, v39
    v_cvt_pk_bf16_f32 v70, v36, v37
    v_add_f32 v40, v40, v42
    v_add_f32 v41, v41, v43
    v_cvt_pk_bf16_f32 v71, v40, v41
    v_cvt_pk_bf16_f32 v60, v28, v29
    v_cvt_pk_bf16_f32 v61, v30, v31
    v_mfma_f32_16x16x16_bf16 v[36:39], v[70:71], v[8:9], 0
    v_cvt_pk_bf16_f32 v62, v32, v33
    v_cvt_pk_bf16_f32 v63, v34, v35
    v_mfma_f32_16x16x16_bf16 v[40:43], v[70:71], v[10:11], 0
    s_nop 0
    v_mfma_f32_16x16x32_bf16 v[28:31], v[72:75], v[60:63], 0
    v_mfma_f32_16x16x32_bf16 v[32:35], v[76:79], v[60:63], 0
    s_waitcnt lgkmcnt(3)
    v_smfmac_f32_16x16x64_bf16 v[44:47], v[24:27], v[88:95], v7
    ds_read_b128 v[88:91], v2 offset:32768
    v_cvt_pk_bf16_f32 v64, v36, v37
    v_cvt_pk_bf16_f32 v65, v38, v39
    v_cvt_pk_bf16_f32 v66, v40, v41
    v_cvt_pk_bf16_f32 v67, v42, v43
    s_nop 0
    v_cndmask_b32 v28, v28, v32, s[54:55]
    v_cndmask_b32 v29, v29, v33, s[54:55]
    v_mfma_f32_16x16x32_bf16 v[36:39], v[64:67], v[60:63], 0
    v_cndmask_b32 v30, v30, v34, s[54:55]
    v_cndmask_b32 v31, v31, v35, s[54:55]
    ds_write_b128 v15, v[28:31] offset:10240
    v_smfmac_f32_16x16x64_bf16 v[48:51], v[24:27], v[128:135], v7
    ds_read_b128 v[24:27], v1 offset:6144
    s_nop 2
    v_cndmask_b32 v36, v36, v37, s[54:55]
    ds_write_b32 v14, v36 offset:14336
    buffer_load_dwordx4 v[72:75], v6, s[8:11], s22 offen sc1
    buffer_load_dwordx4 v[76:79], v6, s[8:11], s22 offen offset:128 sc1
    s_waitcnt lgkmcnt(5)
    v_smfmac_f32_16x16x64_bf16 v[44:47], v[16:19], v[80:87], v7
    ds_read_b128 v[92:95], v2 offset:33792
    ds_read_b128 v[80:83], v2 offset:34816
    v_smfmac_f32_16x16x64_bf16 v[48:51], v[16:19], v[136:143], v7
    ds_read_b128 v[84:87], v2 offset:35840
    s_waitcnt lgkmcnt(3)
    s_barrier
    ds_read_b128 v[68:71], v0 offset:14336
    ds_read_b128 v[32:35], v0 offset:13312
    ds_read_b128 v[36:39], v0 offset:10240
    ds_read_b128 v[40:43], v0 offset:11264
    s_cmp_eq_u32 s20, 63
    s_waitcnt lgkmcnt(6)
    v_smfmac_f32_16x16x64_bf16 v[44:47], v[20:23], v[88:95], v7
    v_smfmac_f32_16x16x64_bf16 v[48:51], v[20:23], v[144:151], v7
    s_waitcnt lgkmcnt(4)
    v_smfmac_f32_16x16x64_bf16 v[44:47], v[24:27], v[80:87], v7
    v_mov_b64 v[88:89], s[98:99]
    v_smfmac_f32_16x16x64_bf16 v[48:51], v[24:27], v[152:159], v7
    v_mov_b64 v[90:91], s[98:99]
    s_cbranch_scc1 R_end_21
    s_waitcnt lgkmcnt(3)
    v_pk_add_f32 v[68:69], v[68:69], v[70:71]
    s_waitcnt lgkmcnt(2)
    v_pk_add_f32 v[28:29], v[28:29], v[32:33]
    v_pk_add_f32 v[30:31], v[30:31], v[34:35]
    v_add_f32 v68, v68, v69
    s_waitcnt lgkmcnt(0)
    v_pk_add_f32 v[36:37], v[36:37], v[40:41]
    v_pk_add_f32 v[38:39], v[38:39], v[42:43]
    v_pk_add_f32 v[28:29], v[28:29], v[36:37]
    v_pk_add_f32 v[30:31], v[30:31], v[38:39]
    v_max3_f32 v13, v28, v29, v68
    v_max3_f32 v13, v30, v31, v13
    v_add_f32 v44, v44, v46
    v_add_f32 v45, v45, v47
    v_max_f32_dpp v13, v13, v13 quad_perm:[2,3,0,1] row_mask:0xf bank_mask:0xf
    v_mov_b32 v14, v13
    v_add_f32 v48, v48, v50
    v_add_f32 v49, v49, v51
    v_permlane16_swap_b32 v13, v14
    v_max_f32 v13, v13, v14
    v_mov_b32 v14, v13
    v_cvt_pk_bf16_f32 v70, v44, v45
    v_cvt_pk_bf16_f32 v71, v48, v49
    v_permlane32_swap_b32 v13, v14
    v_max_f32 v13, v13, v14
    v_mul_f32 v13, s60, v13
    v_fma_f32 v68, s60, v68, -v13
    v_pk_fma_f32 v[28:29], v[28:29], s[60:61], v[12:13] op_sel:[0,0,1] op_sel_hi:[1,0,1] neg_lo:[0,0,1] neg_hi:[0,0,1]
    v_pk_fma_f32 v[30:31], v[30:31], s[60:61], v[12:13] op_sel:[0,0,1] op_sel_hi:[1,0,1] neg_lo:[0,0,1] neg_hi:[0,0,1]
    v_exp_f32 v68, v68
    v_exp_f32 v28, v28
    v_exp_f32 v29, v29
    v_exp_f32 v30, v30
    v_exp_f32 v31, v31
    v_mov_b32_dpp v14, v68 quad_perm:[2,3,0,1] row_mask:0xf bank_mask:0xf
    v_cvt_pk_bf16_f32 v60, v28, v29
    v_cvt_pk_bf16_f32 v61, v30, v31
    v_cvt_pk_bf16_f32 v8, v68, v14
    v_cvt_pk_bf16_f32 v11, v68, v14
    v_mov_b32_dpp v62, v60 quad_perm:[2,3,0,1] row_mask:0xf bank_mask:0xf
    v_mfma_f32_16x16x16_bf16 v[28:31], v[88:89], v[8:9], 0
    v_mov_b32_dpp v63, v61 quad_perm:[2,3,0,1] row_mask:0xf bank_mask:0xf
    v_mfma_f32_16x16x16_bf16 v[36:39], v[70:71], v[8:9], 0
    v_lshrrev_b32 v14, 2, v6
    v_add_u32 v14, s59, v14
    v_mfma_f32_16x16x16_bf16 v[40:43], v[70:71], v[10:11], 0
    v_lshrrev_b32 v68, 1, v0
    v_mfma_f32_16x16x32_bf16 v[28:31], v[88:91], v[60:63], v[28:31]
    v_bfi_b32 v68, 24, v0, v68
    s_waitcnt vmcnt(4)
    v_mfma_f32_16x16x32_bf16 v[36:39], v[52:55], v[60:63], v[36:39]
    v_add_u32 v68, s59, v68
    s_waitcnt vmcnt(3)
    v_mfma_f32_16x16x32_bf16 v[40:43], v[56:59], v[60:63], v[40:43]
    s_nop 1
    v_rcp_f32 v13, v28
    s_mov_b64 exec, s[42:43]
    s_nop 0
    v_pk_mul_f32 v[36:37], v[36:37], v[12:13] op_sel:[0,1] op_sel_hi:[1,1]
    v_pk_mul_f32 v[38:39], v[38:39], v[12:13] op_sel:[0,1] op_sel_hi:[1,1]
    v_cvt_pk_bf16_f32 v36, v36, v37
    v_cvt_pk_bf16_f32 v37, v38, v39
    ds_write_b64 v5, v[36:37] offset:0
    v_pk_mul_f32 v[40:41], v[40:41], v[12:13] op_sel:[0,1] op_sel_hi:[1,1]
    v_pk_mul_f32 v[42:43], v[42:43], v[12:13] op_sel:[0,1] op_sel_hi:[1,1]
    v_cvt_pk_bf16_f32 v40, v40, v41
    v_cvt_pk_bf16_f32 v41, v42, v43
    ds_write_b64 v5, v[40:41] offset:128
    s_mov_b64 exec, -1
    v_mfma_f32_32x32x8_bf16 v[44:59], v[8:9], v[10:11], 0
    v_mfma_f32_32x32x8_bf16 v[28:43], v[8:9], v[10:11], 0
    s_waitcnt lgkmcnt(0)
    s_barrier
    ds_read_b128 v[16:19], v1 offset:0
    ds_read_b128 v[20:23], v1 offset:1024
    ds_write_b32 v14, v70 offset:12288
    ds_write_b32 v14, v71 offset:12320
    s_nop 1
    s_waitcnt lgkmcnt(3)
    v_smfmac_f32_16x16x64_bf16 v[44:47], v[16:19], v[160:167], v7
    s_waitcnt lgkmcnt(2)
    v_smfmac_f32_16x16x64_bf16 v[44:47], v[20:23], v[168:175], v7
    v_smfmac_f32_16x16x64_bf16 v[48:51], v[16:19], v[176:183], v7
    v_smfmac_f32_16x16x64_bf16 v[48:51], v[20:23], v[184:191], v7
    v_smfmac_f32_16x16x64_bf16 v[52:55], v[16:19], v[192:199], v7
    v_smfmac_f32_16x16x64_bf16 v[52:55], v[20:23], v[200:207], v7
    s_nop 3
    v_add_f32 v44, v44, v46
    v_add_f32 v45, v45, v47
    v_smfmac_f32_16x16x64_bf16 v[56:59], v[16:19], v[208:215], v7
    v_cvt_pk_bf16_f32 v24, v44, v45
    v_bfi_b32 v24, 1, s21, v24
    v_smfmac_f32_16x16x64_bf16 v[56:59], v[20:23], v[216:223], v7
    v_add_f32 v48, v48, v50
    v_permlane32_swap_b32 v24, v26
    v_smfmac_f32_16x16x64_bf16 v[28:31], v[16:19], v[224:231], v7
    v_add_f32 v49, v49, v51
    v_permlane16_swap_b32 v24, v25
    v_smfmac_f32_16x16x64_bf16 v[28:31], v[20:23], v[232:239], v7
    v_permlane16_swap_b32 v26, v27
    s_mov_b64 exec, 0xffff
    buffer_store_dwordx4 v[24:27], v0, s[8:11], s25 offen sc1
    s_mov_b64 exec, -1
    v_cvt_pk_bf16_f32 v60, v48, v49
    v_bfi_b32 v60, 1, s21, v60
    v_add_f32 v52, v52, v54
    v_add_f32 v53, v53, v55
    v_cvt_pk_bf16_f32 v61, v52, v53
    v_add_f32 v56, v56, v58
    v_add_f32 v57, v57, v59
    v_cvt_pk_bf16_f32 v62, v56, v57
    v_bfi_b32 v62, 1, s21, v62
    v_add_f32 v28, v28, v30
    v_add_f32 v29, v29, v31
    v_cvt_pk_bf16_f32 v63, v28, v29
    buffer_store_dwordx4 v[60:63], v0, s[8:11], s24 offen sc1
    ds_write_b128 v68, v[64:67] offset:10240
    s_branch R_comm_21
R_e_21:
    buffer_load_dwordx4 v[80:83], v0, s[8:11], s32 offen sc1
    buffer_load_dword v84, v68, s[8:11], s33 offen sc1
    s_waitcnt vmcnt(3)
    ds_write_b128 v15, v[52:55] offset:0
    s_waitcnt lgkmcnt(2)
    ds_read_b128 v[16:19], v1 offset:2048
    s_waitcnt vmcnt(2)
    ds_write_b32 v13, v56 offset:0
    v_max3_u32 v14, v52, v53, v54
    v_max3_u32 v14, v14, v55, v56
    v_cmp_eq_u32 vcc, -1, v14
    s_cbranch_vccz R_eput_21
    buffer_load_dwordx4 v[52:55], v0, s[8:11], s32 offen sc1
    buffer_load_dword v56, v68, s[8:11], s33 offen sc1
    s_waitcnt vmcnt(3)
    ds_write_b128 v15, v[80:83] offset:0
    s_waitcnt lgkmcnt(2)
    ds_read_b128 v[16:19], v1 offset:2048
    s_waitcnt vmcnt(2)
    ds_write_b32 v13, v84 offset:0
    v_max3_u32 v14, v80, v81, v82
    v_max3_u32 v14, v14, v83, v84
    v_cmp_eq_u32 vcc, -1, v14
    s_cbranch_vccz R_eput_21
    s_sub_u32 s40, s40, 1
    s_cbranch_scc0 R_e_21
    s_branch R_abort_21
R_slowl_21:
    v_lshrrev_b32 v14, 2, v0
    buffer_load_dwordx4 v[88:91], v0, s[8:11], s34 offen sc1
    buffer_load_dword v92, v14, s[8:11], s35 offen sc1
    s_sub_u32 s40, s40, 1
    s_cbranch_scc1 R_abort_21
    s_waitcnt vmcnt(1)
    v_max3_u32 v14, v88, v89, v90
    s_waitcnt vmcnt(0)
    v_max3_u32 v14, v14, v91, v92
    v_cmp_eq_u32 vcc, -1, v14
    s_cbranch_vccnz R_slowl_21
    ds_write_b128 v15, v[88:91] offset:5120
    ds_write_b32 v13, v92 offset:5120
    s_waitcnt lgkmcnt(0)
    s_branch R_contl_21
R_end_21:
    s_waitcnt lgkmcnt(0)
    s_lshl_b32 s64, s3, 12
    s_add_u32 s64, s64, 96337920
    s_cmp_eq_u32 s5, 0
    s_cbranch_scc0 R_endv_21
    v_lshrrev_b32 v68, 1, v0
    v_bfi_b32 v68, 24, v0, v68
    v_add_u32 v68, s59, v68
    buffer_store_dwordx4 v[64:67], v68, s[8:11], s64 offen sc1
    s_branch R_endw_21
R_endv_21:
    v_lshrrev_b32 v14, 2, v6
    v_add_u32 v14, s59, v14
    s_nop 4
    v_add_f32 v44, v44, v46
    v_add_f32 v45, v45, v47
    v_cvt_pk_bf16_f32 v44, v44, v45
    buffer_store_dword v44, v14, s[8:11], s64 offen offset:2048 sc1
    v_add_f32 v48, v48, v50
    v_add_f32 v49, v49, v51
    v_cvt_pk_bf16_f32 v48, v48, v49
    buffer_store_dword v48, v14, s[8:11], s64 offen offset:2080 sc1
R_endw_21:
    s_waitcnt vmcnt(0)
    s_barrier
R_abort_21:
    s_waitcnt vmcnt(0) lgkmcnt(0)
    s_branch R_exit
.p2align 6
R_comm_31:
    v_mfma_f32_32x32x8_bf16 v[44:59], v[8:9], v[10:11], 0
    v_mov_b64 v[28:29], 0
    v_mov_b64 v[30:31], 0
    v_mov_b32 v3, s20
    s_waitcnt vmcnt(5)
    v_cmp_eq_u32 vcc, 0, v4
    s_cbranch_vccnz R_slowk_31
R_contk_31:
    s_add_u32 s64, s20, 3
    s_lshr_b32 s64, s64, 1
    s_min_u32 s64, s64, 31
    s_lshl_b32 s64, s64, 2
    s_add_u32 s7, s64, s96
    s_add_u32 s20, s20, 1
    s_add_u32 s22, s22, 0x80000
    s_add_u32 s23, s23, 0x80000
    s_add_u32 s36, s30, s38
    s_add_u32 s37, s30, s39
    s_add_u32 s32, s36, s56
    s_add_u32 s33, s36, s58
    s_add_u32 s34, s30, s6
    s_add_u32 s35, s34, s58
    s_add_u32 s34, s34, s56
    s_mov_b32 s41, s63
    s_add_u32 s63, s63, 0x20000
    s_add_u32 s30, s30, 16384
    s_cmp_eq_u32 s30, 49152
    s_cselect_b32 s30, 0, s30
    s_add_u32 s31, s31, 16384
    s_cmp_eq_u32 s31, 49152
    s_cselect_b32 s31, 0, s31
    ds_read_b128 v[60:63], v2 offset:6144
    ds_read_b128 v[64:67], v2 offset:7168
    v_lshrrev_b32 v68, 2, v0
    v_bfe_u32 v14, v68, 5, 2
    v_lshlrev_b32 v13, 8, v14
    v_and_b32 v69, 0x9c, v68
    v_add_u32 v13, v13, v69
    v_and_b32 v69, 64, v68
    v_xor_b32 v69, s71, v69
    v_add_u32 v13, v13, v69
    s_waitcnt lgkmcnt(2)
    s_barrier
    s_xor_b32 s21, s21, 1
    s_sleep 4
    buffer_load_dwordx4 v[80:83], v0, s[8:11], s32 offen sc1
    buffer_load_dword v84, v68, s[8:11], s33 offen sc1
    s_sleep 3
    buffer_load_dwordx4 v[52:55], v0, s[8:11], s32 offen sc1
    buffer_load_dword v56, v68, s[8:11], s33 offen sc1
    s_waitcnt vmcnt(3)
    ds_write_b128 v15, v[80:83] offset:0
    ds_read_b128 v[16:19], v1 offset:3072
    s_waitcnt vmcnt(2)
    ds_write_b32 v13, v84 offset:0
    v_max3_u32 v14, v80, v81, v82
    v_max3_u32 v14, v14, v83, v84
    v_cmp_eq_u32 vcc, -1, v14
    s_cbranch_vccnz R_e_31
R_eput_31:
    buffer_load_dwordx4 v[88:91], v0, s[8:11], s34 offen sc1
    buffer_load_dword v92, v68, s[8:11], s35 offen sc1
R_top_31:
    s_waitcnt lgkmcnt(1)
    v_smfmac_f32_16x16x64_bf16 v[28:31], v[16:19], a[104:111], v7
    s_waitcnt lgkmcnt(0)
    s_barrier
    ds_read_b128 v[20:23], v1 offset:0
    ds_read_b128 v[24:27], v1 offset:1024
    v_smfmac_f32_16x16x64_bf16 v[32:35], v[16:19], a[112:119], v7
    buffer_load_dwordx4 v[52:55], v6, s[8:11], s23 offen sc1
    v_add_u32 v14, s62, v0
    v_smfmac_f32_16x16x64_bf16 v[36:39], v[16:19], a[120:127], v7
    buffer_load_dwordx4 v[56:59], v6, s[8:11], s23 offen offset:128 sc1
    v_smfmac_f32_16x16x64_bf16 v[40:43], v[16:19], v[60:67], v7
    s_waitcnt vmcnt(4)
    ds_read_b128 v[80:83], v2 offset:0
    v_smfmac_f32_16x16x64_bf16 v[44:47], v[16:19], a[128:135], v7
    ds_read_b128 v[84:87], v2 offset:1024
    v_smfmac_f32_16x16x64_bf16 v[48:51], v[16:19], a[136:143], v7
    ds_read_b128 v[16:19], v1 offset:2048
    s_waitcnt lgkmcnt(4)
    v_smfmac_f32_16x16x64_bf16 v[28:31], v[20:23], v[240:247], v7
    ds_read_b128 v[60:63], v2 offset:2048
    v_smfmac_f32_16x16x64_bf16 v[32:35], v[20:23], v[248:255], v7
    ds_read_b128 v[64:67], v2 offset:3072
    v_smfmac_f32_16x16x64_bf16 v[36:39], v[20:23], a[0:7], v7
    ds_read_b128 v[68:71], v14 offset:10240
    s_waitcnt lgkmcnt(4)
    v_smfmac_f32_16x16x64_bf16 v[40:43], v[20:23], v[80:87], v7
    ds_read_b128 v[80:83], v2 offset:4096
    v_smfmac_f32_16x16x64_bf16 v[44:47], v[20:23], a[8:15], v7
    ds_read_b128 v[84:87], v2 offset:5120
    v_smfmac_f32_16x16x64_bf16 v[48:51], v[20:23], a[16:23], v7
    ds_read_b128 v[20:23], v1 offset:4096
    v_smfmac_f32_16x16x64_bf16 v[28:31], v[24:27], a[24:31], v7
    v_smfmac_f32_16x16x64_bf16 v[32:35], v[24:27], a[32:39], v7
    v_smfmac_f32_16x16x64_bf16 v[36:39], v[24:27], a[40:47], v7
    s_waitcnt lgkmcnt(4)
    v_smfmac_f32_16x16x64_bf16 v[40:43], v[24:27], v[60:67], v7
    ds_read_b128 v[60:63], v2 offset:8192
    v_smfmac_f32_16x16x64_bf16 v[44:47], v[24:27], a[48:55], v7
    ds_read_b128 v[64:67], v2 offset:9216
    v_smfmac_f32_16x16x64_bf16 v[48:51], v[24:27], a[56:63], v7
    v_smfmac_f32_16x16x64_bf16 v[28:31], v[16:19], a[64:71], v7
    s_waitcnt vmcnt(3)
    ds_write_b128 v15, v[88:91] offset:5120
    v_smfmac_f32_16x16x64_bf16 v[32:35], v[16:19], a[72:79], v7
    s_waitcnt vmcnt(2)
    ds_write_b32 v13, v92 offset:5120
    v_max3_u32 v14, v88, v89, v90
    v_smfmac_f32_16x16x64_bf16 v[36:39], v[16:19], a[80:87], v7
    v_max3_u32 v14, v14, v91, v92
    s_waitcnt lgkmcnt(5)
    v_smfmac_f32_16x16x64_bf16 v[40:43], v[16:19], v[80:87], v7
    ds_read_b128 v[80:83], v2 offset:10240
    v_cmp_eq_u32 vcc, -1, v14
    v_and_b32 v14, 16, v0
    v_smfmac_f32_16x16x64_bf16 v[44:47], v[16:19], a[88:95], v7
    ds_read_b128 v[84:87], v2 offset:11264
    s_cbranch_vccnz R_slowl_31
R_contl_31:
    v_lshlrev_b32 v14, 7, v14
    v_smfmac_f32_16x16x64_bf16 v[48:51], v[16:19], a[96:103], v7
    s_waitcnt lgkmcnt(2)
    s_barrier
    ds_read_b128 v[24:27], v1 offset:5120
    v_smfmac_f32_16x16x64_bf16 v[28:31], v[20:23], a[144:151], v7
    ds_read_b128 v[16:19], v1 offset:6144
    buffer_store_dwordx4 v[68:71], v0, s[8:11], s41 offen sc1
    v_smfmac_f32_16x16x64_bf16 v[32:35], v[20:23], v[60:67], v7
    ds_read_b128 v[88:91], v2 offset:12288
    buffer_load_dword v4, v14, s[8:11], s7 offen sc1
    v_smfmac_f32_16x16x64_bf16 v[36:39], v[20:23], a[152:159], v7
    ds_read_b128 v[92:95], v2 offset:13312
    s_mov_b64 exec, 1
    buffer_store_dword v3, off, s[8:11], s61 sc1
    s_mov_b64 exec, -1
    v_smfmac_f32_16x16x64_bf16 v[40:43], v[20:23], a[160:167], v7
    ds_read_b128 v[60:63], v2 offset:14336
    s_waitcnt lgkmcnt(5)
    v_smfmac_f32_16x16x64_bf16 v[44:47], v[20:23], v[80:87], v7
    ds_read_b128 v[64:67], v2 offset:15360
    v_smfmac_f32_16x16x64_bf16 v[48:51], v[20:23], a[168:175], v7
    ds_read_b128 v[20:23], v1 offset:7168
    s_waitcnt lgkmcnt(3)
    v_smfmac_f32_16x16x64_bf16 v[28:31], v[24:27], v[88:95], v7
    ds_read_b128 v[80:83], v2 offset:16384
    v_smfmac_f32_16x16x64_bf16 v[32:35], v[24:27], a[176:183], v7
    ds_read_b128 v[84:87], v2 offset:17408
    v_smfmac_f32_16x16x64_bf16 v[36:39], v[24:27], a[184:191], v7
    ds_read_b128 v[88:91], v2 offset:18432
    s_waitcnt lgkmcnt(4)
    v_smfmac_f32_16x16x64_bf16 v[40:43], v[24:27], v[60:67], v7
    ds_read_b128 v[24:27], v1 offset:8192
    v_smfmac_f32_16x16x64_bf16 v[28:31], v[16:19], a[192:199], v7
    ds_read_b128 v[92:95], v2 offset:19456
    s_waitcnt lgkmcnt(3)
    v_smfmac_f32_16x16x64_bf16 v[32:35], v[16:19], v[80:87], v7
    ds_read_b128 v[60:63], v2 offset:20480
    v_smfmac_f32_16x16x64_bf16 v[36:39], v[16:19], a[200:207], v7
    ds_read_b128 v[64:67], v2 offset:21504
    v_smfmac_f32_16x16x64_bf16 v[40:43], v[16:19], a[208:215], v7
    ds_read_b128 v[16:19], v1 offset:9216
    s_waitcnt lgkmcnt(3)
    v_smfmac_f32_16x16x64_bf16 v[28:31], v[20:23], v[88:95], v7
    ds_read_b128 v[80:83], v2 offset:22528
    v_smfmac_f32_16x16x64_bf16 v[32:35], v[20:23], a[216:223], v7
    ds_read_b128 v[84:87], v2 offset:23552
    v_smfmac_f32_16x16x64_bf16 v[28:31], v[24:27], a[224:231], v7
    ds_read_b128 v[88:91], v2 offset:24576
    s_waitcnt lgkmcnt(4)
    v_smfmac_f32_16x16x64_bf16 v[32:35], v[24:27], v[60:67], v7
    ds_read_b128 v[92:95], v2 offset:25600
    v_cndmask_b32 v8, v9, v12, s[52:53]
    s_waitcnt lgkmcnt(4)
    v_smfmac_f32_16x16x64_bf16 v[28:31], v[16:19], a[232:239], v7
    v_cndmask_b32 v11, v9, v12, s[52:53]
    s_waitcnt lgkmcnt(2)
    v_smfmac_f32_16x16x64_bf16 v[32:35], v[16:19], v[80:87], v7
    ds_read_b128 v[80:83], v2 offset:26624
    v_add_u32 v14, s57, v0
    v_smfmac_f32_16x16x64_bf16 v[36:39], v[20:23], a[240:247], v7
    ds_read_b128 v[84:87], v2 offset:27648
    v_smfmac_f32_16x16x64_bf16 v[40:43], v[20:23], a[248:255], v7
    s_waitcnt lgkmcnt(2)
    v_smfmac_f32_16x16x64_bf16 v[36:39], v[24:27], v[88:95], v7
    ds_read_b128 v[88:91], v2 offset:28672
    v_smfmac_f32_16x16x64_bf16 v[40:43], v[24:27], v[96:103], v7
    ds_read_b128 v[92:95], v2 offset:29696
    v_add_f32 v28, v28, v30
    v_add_f32 v29, v29, v31
    v_smfmac_f32_16x16x64_bf16 v[36:39], v[16:19], v[104:111], v7
    v_cvt_pk_bf16_f32 v68, v28, v29
    v_add_f32 v32, v32, v34
    v_smfmac_f32_16x16x64_bf16 v[40:43], v[16:19], v[112:119], v7
    v_add_f32 v33, v33, v35
    v_cvt_pk_bf16_f32 v69, v32, v33
    s_waitcnt lgkmcnt(2)
    v_smfmac_f32_16x16x64_bf16 v[44:47], v[20:23], v[80:87], v7
    ds_read_b128 v[80:83], v2 offset:30720
    v_mfma_f32_16x16x16_bf16 v[28:31], v[68:69], v[8:9], 0
    ds_read_b128 v[84:87], v2 offset:31744
    v_mfma_f32_16x16x16_bf16 v[32:35], v[68:69], v[10:11], 0
    v_smfmac_f32_16x16x64_bf16 v[48:51], v[20:23], v[120:127], v7
    ds_read_b128 v[20:23], v1 offset:5120
    v_add_f32 v36, v36, v38
    v_add_f32 v37, v37, v39
    v_cvt_pk_bf16_f32 v70, v36, v37
    v_add_f32 v40, v40, v42
    v_add_f32 v41, v41, v43
    v_cvt_pk_bf16_f32 v71, v40, v41
    v_cvt_pk_bf16_f32 v60, v28, v29
    v_cvt_pk_bf16_f32 v61, v30, v31
    v_mfma_f32_16x16x16_bf16 v[36:39], v[70:71], v[8:9], 0
    v_cvt_pk_bf16_f32 v62, v32, v33
    v_cvt_pk_bf16_f32 v63, v34, v35
    v_mfma_f32_16x16x16_bf16 v[40:43], v[70:71], v[10:11], 0
    s_nop 0
    v_mfma_f32_16x16x32_bf16 v[28:31], v[72:75], v[60:63], 0
    v_mfma_f32_16x16x32_bf16 v[32:35], v[76:79], v[60:63], 0
    s_waitcnt lgkmcnt(3)
    v_smfmac_f32_16x16x64_bf16 v[44:47], v[24:27], v[88:95], v7
    ds_read_b128 v[88:91], v2 offset:32768
    v_cvt_pk_bf16_f32 v64, v36, v37
    v_cvt_pk_bf16_f32 v65, v38, v39
    v_cvt_pk_bf16_f32 v66, v40, v41
    v_cvt_pk_bf16_f32 v67, v42, v43
    s_nop 0
    v_cndmask_b32 v28, v28, v32, s[54:55]
    v_cndmask_b32 v29, v29, v33, s[54:55]
    v_mfma_f32_16x16x32_bf16 v[36:39], v[64:67], v[60:63], 0
    v_cndmask_b32 v30, v30, v34, s[54:55]
    v_cndmask_b32 v31, v31, v35, s[54:55]
    ds_write_b128 v15, v[28:31] offset:10240
    v_smfmac_f32_16x16x64_bf16 v[48:51], v[24:27], v[128:135], v7
    ds_read_b128 v[24:27], v1 offset:6144
    s_nop 2
    v_cndmask_b32 v36, v36, v37, s[54:55]
    ds_write_b32 v14, v36 offset:14336
    buffer_load_dwordx4 v[72:75], v6, s[8:11], s22 offen sc1
    buffer_load_dwordx4 v[76:79], v6, s[8:11], s22 offen offset:128 sc1
    s_waitcnt lgkmcnt(5)
    v_smfmac_f32_16x16x64_bf16 v[44:47], v[16:19], v[80:87], v7
    ds_read_b128 v[92:95], v2 offset:33792
    ds_read_b128 v[80:83], v2 offset:34816
    v_smfmac_f32_16x16x64_bf16 v[48:51], v[16:19], v[136:143], v7
    ds_read_b128 v[84:87], v2 offset:35840
    s_waitcnt lgkmcnt(3)
    s_barrier
    ds_read_b128 v[68:71], v0 offset:14336
    ds_read_b128 v[32:35], v0 offset:10240
    ds_read_b128 v[36:39], v0 offset:11264
    ds_read_b128 v[40:43], v0 offset:12288
    s_cmp_eq_u32 s20, 63
    s_waitcnt lgkmcnt(6)
    v_smfmac_f32_16x16x64_bf16 v[44:47], v[20:23], v[88:95], v7
    v_smfmac_f32_16x16x64_bf16 v[48:51], v[20:23], v[144:151], v7
    s_waitcnt lgkmcnt(4)
    v_smfmac_f32_16x16x64_bf16 v[44:47], v[24:27], v[80:87], v7
    v_mov_b64 v[88:89], s[98:99]
    v_smfmac_f32_16x16x64_bf16 v[48:51], v[24:27], v[152:159], v7
    v_mov_b64 v[90:91], s[98:99]
    s_cbranch_scc1 R_end_31
    s_waitcnt lgkmcnt(3)
    v_pk_add_f32 v[68:69], v[68:69], v[70:71]
    s_waitcnt lgkmcnt(2)
    v_pk_add_f32 v[28:29], v[28:29], v[32:33]
    v_pk_add_f32 v[30:31], v[30:31], v[34:35]
    v_add_f32 v68, v68, v69
    s_waitcnt lgkmcnt(0)
    v_pk_add_f32 v[36:37], v[36:37], v[40:41]
    v_pk_add_f32 v[38:39], v[38:39], v[42:43]
    v_pk_add_f32 v[28:29], v[28:29], v[36:37]
    v_pk_add_f32 v[30:31], v[30:31], v[38:39]
    v_max3_f32 v13, v28, v29, v68
    v_max3_f32 v13, v30, v31, v13
    v_add_f32 v44, v44, v46
    v_add_f32 v45, v45, v47
    v_max_f32_dpp v13, v13, v13 quad_perm:[2,3,0,1] row_mask:0xf bank_mask:0xf
    v_mov_b32 v14, v13
    v_add_f32 v48, v48, v50
    v_add_f32 v49, v49, v51
    v_permlane16_swap_b32 v13, v14
    v_max_f32 v13, v13, v14
    v_mov_b32 v14, v13
    v_cvt_pk_bf16_f32 v70, v44, v45
    v_cvt_pk_bf16_f32 v71, v48, v49
    v_permlane32_swap_b32 v13, v14
    v_max_f32 v13, v13, v14
    v_mul_f32 v13, s60, v13
    v_fma_f32 v68, s60, v68, -v13
    v_pk_fma_f32 v[28:29], v[28:29], s[60:61], v[12:13] op_sel:[0,0,1] op_sel_hi:[1,0,1] neg_lo:[0,0,1] neg_hi:[0,0,1]
    v_pk_fma_f32 v[30:31], v[30:31], s[60:61], v[12:13] op_sel:[0,0,1] op_sel_hi:[1,0,1] neg_lo:[0,0,1] neg_hi:[0,0,1]
    v_exp_f32 v68, v68
    v_exp_f32 v28, v28
    v_exp_f32 v29, v29
    v_exp_f32 v30, v30
    v_exp_f32 v31, v31
    v_mov_b32_dpp v14, v68 quad_perm:[2,3,0,1] row_mask:0xf bank_mask:0xf
    v_cvt_pk_bf16_f32 v60, v28, v29
    v_cvt_pk_bf16_f32 v61, v30, v31
    v_cvt_pk_bf16_f32 v8, v68, v14
    v_cvt_pk_bf16_f32 v11, v68, v14
    v_mov_b32_dpp v62, v60 quad_perm:[2,3,0,1] row_mask:0xf bank_mask:0xf
    v_mfma_f32_16x16x16_bf16 v[28:31], v[88:89], v[8:9], 0
    v_mov_b32_dpp v63, v61 quad_perm:[2,3,0,1] row_mask:0xf bank_mask:0xf
    v_mfma_f32_16x16x16_bf16 v[36:39], v[70:71], v[8:9], 0
    v_lshrrev_b32 v14, 2, v6
    v_add_u32 v14, s59, v14
    v_mfma_f32_16x16x16_bf16 v[40:43], v[70:71], v[10:11], 0
    v_lshrrev_b32 v68, 1, v0
    v_mfma_f32_16x16x32_bf16 v[28:31], v[88:91], v[60:63], v[28:31]
    v_bfi_b32 v68, 24, v0, v68
    s_waitcnt vmcnt(6)
    v_mfma_f32_16x16x32_bf16 v[36:39], v[52:55], v[60:63], v[36:39]
    v_add_u32 v68, s59, v68
    s_waitcnt vmcnt(5)
    v_mfma_f32_16x16x32_bf16 v[40:43], v[56:59], v[60:63], v[40:43]
    s_nop 1
    v_rcp_f32 v13, v28
    s_mov_b64 exec, s[42:43]
    s_nop 0
    v_pk_mul_f32 v[36:37], v[36:37], v[12:13] op_sel:[0,1] op_sel_hi:[1,1]
    v_pk_mul_f32 v[38:39], v[38:39], v[12:13] op_sel:[0,1] op_sel_hi:[1,1]
    v_cvt_pk_bf16_f32 v36, v36, v37
    v_cvt_pk_bf16_f32 v37, v38, v39
    ds_write_b64 v5, v[36:37] offset:0
    v_pk_mul_f32 v[40:41], v[40:41], v[12:13] op_sel:[0,1] op_sel_hi:[1,1]
    v_pk_mul_f32 v[42:43], v[42:43], v[12:13] op_sel:[0,1] op_sel_hi:[1,1]
    v_cvt_pk_bf16_f32 v40, v40, v41
    v_cvt_pk_bf16_f32 v41, v42, v43
    ds_write_b64 v5, v[40:41] offset:128
    s_mov_b64 exec, -1
    v_mfma_f32_32x32x8_bf16 v[44:59], v[8:9], v[10:11], 0
    v_mfma_f32_32x32x8_bf16 v[28:43], v[8:9], v[10:11], 0
    s_waitcnt lgkmcnt(0)
    s_barrier
    ds_read_b128 v[16:19], v1 offset:0
    ds_read_b128 v[20:23], v1 offset:1024
    ds_write_b32 v14, v70 offset:12288
    ds_write_b32 v14, v71 offset:12320
    s_nop 1
    s_waitcnt lgkmcnt(3)
    v_smfmac_f32_16x16x64_bf16 v[44:47], v[16:19], v[160:167], v7
    s_waitcnt lgkmcnt(2)
    v_smfmac_f32_16x16x64_bf16 v[44:47], v[20:23], v[168:175], v7
    v_smfmac_f32_16x16x64_bf16 v[48:51], v[16:19], v[176:183], v7
    v_smfmac_f32_16x16x64_bf16 v[48:51], v[20:23], v[184:191], v7
    v_smfmac_f32_16x16x64_bf16 v[52:55], v[16:19], v[192:199], v7
    v_smfmac_f32_16x16x64_bf16 v[52:55], v[20:23], v[200:207], v7
    s_nop 3
    v_add_f32 v44, v44, v46
    v_add_f32 v45, v45, v47
    v_smfmac_f32_16x16x64_bf16 v[56:59], v[16:19], v[208:215], v7
    v_cvt_pk_bf16_f32 v24, v44, v45
    v_bfi_b32 v24, 1, s21, v24
    v_smfmac_f32_16x16x64_bf16 v[56:59], v[20:23], v[216:223], v7
    v_add_f32 v48, v48, v50
    v_permlane32_swap_b32 v24, v26
    v_smfmac_f32_16x16x64_bf16 v[28:31], v[16:19], v[224:231], v7
    v_add_f32 v49, v49, v51
    v_permlane16_swap_b32 v24, v25
    v_smfmac_f32_16x16x64_bf16 v[28:31], v[20:23], v[232:239], v7
    v_permlane16_swap_b32 v26, v27
    s_mov_b64 exec, 0xffff
    buffer_store_dwordx4 v[24:27], v0, s[8:11], s25 offen sc1
    s_mov_b64 exec, -1
    v_cvt_pk_bf16_f32 v60, v48, v49
    v_bfi_b32 v60, 1, s21, v60
    v_add_f32 v52, v52, v54
    v_add_f32 v53, v53, v55
    v_cvt_pk_bf16_f32 v61, v52, v53
    v_add_f32 v56, v56, v58
    v_add_f32 v57, v57, v59
    v_cvt_pk_bf16_f32 v62, v56, v57
    v_bfi_b32 v62, 1, s21, v62
    v_add_f32 v28, v28, v30
    v_add_f32 v29, v29, v31
    v_cvt_pk_bf16_f32 v63, v28, v29
    buffer_store_dwordx4 v[60:63], v0, s[8:11], s24 offen sc1
    ds_write_b128 v68, v[64:67] offset:10240
    s_branch R_comm_31
R_e_31:
    buffer_load_dwordx4 v[80:83], v0, s[8:11], s32 offen sc1
    buffer_load_dword v84, v68, s[8:11], s33 offen sc1
    s_waitcnt vmcnt(3)
    ds_write_b128 v15, v[52:55] offset:0
    s_waitcnt lgkmcnt(2)
    ds_read_b128 v[16:19], v1 offset:3072
    s_waitcnt vmcnt(2)
    ds_write_b32 v13, v56 offset:0
    v_max3_u32 v14, v52, v53, v54
    v_max3_u32 v14, v14, v55, v56
    v_cmp_eq_u32 vcc, -1, v14
    s_cbranch_vccz R_eput_31
    buffer_load_dwordx4 v[52:55], v0, s[8:11], s32 offen sc1
    buffer_load_dword v56, v68, s[8:11], s33 offen sc1
    s_waitcnt vmcnt(3)
    ds_write_b128 v15, v[80:83] offset:0
    s_waitcnt lgkmcnt(2)
    ds_read_b128 v[16:19], v1 offset:3072
    s_waitcnt vmcnt(2)
    ds_write_b32 v13, v84 offset:0
    v_max3_u32 v14, v80, v81, v82
    v_max3_u32 v14, v14, v83, v84
    v_cmp_eq_u32 vcc, -1, v14
    s_cbranch_vccz R_eput_31
    s_sub_u32 s40, s40, 1
    s_cbranch_scc0 R_e_31
    s_branch R_abort_31
R_slowl_31:
    v_lshrrev_b32 v14, 2, v0
    buffer_load_dwordx4 v[88:91], v0, s[8:11], s34 offen sc1
    buffer_load_dword v92, v14, s[8:11], s35 offen sc1
    s_sub_u32 s40, s40, 1
    s_cbranch_scc1 R_abort_31
    s_waitcnt vmcnt(1)
    v_max3_u32 v14, v88, v89, v90
    s_waitcnt vmcnt(0)
    v_max3_u32 v14, v14, v91, v92
    v_cmp_eq_u32 vcc, -1, v14
    s_cbranch_vccnz R_slowl_31
    ds_write_b128 v15, v[88:91] offset:5120
    ds_write_b32 v13, v92 offset:5120
    s_waitcnt lgkmcnt(0)
    s_branch R_contl_31
R_slowk_31:
    v_and_b32 v14, 16, v0
    v_lshlrev_b32 v14, 7, v14
    buffer_load_dword v4, v14, s[8:11], s7 offen sc1
    s_sub_u32 s40, s40, 1
    s_cbranch_scc1 R_abort_31
    s_waitcnt vmcnt(0)
    v_cmp_eq_u32 vcc, 0, v4
    s_cbranch_vccnz R_slowk_31
    s_branch R_contk_31
R_end_31:
    s_waitcnt lgkmcnt(0)
    s_lshl_b32 s64, s3, 12
    s_add_u32 s64, s64, 96337920
    s_cmp_eq_u32 s5, 0
    s_cbranch_scc0 R_endv_31
    v_lshrrev_b32 v68, 1, v0
    v_bfi_b32 v68, 24, v0, v68
    v_add_u32 v68, s59, v68
    buffer_store_dwordx4 v[64:67], v68, s[8:11], s64 offen sc1
    s_branch R_endw_31
R_endv_31:
    v_lshrrev_b32 v14, 2, v6
    v_add_u32 v14, s59, v14
    s_nop 4
    v_add_f32 v44, v44, v46
    v_add_f32 v45, v45, v47
    v_cvt_pk_bf16_f32 v44, v44, v45
    buffer_store_dword v44, v14, s[8:11], s64 offen offset:2048 sc1
    v_add_f32 v48, v48, v50
    v_add_f32 v49, v49, v51
    v_cvt_pk_bf16_f32 v48, v48, v49
    buffer_store_dword v48, v14, s[8:11], s64 offen offset:2080 sc1
R_endw_31:
    s_waitcnt vmcnt(0)
    s_barrier
    v_mov_b32 v14, 64
    s_mov_b64 exec, 1
    buffer_store_dword v14, off, s[8:11], s61 sc1
    s_mov_b64 exec, -1
R_abort_31:
    s_waitcnt vmcnt(0) lgkmcnt(0)
    s_branch R_exit
R_exit:
    s_endpgm
.section .rodata,"a"
.p2align 6
.p2align 6
.amdhsa_kernel recurrent_scan__memory_aug_recurrent_mem_tr__geglu_ffn__prompt_kernel
  .amdhsa_next_free_vgpr 512
  .amdhsa_next_free_sgpr 102
  .amdhsa_accum_offset 256
  .amdhsa_group_segment_fixed_size 0
  .amdhsa_kernarg_size 112
  .amdhsa_user_sgpr_count 2
  .amdhsa_user_sgpr_kernarg_segment_ptr 1
  .amdhsa_system_sgpr_workgroup_id_x 1
.end_amdhsa_kernel
```
